```python
import torch

def _softmax(x, axis=-1):
    return torch.softmax(x, dim=axis)

def _gelu(x):
    return torch.nn.functional.gelu(x, approximate='tanh')

def _silu(x):
    return torch.nn.functional.silu(x)

def _sigmoid(x):
    return torch.sigmoid(x)

def _layernorm(x, axis=-1, eps=1e-05):
    m = x.mean(dim=axis, keepdim=True)
    v = x.var(dim=axis, keepdim=True, unbiased=False)
    return (x - m) / torch.sqrt(v + eps)

def _scatter_add(tgt, idx, src, axis=0):
    return tgt.clone().index_add_(axis, idx, src)

def _segment_sum(src, seg, n):
    out = torch.zeros((n,) + src.shape[1:], dtype=src.dtype)
    return out.index_add_(0, seg, src)

def _pad(x, pw):
    flat = tuple((v for pair in reversed(pw) for v in pair))
    return torch.nn.functional.pad(x, flat)
kernel_name = 'gated_mix__ssm_conv_s5__memory_aug_recurrent_mem_tr__prompt'

def setup_inputs():

    _w = lambda a: (lambda t: t.to(torch.bfloat16) if t.is_floating_point() else t)(torch.as_tensor(a))

    def _A_setup():
        B, S, D = (1, 2048, 448)
        P = D
        Lambda_re = -0.5 * (lambda _x: torch.exp(torch.as_tensor(_x)))((lambda *s: torch.randn(*s, dtype=torch.bfloat16) * 0.8)(P))
        Lambda_im = (lambda *s: torch.randn(*s, dtype=torch.bfloat16) * 0.8)(P) * 1.0
        B_re = (lambda *s: torch.randn(*s, dtype=torch.bfloat16) * 0.8)(P, D) * D ** (-0.5)
        B_im = (lambda *s: torch.randn(*s, dtype=torch.bfloat16) * 0.8)(P, D) * D ** (-0.5)
        C_re = (lambda *s: torch.randn(*s, dtype=torch.bfloat16) * 0.8)(D, P) * P ** (-0.5)
        C_im = (lambda *s: torch.randn(*s, dtype=torch.bfloat16) * 0.8)(D, P) * P ** (-0.5)
        log_dt = (lambda *s: torch.randn(*s, dtype=torch.bfloat16) * 0.8)(P) * 0.3 - 2.0
        Dskip = (lambda *s: torch.randn(*s, dtype=torch.bfloat16) * 0.8)(D)
        return {'x': _w((lambda *s: torch.randn(*s, dtype=torch.bfloat16) * 0.05)(B, S, D)), 'Lambda_re': _w(Lambda_re), 'Lambda_im': _w(Lambda_im), 'B_re': _w(B_re), 'B_im': _w(B_im), 'C_re': _w(C_re), 'C_im': _w(C_im), 'log_dt': _w(log_dt), 'Dskip': _w(Dskip)}
    _A_in = _A_setup()

    def _B_setup():
        B, S, Dm = (1, 2048, 448)
        H, Dh = (16, 256)
        M, seg = (8, 32)
        seg = min(seg, S)
        S = S // seg * seg
        return {'x': _w((lambda *s: torch.randn(*s, dtype=torch.bfloat16) * 0.05)(B, S, Dm)), 'mem0': _w((lambda *s: torch.randn(*s, dtype=torch.bfloat16) * 0.8)(B, M, Dm)), 'Wq': _w((lambda *s: torch.randn(*s, dtype=torch.bfloat16) * 3.2)(Dm, H, Dh) * Dm ** (-0.5)), 'Wk': _w((lambda *s: torch.randn(*s, dtype=torch.bfloat16) * 3.2)(Dm, H, Dh) * Dm ** (-0.5)), 'Wv': _w((lambda *s: torch.randn(*s, dtype=torch.bfloat16) * 0.8)(Dm, H, Dh) * Dm ** (-0.5)), 'Wo': _w((lambda *s: torch.randn(*s, dtype=torch.bfloat16) * 0.8)(H, Dh, Dm) * (H * Dh) ** (-0.5)), 'seg_len': seg}
    _B_in = _B_setup()
    return {'A_x': _A_in['x'], 'A_Lambda_re': _A_in['Lambda_re'], 'A_Lambda_im': _A_in['Lambda_im'], 'A_B_re': _A_in['B_re'], 'A_B_im': _A_in['B_im'], 'A_C_re': _A_in['C_re'], 'A_C_im': _A_in['C_im'], 'A_log_dt': _A_in['log_dt'], 'A_Dskip': _A_in['Dskip'], 'B_x': _B_in['x'], 'B_mem0': _B_in['mem0'], 'B_Wq': _B_in['Wq'], 'B_Wk': _B_in['Wk'], 'B_Wv': _B_in['Wv'], 'B_Wo': _B_in['Wo'], 'B_seg_len': _B_in['seg_len'], 'gate_w': _w((lambda *s: torch.randn(*s, dtype=torch.bfloat16) * 0.05)(448) * 16.0)}

def reference(A_x, A_Lambda_re, A_Lambda_im, A_B_re, A_B_im, A_C_re, A_C_im, A_log_dt, A_Dskip, B_x, B_mem0, B_Wq, B_Wk, B_Wv, B_Wo, B_seg_len, gate_w):

    def _A_ref(x, Lambda_re, Lambda_im, B_re, B_im, C_re, C_im, log_dt, Dskip):
        Bsz, L, H = x.shape
        Lam = Lambda_re + 1j * Lambda_im
        Bmat = B_re + 1j * B_im
        Cmat = C_re + 1j * C_im
        dt = torch.exp(log_dt)
        Lam_bar = torch.exp(dt * Lam)
        B_bar = ((Lam_bar - 1.0) / Lam)[:, None] * Bmat
        Bu = torch.einsum('bld,pd->blp', x + 0j, B_bar)
        h = torch.zeros_like(Bu[:, 0, :])
        hs = []
        for t in range(L):
            h = Lam_bar[None, :] * h + Bu[:, t, :]
            hs.append(h)
        hseq = torch.stack(hs, 1)
        y = 2.0 * torch.einsum('blp,dp->bld', hseq, Cmat).real + x * Dskip[None, None, :]
        return y

    def _B_ref(x, mem0, Wq, Wk, Wv, Wo, seg_len):
        B, S, Dm = x.shape
        H, Dh = (Wq.shape[1], Wq.shape[2])
        M = mem0.shape[1]
        scale = Dh ** (-0.5)
        n_seg = S // seg_len
        L = M + seg_len
        idx = torch.arange(L)
        mask = (idx[:, None] < M) | (idx[:, None] >= idx[None, :])
        mem = mem0
        outs = []
        for s in range(n_seg):
            xs = x[:, s * seg_len:(s + 1) * seg_len, :].clone()
            h = torch.concatenate([mem, xs], axis=1)
            q = torch.einsum('btd,dhe->bhte', h, Wq)
            k = torch.einsum('btd,dhe->bhte', h, Wk)
            v = torch.einsum('btd,dhe->bhte', h, Wv)
            scores = torch.einsum('bhqe,bhke->bhqk', q, k) * scale
            scores = torch.where(mask[None, None], scores, -1000000000.0)
            p = _softmax(scores, axis=-1)
            o = torch.einsum('bhqk,bhke->bhqe', p, v)
            o = torch.einsum('bhte,hed->btd', o, Wo)
            mem = o[:, :M, :].clone()
            outs.append(o[:, M:, :])
        return torch.concatenate(outs, axis=1)
    x = A_x
    g = _sigmoid((x * gate_w).sum(-1, keepdims=True))
    a = _A_ref(x, A_Lambda_re, A_Lambda_im, A_B_re, A_B_im, A_C_re, A_C_im, A_log_dt, A_Dskip)
    b = _B_ref(x, B_mem0, B_Wq, B_Wk, B_Wv, B_Wo, B_seg_len)
    return g * a + (1 - g) * b
```

```asm
; @launch kernel=prep_kernel grid=(256,1,1) block=(256,1,1) lds=32768
; @launch kernel=main_kernel grid=(256,1,1) block=(256,1,1) lds=163840
.amdgcn_target "amdgcn-amd-amdhsa--gfx950"
.text
.globl prep_kernel
.p2align 8
.type prep_kernel,@function
prep_kernel:
    s_cmp_ge_u32 s2, 256
    s_cbranch_scc1 K1_END
    s_load_dwordx2 s[4:5], s[0:1], 152
    s_waitcnt lgkmcnt(0)
    s_and_b32 s5, s5, 0xffff
    s_mov_b32 s6, 100564992
    s_mov_b32 s7, 0x00020000
    v_and_b32 v1, 63, v0
    v_lshrrev_b32 v2, 6, v0
    s_nop 1
    v_readfirstlane_b32 s20, v2
    v_and_b32 v3, 15, v1
    v_lshrrev_b32 v4, 4, v1
    s_cmp_ge_u32 s2, 224
    s_cbranch_scc1 K1_MISC
    s_cmp_ge_u32 s2, 112
    s_cselect_b32 s21, 1, 0
    s_mul_i32 s16, s21, 112
    s_sub_u32 s16, s2, s16
    s_mul_i32 s17, s16, 9363
    s_lshr_b32 s17, s17, 16
    s_mul_i32 s18, s17, 7
    s_sub_u32 s18, s16, s18
    v_lshrrev_b32 v5, 2, v3
    v_lshlrev_b32 v5, 3, v5
    v_and_b32 v6, 3, v3
    v_add_u32 v5, v5, v6
    v_lshlrev_b32 v5, 13, v5
    v_lshl_add_u32 v5, v4, 4, v5
    s_cmp_eq_u32 s21, 0
    s_cbranch_scc0 K1_VO
    s_load_dwordx2 s[8:9], s[0:1], 88
    s_load_dwordx2 s[12:13], s[0:1], 96
    s_waitcnt lgkmcnt(0)
    s_and_b32 s9, s9, 0xffff
    s_mov_b32 s10, 3670016
    s_mov_b32 s11, 0x00020000
    s_and_b32 s13, s13, 0xffff
    s_mov_b32 s14, 3670016
    s_mov_b32 s15, 0x00020000
    s_lshl_b32 s22, s18, 19
    s_add_u32 s22, s22, 0
    s_lshl_b32 s23, s17, 9
    s_add_u32 s22, s22, s23
    buffer_load_dwordx4 v[64:67], v5, s[12:15], s22 offen offset:0
    buffer_load_dwordx4 v[68:71], v5, s[12:15], s22 offen offset:64
    buffer_load_dwordx4 v[72:75], v5, s[12:15], s22 offen offset:128
    buffer_load_dwordx4 v[76:79], v5, s[12:15], s22 offen offset:192
    buffer_load_dwordx4 v[80:83], v5, s[12:15], s22 offen offset:256
    buffer_load_dwordx4 v[84:87], v5, s[12:15], s22 offen offset:320
    buffer_load_dwordx4 v[88:91], v5, s[12:15], s22 offen offset:384
    buffer_load_dwordx4 v[92:95], v5, s[12:15], s22 offen offset:448
    s_lshl_b32 s22, s18, 19
    s_add_u32 s22, s22, 32768
    s_lshl_b32 s23, s17, 9
    s_add_u32 s22, s22, s23
    buffer_load_dwordx4 v[96:99], v5, s[12:15], s22 offen offset:0
    buffer_load_dwordx4 v[100:103], v5, s[12:15], s22 offen offset:64
    buffer_load_dwordx4 v[104:107], v5, s[12:15], s22 offen offset:128
    buffer_load_dwordx4 v[108:111], v5, s[12:15], s22 offen offset:192
    buffer_load_dwordx4 v[112:115], v5, s[12:15], s22 offen offset:256
    buffer_load_dwordx4 v[116:119], v5, s[12:15], s22 offen offset:320
    buffer_load_dwordx4 v[120:123], v5, s[12:15], s22 offen offset:384
    buffer_load_dwordx4 v[124:127], v5, s[12:15], s22 offen offset:448
    s_lshl_b32 s22, s18, 19
    s_add_u32 s22, s22, 262144
    s_lshl_b32 s23, s17, 9
    s_add_u32 s22, s22, s23
    buffer_load_dwordx4 v[128:131], v5, s[12:15], s22 offen offset:0
    buffer_load_dwordx4 v[132:135], v5, s[12:15], s22 offen offset:64
    buffer_load_dwordx4 v[136:139], v5, s[12:15], s22 offen offset:128
    buffer_load_dwordx4 v[140:143], v5, s[12:15], s22 offen offset:192
    buffer_load_dwordx4 v[144:147], v5, s[12:15], s22 offen offset:256
    buffer_load_dwordx4 v[148:151], v5, s[12:15], s22 offen offset:320
    buffer_load_dwordx4 v[152:155], v5, s[12:15], s22 offen offset:384
    buffer_load_dwordx4 v[156:159], v5, s[12:15], s22 offen offset:448
    s_lshl_b32 s22, s18, 19
    s_add_u32 s22, s22, 294912
    s_lshl_b32 s23, s17, 9
    s_add_u32 s22, s22, s23
    buffer_load_dwordx4 v[160:163], v5, s[12:15], s22 offen offset:0
    buffer_load_dwordx4 v[164:167], v5, s[12:15], s22 offen offset:64
    buffer_load_dwordx4 v[168:171], v5, s[12:15], s22 offen offset:128
    buffer_load_dwordx4 v[172:175], v5, s[12:15], s22 offen offset:192
    buffer_load_dwordx4 v[176:179], v5, s[12:15], s22 offen offset:256
    buffer_load_dwordx4 v[180:183], v5, s[12:15], s22 offen offset:320
    buffer_load_dwordx4 v[184:187], v5, s[12:15], s22 offen offset:384
    buffer_load_dwordx4 v[188:191], v5, s[12:15], s22 offen offset:448
    s_mov_b32 s24, 0x3d800000
    s_mov_b32 s25, 0
    s_branch K1_GEMM
K1_VO:
    s_load_dwordx2 s[8:9], s[0:1], 104
    s_load_dwordx2 s[12:13], s[0:1], 112
    s_waitcnt lgkmcnt(0)
    s_and_b32 s9, s9, 0xffff
    s_mov_b32 s10, 3670016
    s_mov_b32 s11, 0x00020000
    s_and_b32 s13, s13, 0xffff
    s_mov_b32 s14, 3670016
    s_mov_b32 s15, 0x00020000
    v_lshrrev_b32 v6, 3, v0
    v_and_b32 v7, 7, v0
    s_mov_b32 s22, 896
    v_mul_lo_u32 v8, v6, s22
    v_lshl_add_u32 v8, v7, 4, v8
    v_lshlrev_b32 v9, 7, v6
    v_lshl_add_u32 v9, v7, 4, v9
    s_mul_i32 s22, s17, 229376
    s_lshl_b32 s23, s18, 7
    s_add_u32 s22, s22, s23
    buffer_load_dwordx4 v[192:195], v8, s[12:15], s22 offen
    s_add_u32 s22, s22, 28672
    buffer_load_dwordx4 v[196:199], v8, s[12:15], s22 offen
    s_add_u32 s22, s22, 28672
    buffer_load_dwordx4 v[200:203], v8, s[12:15], s22 offen
    s_add_u32 s22, s22, 28672
    buffer_load_dwordx4 v[204:207], v8, s[12:15], s22 offen
    s_add_u32 s22, s22, 28672
    buffer_load_dwordx4 v[208:211], v8, s[12:15], s22 offen
    s_add_u32 s22, s22, 28672
    buffer_load_dwordx4 v[212:215], v8, s[12:15], s22 offen
    s_add_u32 s22, s22, 28672
    buffer_load_dwordx4 v[216:219], v8, s[12:15], s22 offen
    s_add_u32 s22, s22, 28672
    buffer_load_dwordx4 v[220:223], v8, s[12:15], s22 offen
    s_add_u32 s22, s22, 28672
    s_waitcnt vmcnt(7)
    ds_write_b128 v9, v[192:195] offset:0
    s_waitcnt vmcnt(6)
    ds_write_b128 v9, v[196:199] offset:4096
    s_waitcnt vmcnt(5)
    ds_write_b128 v9, v[200:203] offset:8192
    s_waitcnt vmcnt(4)
    ds_write_b128 v9, v[204:207] offset:12288
    s_waitcnt vmcnt(3)
    ds_write_b128 v9, v[208:211] offset:16384
    s_waitcnt vmcnt(2)
    ds_write_b128 v9, v[212:215] offset:20480
    s_waitcnt vmcnt(1)
    ds_write_b128 v9, v[216:219] offset:24576
    s_waitcnt vmcnt(0)
    ds_write_b128 v9, v[220:223] offset:28672
    s_waitcnt lgkmcnt(0)
    s_barrier
    v_lshrrev_b32 v6, 2, v3
    v_lshl_add_u32 v6, v4, 3, v6
    v_lshlrev_b32 v6, 7, v6
    v_and_b32 v7, 3, v3
    v_lshl_add_u32 v6, v7, 3, v6
    ds_read_b64_tr_b16 v[64:65], v6 offset:0
    ds_read_b64_tr_b16 v[66:67], v6 offset:512
    ds_read_b64_tr_b16 v[68:69], v6 offset:4096
    ds_read_b64_tr_b16 v[70:71], v6 offset:4608
    ds_read_b64_tr_b16 v[72:73], v6 offset:8192
    ds_read_b64_tr_b16 v[74:75], v6 offset:8704
    ds_read_b64_tr_b16 v[76:77], v6 offset:12288
    ds_read_b64_tr_b16 v[78:79], v6 offset:12800
    ds_read_b64_tr_b16 v[80:81], v6 offset:16384
    ds_read_b64_tr_b16 v[82:83], v6 offset:16896
    ds_read_b64_tr_b16 v[84:85], v6 offset:20480
    ds_read_b64_tr_b16 v[86:87], v6 offset:20992
    ds_read_b64_tr_b16 v[88:89], v6 offset:24576
    ds_read_b64_tr_b16 v[90:91], v6 offset:25088
    ds_read_b64_tr_b16 v[92:93], v6 offset:28672
    ds_read_b64_tr_b16 v[94:95], v6 offset:29184
    s_waitcnt lgkmcnt(0)
    ds_read_b64_tr_b16 v[96:97], v6 offset:32
    ds_read_b64_tr_b16 v[98:99], v6 offset:544
    ds_read_b64_tr_b16 v[100:101], v6 offset:4128
    ds_read_b64_tr_b16 v[102:103], v6 offset:4640
    ds_read_b64_tr_b16 v[104:105], v6 offset:8224
    ds_read_b64_tr_b16 v[106:107], v6 offset:8736
    ds_read_b64_tr_b16 v[108:109], v6 offset:12320
    ds_read_b64_tr_b16 v[110:111], v6 offset:12832
    ds_read_b64_tr_b16 v[112:113], v6 offset:16416
    ds_read_b64_tr_b16 v[114:115], v6 offset:16928
    ds_read_b64_tr_b16 v[116:117], v6 offset:20512
    ds_read_b64_tr_b16 v[118:119], v6 offset:21024
    ds_read_b64_tr_b16 v[120:121], v6 offset:24608
    ds_read_b64_tr_b16 v[122:123], v6 offset:25120
    ds_read_b64_tr_b16 v[124:125], v6 offset:28704
    ds_read_b64_tr_b16 v[126:127], v6 offset:29216
    s_waitcnt lgkmcnt(0)
    ds_read_b64_tr_b16 v[128:129], v6 offset:64
    ds_read_b64_tr_b16 v[130:131], v6 offset:576
    ds_read_b64_tr_b16 v[132:133], v6 offset:4160
    ds_read_b64_tr_b16 v[134:135], v6 offset:4672
    ds_read_b64_tr_b16 v[136:137], v6 offset:8256
    ds_read_b64_tr_b16 v[138:139], v6 offset:8768
    ds_read_b64_tr_b16 v[140:141], v6 offset:12352
    ds_read_b64_tr_b16 v[142:143], v6 offset:12864
    ds_read_b64_tr_b16 v[144:145], v6 offset:16448
    ds_read_b64_tr_b16 v[146:147], v6 offset:16960
    ds_read_b64_tr_b16 v[148:149], v6 offset:20544
    ds_read_b64_tr_b16 v[150:151], v6 offset:21056
    ds_read_b64_tr_b16 v[152:153], v6 offset:24640
    ds_read_b64_tr_b16 v[154:155], v6 offset:25152
    ds_read_b64_tr_b16 v[156:157], v6 offset:28736
    ds_read_b64_tr_b16 v[158:159], v6 offset:29248
    s_waitcnt lgkmcnt(0)
    ds_read_b64_tr_b16 v[160:161], v6 offset:96
    ds_read_b64_tr_b16 v[162:163], v6 offset:608
    ds_read_b64_tr_b16 v[164:165], v6 offset:4192
    ds_read_b64_tr_b16 v[166:167], v6 offset:4704
    ds_read_b64_tr_b16 v[168:169], v6 offset:8288
    ds_read_b64_tr_b16 v[170:171], v6 offset:8800
    ds_read_b64_tr_b16 v[172:173], v6 offset:12384
    ds_read_b64_tr_b16 v[174:175], v6 offset:12896
    ds_read_b64_tr_b16 v[176:177], v6 offset:16480
    ds_read_b64_tr_b16 v[178:179], v6 offset:16992
    ds_read_b64_tr_b16 v[180:181], v6 offset:20576
    ds_read_b64_tr_b16 v[182:183], v6 offset:21088
    ds_read_b64_tr_b16 v[184:185], v6 offset:24672
    ds_read_b64_tr_b16 v[186:187], v6 offset:25184
    ds_read_b64_tr_b16 v[188:189], v6 offset:28768
    ds_read_b64_tr_b16 v[190:191], v6 offset:29280
    s_waitcnt lgkmcnt(0)
    s_mov_b32 s24, 1.0
    s_mov_b32 s25, 6422528
K1_GEMM:
    s_mul_i32 s22, s17, 28
    s_lshl_b32 s23, s18, 2
    s_add_u32 s22, s22, s23
    s_mul_i32 s22, s22, 14336
    s_add_u32 s25, s25, s22
    v_lshlrev_b32 v7, 4, v1
    s_mov_b32 s26, s20
    s_lshl_b32 s22, s26, 18
    s_lshl_b32 s23, s17, 9
    s_add_u32 s22, s22, s23
    buffer_load_dwordx4 v[192:195], v5, s[8:11], s22 offen offset:0
    buffer_load_dwordx4 v[196:199], v5, s[8:11], s22 offen offset:64
    buffer_load_dwordx4 v[200:203], v5, s[8:11], s22 offen offset:128
    buffer_load_dwordx4 v[204:207], v5, s[8:11], s22 offen offset:192
    buffer_load_dwordx4 v[208:211], v5, s[8:11], s22 offen offset:256
    buffer_load_dwordx4 v[212:215], v5, s[8:11], s22 offen offset:320
    buffer_load_dwordx4 v[216:219], v5, s[8:11], s22 offen offset:384
    buffer_load_dwordx4 v[220:223], v5, s[8:11], s22 offen offset:448
    s_add_u32 s22, s22, 32768
    buffer_load_dwordx4 v[224:227], v5, s[8:11], s22 offen offset:0
    buffer_load_dwordx4 v[228:231], v5, s[8:11], s22 offen offset:64
    buffer_load_dwordx4 v[232:235], v5, s[8:11], s22 offen offset:128
    buffer_load_dwordx4 v[236:239], v5, s[8:11], s22 offen offset:192
    buffer_load_dwordx4 v[240:243], v5, s[8:11], s22 offen offset:256
    buffer_load_dwordx4 v[244:247], v5, s[8:11], s22 offen offset:320
    buffer_load_dwordx4 v[248:251], v5, s[8:11], s22 offen offset:384
    buffer_load_dwordx4 v[252:255], v5, s[8:11], s22 offen offset:448
    s_waitcnt vmcnt(0)
K1_KS:
    v_mov_b32 v16, 0
    v_mov_b32 v17, 0
    v_mov_b32 v18, 0
    v_mov_b32 v19, 0
    v_mov_b32 v20, 0
    v_mov_b32 v21, 0
    v_mov_b32 v22, 0
    v_mov_b32 v23, 0
    v_mov_b32 v24, 0
    v_mov_b32 v25, 0
    v_mov_b32 v26, 0
    v_mov_b32 v27, 0
    v_mov_b32 v28, 0
    v_mov_b32 v29, 0
    v_mov_b32 v30, 0
    v_mov_b32 v31, 0
    v_mov_b32 v32, 0
    v_mov_b32 v33, 0
    v_mov_b32 v34, 0
    v_mov_b32 v35, 0
    v_mov_b32 v36, 0
    v_mov_b32 v37, 0
    v_mov_b32 v38, 0
    v_mov_b32 v39, 0
    v_mov_b32 v40, 0
    v_mov_b32 v41, 0
    v_mov_b32 v42, 0
    v_mov_b32 v43, 0
    v_mov_b32 v44, 0
    v_mov_b32 v45, 0
    v_mov_b32 v46, 0
    v_mov_b32 v47, 0
    v_mfma_f32_16x16x32_bf16 v[16:19], v[192:195], v[64:67], v[16:19]
    v_mfma_f32_16x16x32_bf16 v[20:23], v[192:195], v[96:99], v[20:23]
    v_mfma_f32_16x16x32_bf16 v[24:27], v[192:195], v[128:131], v[24:27]
    v_mfma_f32_16x16x32_bf16 v[28:31], v[192:195], v[160:163], v[28:31]
    v_mfma_f32_16x16x32_bf16 v[32:35], v[224:227], v[64:67], v[32:35]
    v_mfma_f32_16x16x32_bf16 v[36:39], v[224:227], v[96:99], v[36:39]
    v_mfma_f32_16x16x32_bf16 v[40:43], v[224:227], v[128:131], v[40:43]
    v_mfma_f32_16x16x32_bf16 v[44:47], v[224:227], v[160:163], v[44:47]
    v_mfma_f32_16x16x32_bf16 v[16:19], v[196:199], v[68:71], v[16:19]
    v_mfma_f32_16x16x32_bf16 v[20:23], v[196:199], v[100:103], v[20:23]
    v_mfma_f32_16x16x32_bf16 v[24:27], v[196:199], v[132:135], v[24:27]
    v_mfma_f32_16x16x32_bf16 v[28:31], v[196:199], v[164:167], v[28:31]
    v_mfma_f32_16x16x32_bf16 v[32:35], v[228:231], v[68:71], v[32:35]
    v_mfma_f32_16x16x32_bf16 v[36:39], v[228:231], v[100:103], v[36:39]
    v_mfma_f32_16x16x32_bf16 v[40:43], v[228:231], v[132:135], v[40:43]
    v_mfma_f32_16x16x32_bf16 v[44:47], v[228:231], v[164:167], v[44:47]
    v_mfma_f32_16x16x32_bf16 v[16:19], v[200:203], v[72:75], v[16:19]
    v_mfma_f32_16x16x32_bf16 v[20:23], v[200:203], v[104:107], v[20:23]
    v_mfma_f32_16x16x32_bf16 v[24:27], v[200:203], v[136:139], v[24:27]
    v_mfma_f32_16x16x32_bf16 v[28:31], v[200:203], v[168:171], v[28:31]
    v_mfma_f32_16x16x32_bf16 v[32:35], v[232:235], v[72:75], v[32:35]
    v_mfma_f32_16x16x32_bf16 v[36:39], v[232:235], v[104:107], v[36:39]
    v_mfma_f32_16x16x32_bf16 v[40:43], v[232:235], v[136:139], v[40:43]
    v_mfma_f32_16x16x32_bf16 v[44:47], v[232:235], v[168:171], v[44:47]
    v_mfma_f32_16x16x32_bf16 v[16:19], v[204:207], v[76:79], v[16:19]
    v_mfma_f32_16x16x32_bf16 v[20:23], v[204:207], v[108:111], v[20:23]
    v_mfma_f32_16x16x32_bf16 v[24:27], v[204:207], v[140:143], v[24:27]
    v_mfma_f32_16x16x32_bf16 v[28:31], v[204:207], v[172:175], v[28:31]
    v_mfma_f32_16x16x32_bf16 v[32:35], v[236:239], v[76:79], v[32:35]
    v_mfma_f32_16x16x32_bf16 v[36:39], v[236:239], v[108:111], v[36:39]
    v_mfma_f32_16x16x32_bf16 v[40:43], v[236:239], v[140:143], v[40:43]
    v_mfma_f32_16x16x32_bf16 v[44:47], v[236:239], v[172:175], v[44:47]
    v_mfma_f32_16x16x32_bf16 v[16:19], v[208:211], v[80:83], v[16:19]
    v_mfma_f32_16x16x32_bf16 v[20:23], v[208:211], v[112:115], v[20:23]
    v_mfma_f32_16x16x32_bf16 v[24:27], v[208:211], v[144:147], v[24:27]
    v_mfma_f32_16x16x32_bf16 v[28:31], v[208:211], v[176:179], v[28:31]
    v_mfma_f32_16x16x32_bf16 v[32:35], v[240:243], v[80:83], v[32:35]
    v_mfma_f32_16x16x32_bf16 v[36:39], v[240:243], v[112:115], v[36:39]
    v_mfma_f32_16x16x32_bf16 v[40:43], v[240:243], v[144:147], v[40:43]
    v_mfma_f32_16x16x32_bf16 v[44:47], v[240:243], v[176:179], v[44:47]
    v_mfma_f32_16x16x32_bf16 v[16:19], v[212:215], v[84:87], v[16:19]
    v_mfma_f32_16x16x32_bf16 v[20:23], v[212:215], v[116:119], v[20:23]
    v_mfma_f32_16x16x32_bf16 v[24:27], v[212:215], v[148:151], v[24:27]
    v_mfma_f32_16x16x32_bf16 v[28:31], v[212:215], v[180:183], v[28:31]
    v_mfma_f32_16x16x32_bf16 v[32:35], v[244:247], v[84:87], v[32:35]
    v_mfma_f32_16x16x32_bf16 v[36:39], v[244:247], v[116:119], v[36:39]
    v_mfma_f32_16x16x32_bf16 v[40:43], v[244:247], v[148:151], v[40:43]
    v_mfma_f32_16x16x32_bf16 v[44:47], v[244:247], v[180:183], v[44:47]
    v_mfma_f32_16x16x32_bf16 v[16:19], v[216:219], v[88:91], v[16:19]
    v_mfma_f32_16x16x32_bf16 v[20:23], v[216:219], v[120:123], v[20:23]
    v_mfma_f32_16x16x32_bf16 v[24:27], v[216:219], v[152:155], v[24:27]
    v_mfma_f32_16x16x32_bf16 v[28:31], v[216:219], v[184:187], v[28:31]
    v_mfma_f32_16x16x32_bf16 v[32:35], v[248:251], v[88:91], v[32:35]
    v_mfma_f32_16x16x32_bf16 v[36:39], v[248:251], v[120:123], v[36:39]
    v_mfma_f32_16x16x32_bf16 v[40:43], v[248:251], v[152:155], v[40:43]
    v_mfma_f32_16x16x32_bf16 v[44:47], v[248:251], v[184:187], v[44:47]
    v_mfma_f32_16x16x32_bf16 v[16:19], v[220:223], v[92:95], v[16:19]
    v_mfma_f32_16x16x32_bf16 v[20:23], v[220:223], v[124:127], v[20:23]
    v_mfma_f32_16x16x32_bf16 v[24:27], v[220:223], v[156:159], v[24:27]
    v_mfma_f32_16x16x32_bf16 v[28:31], v[220:223], v[188:191], v[28:31]
    v_mfma_f32_16x16x32_bf16 v[32:35], v[252:255], v[92:95], v[32:35]
    v_mfma_f32_16x16x32_bf16 v[36:39], v[252:255], v[124:127], v[36:39]
    v_mfma_f32_16x16x32_bf16 v[40:43], v[252:255], v[156:159], v[40:43]
    v_mfma_f32_16x16x32_bf16 v[44:47], v[252:255], v[188:191], v[44:47]
    s_add_u32 s27, s26, 4
    s_cmp_lt_u32 s27, 14
    s_cbranch_scc0 K1_NOLD
    s_lshl_b32 s22, s27, 18
    s_lshl_b32 s23, s17, 9
    s_add_u32 s22, s22, s23
    buffer_load_dwordx4 v[192:195], v5, s[8:11], s22 offen offset:0
    buffer_load_dwordx4 v[196:199], v5, s[8:11], s22 offen offset:64
    buffer_load_dwordx4 v[200:203], v5, s[8:11], s22 offen offset:128
    buffer_load_dwordx4 v[204:207], v5, s[8:11], s22 offen offset:192
    buffer_load_dwordx4 v[208:211], v5, s[8:11], s22 offen offset:256
    buffer_load_dwordx4 v[212:215], v5, s[8:11], s22 offen offset:320
    buffer_load_dwordx4 v[216:219], v5, s[8:11], s22 offen offset:384
    buffer_load_dwordx4 v[220:223], v5, s[8:11], s22 offen offset:448
    s_add_u32 s22, s22, 32768
    buffer_load_dwordx4 v[224:227], v5, s[8:11], s22 offen offset:0
    buffer_load_dwordx4 v[228:231], v5, s[8:11], s22 offen offset:64
    buffer_load_dwordx4 v[232:235], v5, s[8:11], s22 offen offset:128
    buffer_load_dwordx4 v[236:239], v5, s[8:11], s22 offen offset:192
    buffer_load_dwordx4 v[240:243], v5, s[8:11], s22 offen offset:256
    buffer_load_dwordx4 v[244:247], v5, s[8:11], s22 offen offset:320
    buffer_load_dwordx4 v[248:251], v5, s[8:11], s22 offen offset:384
    buffer_load_dwordx4 v[252:255], v5, s[8:11], s22 offen offset:448
K1_NOLD:
    s_nop 7
    s_nop 3
    s_lshl_b32 s22, s26, 10
    s_add_u32 s22, s22, s25
    v_mul_f32 v16, s24, v16
    v_mul_f32 v17, s24, v17
    v_mul_f32 v18, s24, v18
    v_mul_f32 v19, s24, v19
    v_mul_f32 v32, s24, v32
    v_mul_f32 v33, s24, v33
    v_mul_f32 v34, s24, v34
    v_mul_f32 v35, s24, v35
    v_cvt_pk_bf16_f32 v48, v16, v17
    v_cvt_pk_bf16_f32 v49, v18, v19
    v_cvt_pk_bf16_f32 v50, v32, v33
    v_cvt_pk_bf16_f32 v51, v34, v35
    buffer_store_dwordx4 v[48:51], v7, s[4:7], s22 offen
    s_add_u32 s22, s22, 14336
    v_mul_f32 v20, s24, v20
    v_mul_f32 v21, s24, v21
    v_mul_f32 v22, s24, v22
    v_mul_f32 v23, s24, v23
    v_mul_f32 v36, s24, v36
    v_mul_f32 v37, s24, v37
    v_mul_f32 v38, s24, v38
    v_mul_f32 v39, s24, v39
    v_cvt_pk_bf16_f32 v52, v20, v21
    v_cvt_pk_bf16_f32 v53, v22, v23
    v_cvt_pk_bf16_f32 v54, v36, v37
    v_cvt_pk_bf16_f32 v55, v38, v39
    buffer_store_dwordx4 v[52:55], v7, s[4:7], s22 offen
    s_add_u32 s22, s22, 14336
    v_mul_f32 v24, s24, v24
    v_mul_f32 v25, s24, v25
    v_mul_f32 v26, s24, v26
    v_mul_f32 v27, s24, v27
    v_mul_f32 v40, s24, v40
    v_mul_f32 v41, s24, v41
    v_mul_f32 v42, s24, v42
    v_mul_f32 v43, s24, v43
    v_cvt_pk_bf16_f32 v56, v24, v25
    v_cvt_pk_bf16_f32 v57, v26, v27
    v_cvt_pk_bf16_f32 v58, v40, v41
    v_cvt_pk_bf16_f32 v59, v42, v43
    buffer_store_dwordx4 v[56:59], v7, s[4:7], s22 offen
    s_add_u32 s22, s22, 14336
    v_mul_f32 v28, s24, v28
    v_mul_f32 v29, s24, v29
    v_mul_f32 v30, s24, v30
    v_mul_f32 v31, s24, v31
    v_mul_f32 v44, s24, v44
    v_mul_f32 v45, s24, v45
    v_mul_f32 v46, s24, v46
    v_mul_f32 v47, s24, v47
    v_cvt_pk_bf16_f32 v60, v28, v29
    v_cvt_pk_bf16_f32 v61, v30, v31
    v_cvt_pk_bf16_f32 v62, v44, v45
    v_cvt_pk_bf16_f32 v63, v46, v47
    buffer_store_dwordx4 v[60:63], v7, s[4:7], s22 offen
    s_add_u32 s22, s22, 14336
    s_add_u32 s26, s26, 4
    s_cmp_lt_u32 s26, 14
    s_cbranch_scc0 K1_END
    s_waitcnt vmcnt(4)
    s_branch K1_KS
K1_MISC:
    s_sub_u32 s16, s2, 224
    s_load_dwordx2 s[8:9], s[0:1], 0
    s_waitcnt lgkmcnt(0)
    s_and_b32 s9, s9, 0xffff
    s_mov_b32 s10, 1835008
    s_mov_b32 s11, 0x00020000
    s_lshr_b32 s17, s20, 1
    s_lshl_b32 s18, s16, 1
    s_add_u32 s17, s17, s18
    s_and_b32 s18, s20, 1
    s_lshl_b32 s19, s17, 1
    s_add_u32 s19, s19, s18
    s_mul_i32 s22, s19, 14336
    s_mov_b32 s23, 896
    v_mul_lo_u32 v5, v3, s23
    v_lshl_add_u32 v5, v4, 4, v5
    buffer_load_dwordx4 v[64:67], v5, s[8:11], s22 offen offset:0
    buffer_load_dwordx4 v[68:71], v5, s[8:11], s22 offen offset:64
    buffer_load_dwordx4 v[72:75], v5, s[8:11], s22 offen offset:128
    buffer_load_dwordx4 v[76:79], v5, s[8:11], s22 offen offset:192
    buffer_load_dwordx4 v[80:83], v5, s[8:11], s22 offen offset:256
    buffer_load_dwordx4 v[84:87], v5, s[8:11], s22 offen offset:320
    buffer_load_dwordx4 v[88:91], v5, s[8:11], s22 offen offset:384
    buffer_load_dwordx4 v[92:95], v5, s[8:11], s22 offen offset:448
    buffer_load_dwordx4 v[96:99], v5, s[8:11], s22 offen offset:512
    buffer_load_dwordx4 v[100:103], v5, s[8:11], s22 offen offset:576
    buffer_load_dwordx4 v[104:107], v5, s[8:11], s22 offen offset:640
    buffer_load_dwordx4 v[108:111], v5, s[8:11], s22 offen offset:704
    buffer_load_dwordx4 v[112:115], v5, s[8:11], s22 offen offset:768
    buffer_load_dwordx4 v[116:119], v5, s[8:11], s22 offen offset:832
    s_add_u32 s22, s22, 12845056
    v_lshlrev_b32 v7, 4, v1
    s_waitcnt vmcnt(13)
    buffer_store_dwordx4 v[64:67], v7, s[4:7], s22 offen
    s_add_u32 s22, s22, 1024
    s_waitcnt vmcnt(13)
    buffer_store_dwordx4 v[68:71], v7, s[4:7], s22 offen
    s_add_u32 s22, s22, 1024
    s_waitcnt vmcnt(13)
    buffer_store_dwordx4 v[72:75], v7, s[4:7], s22 offen
    s_add_u32 s22, s22, 1024
    s_waitcnt vmcnt(13)
    buffer_store_dwordx4 v[76:79], v7, s[4:7], s22 offen
    s_add_u32 s22, s22, 1024
    s_waitcnt vmcnt(13)
    buffer_store_dwordx4 v[80:83], v7, s[4:7], s22 offen
    s_add_u32 s22, s22, 1024
    s_waitcnt vmcnt(13)
    buffer_store_dwordx4 v[84:87], v7, s[4:7], s22 offen
    s_add_u32 s22, s22, 1024
    s_waitcnt vmcnt(13)
    buffer_store_dwordx4 v[88:91], v7, s[4:7], s22 offen
    s_add_u32 s22, s22, 1024
    s_waitcnt vmcnt(13)
    buffer_store_dwordx4 v[92:95], v7, s[4:7], s22 offen
    s_add_u32 s22, s22, 1024
    s_waitcnt vmcnt(13)
    buffer_store_dwordx4 v[96:99], v7, s[4:7], s22 offen
    s_add_u32 s22, s22, 1024
    s_waitcnt vmcnt(13)
    buffer_store_dwordx4 v[100:103], v7, s[4:7], s22 offen
    s_add_u32 s22, s22, 1024
    s_waitcnt vmcnt(13)
    buffer_store_dwordx4 v[104:107], v7, s[4:7], s22 offen
    s_add_u32 s22, s22, 1024
    s_waitcnt vmcnt(13)
    buffer_store_dwordx4 v[108:111], v7, s[4:7], s22 offen
    s_add_u32 s22, s22, 1024
    s_waitcnt vmcnt(13)
    buffer_store_dwordx4 v[112:115], v7, s[4:7], s22 offen
    s_add_u32 s22, s22, 1024
    s_waitcnt vmcnt(13)
    buffer_store_dwordx4 v[116:119], v7, s[4:7], s22 offen
    s_add_u32 s22, s22, 1024
    v_mov_b32 v16, -1
    v_mov_b32 v20, 0
    v_mov_b32 v17, -1
    v_mov_b32 v21, 0
    v_mov_b32 v18, -1
    v_mov_b32 v22, 0
    v_mov_b32 v19, -1
    v_mov_b32 v23, 0
    v_lshlrev_b32 v7, 4, v0
    s_mul_i32 s22, s16, 53248
    s_add_u32 s22, s22, 73400320
    buffer_store_dwordx4 v[16:19], v7, s[4:7], s22 offen
    s_add_u32 s22, s22, 4096
    buffer_store_dwordx4 v[16:19], v7, s[4:7], s22 offen
    s_add_u32 s22, s22, 4096
    buffer_store_dwordx4 v[16:19], v7, s[4:7], s22 offen
    s_add_u32 s22, s22, 4096
    buffer_store_dwordx4 v[16:19], v7, s[4:7], s22 offen
    s_add_u32 s22, s22, 4096
    buffer_store_dwordx4 v[16:19], v7, s[4:7], s22 offen
    s_add_u32 s22, s22, 4096
    buffer_store_dwordx4 v[16:19], v7, s[4:7], s22 offen
    s_add_u32 s22, s22, 4096
    buffer_store_dwordx4 v[16:19], v7, s[4:7], s22 offen
    s_add_u32 s22, s22, 4096
    buffer_store_dwordx4 v[16:19], v7, s[4:7], s22 offen
    s_add_u32 s22, s22, 4096
    buffer_store_dwordx4 v[16:19], v7, s[4:7], s22 offen
    s_add_u32 s22, s22, 4096
    buffer_store_dwordx4 v[16:19], v7, s[4:7], s22 offen
    s_add_u32 s22, s22, 4096
    buffer_store_dwordx4 v[16:19], v7, s[4:7], s22 offen
    s_add_u32 s22, s22, 4096
    buffer_store_dwordx4 v[16:19], v7, s[4:7], s22 offen
    s_add_u32 s22, s22, 4096
    buffer_store_dwordx4 v[16:19], v7, s[4:7], s22 offen
    s_add_u32 s22, s22, 4096
    s_cmp_eq_u32 s16, 1
    s_cbranch_scc0 K1_NOZ
    s_mov_b32 s22, 100507648
    buffer_store_dwordx4 v[20:23], v7, s[4:7], s22 offen
    s_add_u32 s22, s22, 4096
    buffer_store_dwordx4 v[20:23], v7, s[4:7], s22 offen
    s_add_u32 s22, s22, 4096
    buffer_store_dwordx4 v[20:23], v7, s[4:7], s22 offen
    s_add_u32 s22, s22, 4096
    buffer_store_dwordx4 v[20:23], v7, s[4:7], s22 offen
    s_add_u32 s22, s22, 4096
    buffer_store_dwordx4 v[20:23], v7, s[4:7], s22 offen
    s_add_u32 s22, s22, 4096
    buffer_store_dwordx4 v[20:23], v7, s[4:7], s22 offen
    s_add_u32 s22, s22, 4096
    buffer_store_dwordx4 v[20:23], v7, s[4:7], s22 offen
    s_add_u32 s22, s22, 4096
    buffer_store_dwordx4 v[20:23], v7, s[4:7], s22 offen
    s_add_u32 s22, s22, 4096
    buffer_store_dwordx4 v[20:23], v7, s[4:7], s22 offen
    s_add_u32 s22, s22, 4096
    buffer_store_dwordx4 v[20:23], v7, s[4:7], s22 offen
    s_add_u32 s22, s22, 4096
    buffer_store_dwordx4 v[20:23], v7, s[4:7], s22 offen
    s_add_u32 s22, s22, 4096
    buffer_store_dwordx4 v[20:23], v7, s[4:7], s22 offen
    s_add_u32 s22, s22, 4096
    buffer_store_dwordx4 v[20:23], v7, s[4:7], s22 offen
    s_add_u32 s22, s22, 4096
    buffer_store_dwordx4 v[20:23], v7, s[4:7], s22 offen
    s_add_u32 s22, s22, 4096
K1_NOZ:
    s_mov_b32 s22, 73400320
    s_cmp_eq_u32 s16, 0
    s_cbranch_scc1 K1_MEM0
    s_mov_b32 s22, 73859072
    s_cmp_eq_u32 s16, 8
    s_cbranch_scc0 K1_END
K1_MEM0:
    s_waitcnt vmcnt(0)
    s_barrier
    s_load_dwordx2 s[8:9], s[0:1], 80
    s_waitcnt lgkmcnt(0)
    s_and_b32 s9, s9, 0xffff
    s_mov_b32 s10, 7168
    s_mov_b32 s11, 0x00020000
    v_add_u32 v5, 0, v0
    v_lshrrev_b32 v6, 6, v5
    v_lshlrev_b32 v6, 7, v6
    v_bfe_u32 v8, v5, 4, 2
    v_lshl_add_u32 v6, v8, 5, v6
    v_bfe_u32 v8, v5, 3, 1
    v_lshl_add_u32 v6, v8, 2, v6
    v_and_b32 v8, 7, v5
    s_mov_b32 s23, 896
    v_mul_lo_u32 v8, v8, s23
    v_add_u32 v6, v6, v8
    v_lshlrev_b32 v9, 4, v5
    buffer_load_dword v24, v6, s[8:11], 0 offen offset:0
    buffer_load_dword v25, v6, s[8:11], 0 offen offset:8
    buffer_load_dword v26, v6, s[8:11], 0 offen offset:16
    buffer_load_dword v27, v6, s[8:11], 0 offen offset:24
    s_waitcnt vmcnt(0)
    buffer_store_dwordx4 v[24:27], v9, s[4:7], s22 offen
    s_nop 1
    v_add_u32 v5, 256, v0
    v_lshrrev_b32 v6, 6, v5
    v_lshlrev_b32 v6, 7, v6
    v_bfe_u32 v8, v5, 4, 2
    v_lshl_add_u32 v6, v8, 5, v6
    v_bfe_u32 v8, v5, 3, 1
    v_lshl_add_u32 v6, v8, 2, v6
    v_and_b32 v8, 7, v5
    s_mov_b32 s23, 896
    v_mul_lo_u32 v8, v8, s23
    v_add_u32 v6, v6, v8
    v_lshlrev_b32 v9, 4, v5
    v_cmp_gt_u32 vcc, 448, v5
    s_and_saveexec_b64 s[28:29], vcc
    s_cbranch_execz K1_END
    buffer_load_dword v24, v6, s[8:11], 0 offen offset:0
    buffer_load_dword v25, v6, s[8:11], 0 offen offset:8
    buffer_load_dword v26, v6, s[8:11], 0 offen offset:16
    buffer_load_dword v27, v6, s[8:11], 0 offen offset:24
    s_waitcnt vmcnt(0)
    buffer_store_dwordx4 v[24:27], v9, s[4:7], s22 offen
    s_nop 1
K1_END:
    s_endpgm
.globl main_kernel
.p2align 8
.type main_kernel,@function
main_kernel:
    s_cmp_ge_u32 s2, 256
    s_cbranch_scc1 K2_END
    s_load_dwordx2 s[4:5], s[0:1], 152
    s_load_dwordx2 s[8:9], s[0:1], 144
    s_waitcnt lgkmcnt(0)
    s_and_b32 s5, s5, 0xffff
    s_mov_b32 s6, 100564992
    s_mov_b32 s7, 0x00020000
    s_and_b32 s9, s9, 0xffff
    s_mov_b32 s10, 256
    s_mov_b32 s11, 0x00020000
    v_and_b32 v1, 63, v0
    v_lshrrev_b32 v2, 6, v0
    s_nop 1
    v_readfirstlane_b32 s20, v2
    s_mov_b32 s23, 4194304
    s_getreg_b32 s24, hwreg(HW_REG_XCC_ID)
    s_and_b32 s24, s24, 7
    s_cmp_eq_u32 s20, 0
    s_cbranch_scc0 K2_PBAR
    v_mov_b32 v3, 1
    s_lshl_b32 s25, s24, 2
    v_mov_b32 v4, s25
    s_mov_b64 s[28:29], exec
    s_mov_b64 exec, 1
    buffer_atomic_add v3, v4, s[8:11], 0 offen sc0
    s_mov_b64 exec, s[28:29]
    v_lshlrev_b32 v10, 2, v1
K2_PSPIN:
    buffer_load_dword v7, v10, s[8:11], 0 offen sc1
    s_waitcnt vmcnt(0)
    s_mov_b32 s26, 0
    s_mov_b32 s30, 0
    v_readlane_b32 s33, v7, 0
    s_add_u32 s26, s26, s33
    s_cmp_gt_u32 s24, 0
    s_cselect_b32 s33, s33, 0
    s_add_u32 s30, s30, s33
    v_readlane_b32 s33, v7, 1
    s_add_u32 s26, s26, s33
    s_cmp_gt_u32 s24, 1
    s_cselect_b32 s33, s33, 0
    s_add_u32 s30, s30, s33
    v_readlane_b32 s33, v7, 2
    s_add_u32 s26, s26, s33
    s_cmp_gt_u32 s24, 2
    s_cselect_b32 s33, s33, 0
    s_add_u32 s30, s30, s33
    v_readlane_b32 s33, v7, 3
    s_add_u32 s26, s26, s33
    s_cmp_gt_u32 s24, 3
    s_cselect_b32 s33, s33, 0
    s_add_u32 s30, s30, s33
    v_readlane_b32 s33, v7, 4
    s_add_u32 s26, s26, s33
    s_cmp_gt_u32 s24, 4
    s_cselect_b32 s33, s33, 0
    s_add_u32 s30, s30, s33
    v_readlane_b32 s33, v7, 5
    s_add_u32 s26, s26, s33
    s_cmp_gt_u32 s24, 5
    s_cselect_b32 s33, s33, 0
    s_add_u32 s30, s30, s33
    v_readlane_b32 s33, v7, 6
    s_add_u32 s26, s26, s33
    s_cmp_gt_u32 s24, 6
    s_cselect_b32 s33, s33, 0
    s_add_u32 s30, s30, s33
    v_readlane_b32 s33, v7, 7
    s_add_u32 s26, s26, s33
    s_cmp_gt_u32 s24, 7
    s_cselect_b32 s33, s33, 0
    s_add_u32 s30, s30, s33
    s_cmp_ge_u32 s26, 256
    s_cbranch_scc1 K2_PGO
    s_sub_u32 s23, s23, 64
    s_cmp_gt_i32 s23, 0
    s_cbranch_scc1 K2_PSPIN
K2_PGO:
    v_readfirstlane_b32 s27, v3
    s_nop 3
    s_add_u32 s30, s30, s27
    s_mov_b32 s31, 8
    s_mov_b32 s32, 0
    v_readlane_b32 s33, v7, 7
    s_cmp_ge_u32 s33, 30
    s_cselect_b32 s31, 7, s31
    v_readlane_b32 s33, v7, 6
    s_cmp_ge_u32 s33, 30
    s_cselect_b32 s31, 6, s31
    v_readlane_b32 s33, v7, 5
    s_cmp_ge_u32 s33, 30
    s_cselect_b32 s31, 5, s31
    v_readlane_b32 s33, v7, 4
    s_cmp_ge_u32 s33, 30
    s_cselect_b32 s31, 4, s31
    v_readlane_b32 s33, v7, 3
    s_cmp_ge_u32 s33, 30
    s_cselect_b32 s31, 3, s31
    v_readlane_b32 s33, v7, 2
    s_cmp_ge_u32 s33, 30
    s_cselect_b32 s31, 2, s31
    v_readlane_b32 s33, v7, 1
    s_cmp_ge_u32 s33, 30
    s_cselect_b32 s31, 1, s31
    v_readlane_b32 s33, v7, 0
    s_cmp_ge_u32 s33, 30
    s_cselect_b32 s31, 0, s31
    v_readlane_b32 s33, v7, 0
    s_cmp_eq_u32 s31, 0
    s_cselect_b32 s34, 30, 0
    s_sub_u32 s33, s33, s34
    s_cmp_gt_u32 s24, 0
    s_cselect_b32 s33, s33, 0
    s_add_u32 s32, s32, s33
    v_readlane_b32 s33, v7, 1
    s_cmp_eq_u32 s31, 1
    s_cselect_b32 s34, 30, 0
    s_sub_u32 s33, s33, s34
    s_cmp_gt_u32 s24, 1
    s_cselect_b32 s33, s33, 0
    s_add_u32 s32, s32, s33
    v_readlane_b32 s33, v7, 2
    s_cmp_eq_u32 s31, 2
    s_cselect_b32 s34, 30, 0
    s_sub_u32 s33, s33, s34
    s_cmp_gt_u32 s24, 2
    s_cselect_b32 s33, s33, 0
    s_add_u32 s32, s32, s33
    v_readlane_b32 s33, v7, 3
    s_cmp_eq_u32 s31, 3
    s_cselect_b32 s34, 30, 0
    s_sub_u32 s33, s33, s34
    s_cmp_gt_u32 s24, 3
    s_cselect_b32 s33, s33, 0
    s_add_u32 s32, s32, s33
    v_readlane_b32 s33, v7, 4
    s_cmp_eq_u32 s31, 4
    s_cselect_b32 s34, 30, 0
    s_sub_u32 s33, s33, s34
    s_cmp_gt_u32 s24, 4
    s_cselect_b32 s33, s33, 0
    s_add_u32 s32, s32, s33
    v_readlane_b32 s33, v7, 5
    s_cmp_eq_u32 s31, 5
    s_cselect_b32 s34, 30, 0
    s_sub_u32 s33, s33, s34
    s_cmp_gt_u32 s24, 5
    s_cselect_b32 s33, s33, 0
    s_add_u32 s32, s32, s33
    v_readlane_b32 s33, v7, 6
    s_cmp_eq_u32 s31, 6
    s_cselect_b32 s34, 30, 0
    s_sub_u32 s33, s33, s34
    s_cmp_gt_u32 s24, 6
    s_cselect_b32 s33, s33, 0
    s_add_u32 s32, s32, s33
    v_readlane_b32 s33, v7, 7
    s_cmp_eq_u32 s31, 7
    s_cselect_b32 s34, 30, 0
    s_sub_u32 s33, s33, s34
    s_cmp_gt_u32 s24, 7
    s_cselect_b32 s33, s33, 0
    s_add_u32 s32, s32, s33
    s_mov_b32 s22, 0
    s_cmp_eq_u32 s31, 8
    s_cbranch_scc1 K2_PFB
    s_cmp_eq_u32 s31, s24
    s_cbranch_scc0 K2_PW
    s_cmp_lt_u32 s27, 30
    s_cbranch_scc0 K2_PW2
    s_mov_b32 s21, s27
    s_branch K2_PWR
K2_PW2:
    s_sub_u32 s27, s27, 30
K2_PW:
    s_add_u32 s21, s32, s27
    s_add_u32 s21, s21, 32
    s_branch K2_PWR
K2_PFB:
    s_mov_b32 s22, 1
    s_add_u32 s33, s30, 2
    s_cmp_lt_u32 s30, 30
    s_cselect_b32 s21, s30, s33
K2_PWR:
    v_mov_b32 v3, s21
    v_mov_b32 v4, s22
    v_mov_b32 v5, 0
    v_mov_b32 v8, s21
    v_mov_b32 v9, s22
    ds_write_b64 v5, v[8:9]
    s_waitcnt lgkmcnt(0)
K2_PBAR:
    s_barrier
    v_mov_b32 v5, 0
    ds_read_b64 v[8:9], v5
    s_waitcnt lgkmcnt(0)
    v_readfirstlane_b32 s21, v8
    v_readfirstlane_b32 s22, v9
    s_barrier
    v_and_b32 v3, 15, v1
    v_lshrrev_b32 v4, 4, v1
    s_cmp_lt_u32 s21, 16
    s_cbranch_scc1 K2_AROLE
    s_cmp_lt_u32 s21, 30
    s_cbranch_scc1 K2_VROLE
    s_sub_u32 s21, s21, 32
    s_cmp_ge_u32 s21, 224
    s_cbranch_scc1 K2_END
    s_cmp_ge_u32 s21, 112
    s_cselect_b32 s24, 1, 0
    s_mul_i32 s25, s24, 112
    s_sub_u32 s25, s21, s25
    s_mul_i32 s26, s25, 9363
    s_lshr_b32 s26, s26, 16
    s_mul_i32 s27, s26, 7
    s_sub_u32 s27, s25, s27
    v_lshlrev_b32 v5, 4, v1
    s_cmp_eq_u32 s24, 0
    s_cselect_b32 s28, 6422528, 0
    s_mul_i32 s29, s26, 28
    s_lshl_b32 s30, s27, 2
    s_add_u32 s29, s29, s30
    s_mul_i32 s29, s29, 14336
    s_add_u32 s28, s28, s29
    buffer_load_dwordx4 a[0:3], v5, s[4:7], s28 offen
    buffer_load_dwordx4 a[4:7], v5, s[4:7], s28 offen offset:1024
    buffer_load_dwordx4 a[8:11], v5, s[4:7], s28 offen offset:2048
    buffer_load_dwordx4 a[12:15], v5, s[4:7], s28 offen offset:3072
    s_add_u32 s28, s28, 4096
    buffer_load_dwordx4 a[16:19], v5, s[4:7], s28 offen
    buffer_load_dwordx4 a[20:23], v5, s[4:7], s28 offen offset:1024
    buffer_load_dwordx4 a[24:27], v5, s[4:7], s28 offen offset:2048
    buffer_load_dwordx4 a[28:31], v5, s[4:7], s28 offen offset:3072
    s_add_u32 s28, s28, 4096
    buffer_load_dwordx4 a[32:35], v5, s[4:7], s28 offen
    buffer_load_dwordx4 a[36:39], v5, s[4:7], s28 offen offset:1024
    buffer_load_dwordx4 a[40:43], v5, s[4:7], s28 offen offset:2048
    buffer_load_dwordx4 a[44:47], v5, s[4:7], s28 offen offset:3072
    s_add_u32 s28, s28, 4096
    buffer_load_dwordx4 a[48:51], v5, s[4:7], s28 offen
    buffer_load_dwordx4 a[52:55], v5, s[4:7], s28 offen offset:1024
    s_add_u32 s28, s28, 2048
    buffer_load_dwordx4 a[56:59], v5, s[4:7], s28 offen
    buffer_load_dwordx4 a[60:63], v5, s[4:7], s28 offen offset:1024
    buffer_load_dwordx4 a[64:67], v5, s[4:7], s28 offen offset:2048
    buffer_load_dwordx4 a[68:71], v5, s[4:7], s28 offen offset:3072
    s_add_u32 s28, s28, 4096
    buffer_load_dwordx4 a[72:75], v5, s[4:7], s28 offen
    buffer_load_dwordx4 a[76:79], v5, s[4:7], s28 offen offset:1024
    buffer_load_dwordx4 a[80:83], v5, s[4:7], s28 offen offset:2048
    buffer_load_dwordx4 a[84:87], v5, s[4:7], s28 offen offset:3072
    s_add_u32 s28, s28, 4096
    buffer_load_dwordx4 a[88:91], v5, s[4:7], s28 offen
    buffer_load_dwordx4 a[92:95], v5, s[4:7], s28 offen offset:1024
    buffer_load_dwordx4 a[96:99], v5, s[4:7], s28 offen offset:2048
    buffer_load_dwordx4 a[100:103], v5, s[4:7], s28 offen offset:3072
    s_add_u32 s28, s28, 4096
    buffer_load_dwordx4 a[104:107], v5, s[4:7], s28 offen
    buffer_load_dwordx4 a[108:111], v5, s[4:7], s28 offen offset:1024
    s_add_u32 s28, s28, 2048
    buffer_load_dwordx4 a[112:115], v5, s[4:7], s28 offen
    buffer_load_dwordx4 a[116:119], v5, s[4:7], s28 offen offset:1024
    buffer_load_dwordx4 a[120:123], v5, s[4:7], s28 offen offset:2048
    buffer_load_dwordx4 a[124:127], v5, s[4:7], s28 offen offset:3072
    s_add_u32 s28, s28, 4096
    buffer_load_dwordx4 a[128:131], v5, s[4:7], s28 offen
    buffer_load_dwordx4 a[132:135], v5, s[4:7], s28 offen offset:1024
    buffer_load_dwordx4 a[136:139], v5, s[4:7], s28 offen offset:2048
    buffer_load_dwordx4 a[140:143], v5, s[4:7], s28 offen offset:3072
    s_add_u32 s28, s28, 4096
    buffer_load_dwordx4 a[144:147], v5, s[4:7], s28 offen
    buffer_load_dwordx4 a[148:151], v5, s[4:7], s28 offen offset:1024
    buffer_load_dwordx4 a[152:155], v5, s[4:7], s28 offen offset:2048
    buffer_load_dwordx4 a[156:159], v5, s[4:7], s28 offen offset:3072
    s_add_u32 s28, s28, 4096
    buffer_load_dwordx4 a[160:163], v5, s[4:7], s28 offen
    buffer_load_dwordx4 a[164:167], v5, s[4:7], s28 offen offset:1024
    s_add_u32 s28, s28, 2048
    buffer_load_dwordx4 a[168:171], v5, s[4:7], s28 offen
    buffer_load_dwordx4 a[172:175], v5, s[4:7], s28 offen offset:1024
    buffer_load_dwordx4 a[176:179], v5, s[4:7], s28 offen offset:2048
    buffer_load_dwordx4 a[180:183], v5, s[4:7], s28 offen offset:3072
    s_add_u32 s28, s28, 4096
    buffer_load_dwordx4 a[184:187], v5, s[4:7], s28 offen
    buffer_load_dwordx4 a[188:191], v5, s[4:7], s28 offen offset:1024
    buffer_load_dwordx4 a[192:195], v5, s[4:7], s28 offen offset:2048
    buffer_load_dwordx4 a[196:199], v5, s[4:7], s28 offen offset:3072
    s_add_u32 s28, s28, 4096
    buffer_load_dwordx4 a[200:203], v5, s[4:7], s28 offen
    buffer_load_dwordx4 a[204:207], v5, s[4:7], s28 offen offset:1024
    buffer_load_dwordx4 a[208:211], v5, s[4:7], s28 offen offset:2048
    buffer_load_dwordx4 a[212:215], v5, s[4:7], s28 offen offset:3072
    s_add_u32 s28, s28, 4096
    buffer_load_dwordx4 a[216:219], v5, s[4:7], s28 offen
    buffer_load_dwordx4 a[220:223], v5, s[4:7], s28 offen offset:1024
    s_add_u32 s28, s28, 2048
    s_mul_i32 s31, s20, 28672
    s_add_u32 s31, s31, 12845056
    s_add_u32 s33, s31, 0
    buffer_load_dwordx4 v[16:19], v5, s[4:7], s33 offen
    s_add_u32 s33, s31, 14336
    buffer_load_dwordx4 v[72:75], v5, s[4:7], s33 offen
    s_add_u32 s33, s31, 1024
    buffer_load_dwordx4 v[20:23], v5, s[4:7], s33 offen
    s_add_u32 s33, s31, 15360
    buffer_load_dwordx4 v[76:79], v5, s[4:7], s33 offen
    s_add_u32 s33, s31, 2048
    buffer_load_dwordx4 v[24:27], v5, s[4:7], s33 offen
    s_add_u32 s33, s31, 16384
    buffer_load_dwordx4 v[80:83], v5, s[4:7], s33 offen
    s_add_u32 s33, s31, 3072
    buffer_load_dwordx4 v[28:31], v5, s[4:7], s33 offen
    s_add_u32 s33, s31, 17408
    buffer_load_dwordx4 v[84:87], v5, s[4:7], s33 offen
    s_add_u32 s33, s31, 4096
    buffer_load_dwordx4 v[32:35], v5, s[4:7], s33 offen
    s_add_u32 s33, s31, 18432
    buffer_load_dwordx4 v[88:91], v5, s[4:7], s33 offen
    s_add_u32 s33, s31, 5120
    buffer_load_dwordx4 v[36:39], v5, s[4:7], s33 offen
    s_add_u32 s33, s31, 19456
    buffer_load_dwordx4 v[92:95], v5, s[4:7], s33 offen
    s_add_u32 s33, s31, 6144
    buffer_load_dwordx4 v[40:43], v5, s[4:7], s33 offen
    s_add_u32 s33, s31, 20480
    buffer_load_dwordx4 v[96:99], v5, s[4:7], s33 offen
    s_add_u32 s33, s31, 7168
    buffer_load_dwordx4 v[44:47], v5, s[4:7], s33 offen
    s_add_u32 s33, s31, 21504
    buffer_load_dwordx4 v[100:103], v5, s[4:7], s33 offen
    s_add_u32 s33, s31, 8192
    buffer_load_dwordx4 v[48:51], v5, s[4:7], s33 offen
    s_add_u32 s33, s31, 22528
    buffer_load_dwordx4 v[104:107], v5, s[4:7], s33 offen
    s_add_u32 s33, s31, 9216
    buffer_load_dwordx4 v[52:55], v5, s[4:7], s33 offen
    s_add_u32 s33, s31, 23552
    buffer_load_dwordx4 v[108:111], v5, s[4:7], s33 offen
    s_add_u32 s33, s31, 10240
    buffer_load_dwordx4 v[56:59], v5, s[4:7], s33 offen
    s_add_u32 s33, s31, 24576
    buffer_load_dwordx4 v[112:115], v5, s[4:7], s33 offen
    s_add_u32 s33, s31, 11264
    buffer_load_dwordx4 v[60:63], v5, s[4:7], s33 offen
    s_add_u32 s33, s31, 25600
    buffer_load_dwordx4 v[116:119], v5, s[4:7], s33 offen
    s_add_u32 s33, s31, 12288
    buffer_load_dwordx4 v[64:67], v5, s[4:7], s33 offen
    s_add_u32 s33, s31, 26624
    buffer_load_dwordx4 v[120:123], v5, s[4:7], s33 offen
    s_add_u32 s33, s31, 13312
    buffer_load_dwordx4 v[68:71], v5, s[4:7], s33 offen
    s_add_u32 s33, s31, 27648
    buffer_load_dwordx4 v[124:127], v5, s[4:7], s33 offen
    s_mov_b32 s32, s20
    v_mov_b32 v6, 0
    v_mov_b32 v7, 1
    s_cmp_eq_u32 s24, 0
    s_cbranch_scc0 K2_G1PRE
    s_mul_i32 s34, s26, 448
    s_lshl_b32 s35, s27, 6
    s_add_u32 s34, s34, s35
    s_lshl_b32 s34, s34, 6
    s_add_u32 s34, s34, 14680064
    v_mov_b32 v8, v5
    s_mov_b32 s36, 100507648
    s_waitcnt vmcnt(0)
K2_G0:
    s_add_u32 s31, s31, 114688
    v_mov_b32 v128, 0
    v_mov_b32 v129, 0
    v_mov_b32 v130, 0
    v_mov_b32 v131, 0
    v_mov_b32 v132, 0
    v_mov_b32 v133, 0
    v_mov_b32 v134, 0
    v_mov_b32 v135, 0
    v_mov_b32 v136, 0
    v_mov_b32 v137, 0
    v_mov_b32 v138, 0
    v_mov_b32 v139, 0
    v_mov_b32 v140, 0
    v_mov_b32 v141, 0
    v_mov_b32 v142, 0
    v_mov_b32 v143, 0
    v_mov_b32 v144, 0
    v_mov_b32 v145, 0
    v_mov_b32 v146, 0
    v_mov_b32 v147, 0
    v_mov_b32 v148, 0
    v_mov_b32 v149, 0
    v_mov_b32 v150, 0
    v_mov_b32 v151, 0
    v_mov_b32 v152, 0
    v_mov_b32 v153, 0
    v_mov_b32 v154, 0
    v_mov_b32 v155, 0
    v_mov_b32 v156, 0
    v_mov_b32 v157, 0
    v_mov_b32 v158, 0
    v_mov_b32 v159, 0
    s_waitcnt vmcnt(31)
    v_mfma_f32_16x16x32_bf16 v[128:131], v[16:19], a[0:3], v[128:131]
    v_mfma_f32_16x16x32_bf16 v[132:135], v[16:19], a[56:59], v[132:135]
    v_mfma_f32_16x16x32_bf16 v[136:139], v[16:19], a[112:115], v[136:139]
    v_mfma_f32_16x16x32_bf16 v[140:143], v[16:19], a[168:171], v[140:143]
    v_mfma_f32_16x16x32_bf16 v[144:147], v[72:75], a[0:3], v[144:147]
    v_mfma_f32_16x16x32_bf16 v[148:151], v[72:75], a[56:59], v[148:151]
    v_mfma_f32_16x16x32_bf16 v[152:155], v[72:75], a[112:115], v[152:155]
    v_mfma_f32_16x16x32_bf16 v[156:159], v[72:75], a[168:171], v[156:159]
    s_add_u32 s33, s31, 0
    buffer_load_dwordx4 v[16:19], v5, s[4:7], s33 offen
    s_add_u32 s33, s31, 14336
    buffer_load_dwordx4 v[72:75], v5, s[4:7], s33 offen
    s_waitcnt vmcnt(31)
    v_mfma_f32_16x16x32_bf16 v[128:131], v[20:23], a[4:7], v[128:131]
    v_mfma_f32_16x16x32_bf16 v[132:135], v[20:23], a[60:63], v[132:135]
    v_mfma_f32_16x16x32_bf16 v[136:139], v[20:23], a[116:119], v[136:139]
    v_mfma_f32_16x16x32_bf16 v[140:143], v[20:23], a[172:175], v[140:143]
    v_mfma_f32_16x16x32_bf16 v[144:147], v[76:79], a[4:7], v[144:147]
    v_mfma_f32_16x16x32_bf16 v[148:151], v[76:79], a[60:63], v[148:151]
    v_mfma_f32_16x16x32_bf16 v[152:155], v[76:79], a[116:119], v[152:155]
    v_mfma_f32_16x16x32_bf16 v[156:159], v[76:79], a[172:175], v[156:159]
    s_add_u32 s33, s31, 1024
    buffer_load_dwordx4 v[20:23], v5, s[4:7], s33 offen
    s_add_u32 s33, s31, 15360
    buffer_load_dwordx4 v[76:79], v5, s[4:7], s33 offen
    s_waitcnt vmcnt(31)
    v_mfma_f32_16x16x32_bf16 v[128:131], v[24:27], a[8:11], v[128:131]
    v_mfma_f32_16x16x32_bf16 v[132:135], v[24:27], a[64:67], v[132:135]
    v_mfma_f32_16x16x32_bf16 v[136:139], v[24:27], a[120:123], v[136:139]
    v_mfma_f32_16x16x32_bf16 v[140:143], v[24:27], a[176:179], v[140:143]
    v_mfma_f32_16x16x32_bf16 v[144:147], v[80:83], a[8:11], v[144:147]
    v_mfma_f32_16x16x32_bf16 v[148:151], v[80:83], a[64:67], v[148:151]
    v_mfma_f32_16x16x32_bf16 v[152:155], v[80:83], a[120:123], v[152:155]
    v_mfma_f32_16x16x32_bf16 v[156:159], v[80:83], a[176:179], v[156:159]
    s_add_u32 s33, s31, 2048
    buffer_load_dwordx4 v[24:27], v5, s[4:7], s33 offen
    s_add_u32 s33, s31, 16384
    buffer_load_dwordx4 v[80:83], v5, s[4:7], s33 offen
    s_waitcnt vmcnt(31)
    v_mfma_f32_16x16x32_bf16 v[128:131], v[28:31], a[12:15], v[128:131]
    v_mfma_f32_16x16x32_bf16 v[132:135], v[28:31], a[68:71], v[132:135]
    v_mfma_f32_16x16x32_bf16 v[136:139], v[28:31], a[124:127], v[136:139]
    v_mfma_f32_16x16x32_bf16 v[140:143], v[28:31], a[180:183], v[140:143]
    v_mfma_f32_16x16x32_bf16 v[144:147], v[84:87], a[12:15], v[144:147]
    v_mfma_f32_16x16x32_bf16 v[148:151], v[84:87], a[68:71], v[148:151]
    v_mfma_f32_16x16x32_bf16 v[152:155], v[84:87], a[124:127], v[152:155]
    v_mfma_f32_16x16x32_bf16 v[156:159], v[84:87], a[180:183], v[156:159]
    s_add_u32 s33, s31, 3072
    buffer_load_dwordx4 v[28:31], v5, s[4:7], s33 offen
    s_add_u32 s33, s31, 17408
    buffer_load_dwordx4 v[84:87], v5, s[4:7], s33 offen
    s_waitcnt vmcnt(31)
    v_mfma_f32_16x16x32_bf16 v[128:131], v[32:35], a[16:19], v[128:131]
    v_mfma_f32_16x16x32_bf16 v[132:135], v[32:35], a[72:75], v[132:135]
    v_mfma_f32_16x16x32_bf16 v[136:139], v[32:35], a[128:131], v[136:139]
    v_mfma_f32_16x16x32_bf16 v[140:143], v[32:35], a[184:187], v[140:143]
    v_mfma_f32_16x16x32_bf16 v[144:147], v[88:91], a[16:19], v[144:147]
    v_mfma_f32_16x16x32_bf16 v[148:151], v[88:91], a[72:75], v[148:151]
    v_mfma_f32_16x16x32_bf16 v[152:155], v[88:91], a[128:131], v[152:155]
    v_mfma_f32_16x16x32_bf16 v[156:159], v[88:91], a[184:187], v[156:159]
    s_add_u32 s33, s31, 4096
    buffer_load_dwordx4 v[32:35], v5, s[4:7], s33 offen
    s_add_u32 s33, s31, 18432
    buffer_load_dwordx4 v[88:91], v5, s[4:7], s33 offen
    s_waitcnt vmcnt(31)
    v_mfma_f32_16x16x32_bf16 v[128:131], v[36:39], a[20:23], v[128:131]
    v_mfma_f32_16x16x32_bf16 v[132:135], v[36:39], a[76:79], v[132:135]
    v_mfma_f32_16x16x32_bf16 v[136:139], v[36:39], a[132:135], v[136:139]
    v_mfma_f32_16x16x32_bf16 v[140:143], v[36:39], a[188:191], v[140:143]
    v_mfma_f32_16x16x32_bf16 v[144:147], v[92:95], a[20:23], v[144:147]
    v_mfma_f32_16x16x32_bf16 v[148:151], v[92:95], a[76:79], v[148:151]
    v_mfma_f32_16x16x32_bf16 v[152:155], v[92:95], a[132:135], v[152:155]
    v_mfma_f32_16x16x32_bf16 v[156:159], v[92:95], a[188:191], v[156:159]
    s_add_u32 s33, s31, 5120
    buffer_load_dwordx4 v[36:39], v5, s[4:7], s33 offen
    s_add_u32 s33, s31, 19456
    buffer_load_dwordx4 v[92:95], v5, s[4:7], s33 offen
    s_waitcnt vmcnt(31)
    v_mfma_f32_16x16x32_bf16 v[128:131], v[40:43], a[24:27], v[128:131]
    v_mfma_f32_16x16x32_bf16 v[132:135], v[40:43], a[80:83], v[132:135]
    v_mfma_f32_16x16x32_bf16 v[136:139], v[40:43], a[136:139], v[136:139]
    v_mfma_f32_16x16x32_bf16 v[140:143], v[40:43], a[192:195], v[140:143]
    v_mfma_f32_16x16x32_bf16 v[144:147], v[96:99], a[24:27], v[144:147]
    v_mfma_f32_16x16x32_bf16 v[148:151], v[96:99], a[80:83], v[148:151]
    v_mfma_f32_16x16x32_bf16 v[152:155], v[96:99], a[136:139], v[152:155]
    v_mfma_f32_16x16x32_bf16 v[156:159], v[96:99], a[192:195], v[156:159]
    s_add_u32 s33, s31, 6144
    buffer_load_dwordx4 v[40:43], v5, s[4:7], s33 offen
    s_add_u32 s33, s31, 20480
    buffer_load_dwordx4 v[96:99], v5, s[4:7], s33 offen
    s_waitcnt vmcnt(31)
    v_mfma_f32_16x16x32_bf16 v[128:131], v[44:47], a[28:31], v[128:131]
    v_mfma_f32_16x16x32_bf16 v[132:135], v[44:47], a[84:87], v[132:135]
    v_mfma_f32_16x16x32_bf16 v[136:139], v[44:47], a[140:143], v[136:139]
    v_mfma_f32_16x16x32_bf16 v[140:143], v[44:47], a[196:199], v[140:143]
    v_mfma_f32_16x16x32_bf16 v[144:147], v[100:103], a[28:31], v[144:147]
    v_mfma_f32_16x16x32_bf16 v[148:151], v[100:103], a[84:87], v[148:151]
    v_mfma_f32_16x16x32_bf16 v[152:155], v[100:103], a[140:143], v[152:155]
    v_mfma_f32_16x16x32_bf16 v[156:159], v[100:103], a[196:199], v[156:159]
    s_add_u32 s33, s31, 7168
    buffer_load_dwordx4 v[44:47], v5, s[4:7], s33 offen
    s_add_u32 s33, s31, 21504
    buffer_load_dwordx4 v[100:103], v5, s[4:7], s33 offen
    s_waitcnt vmcnt(31)
    v_mfma_f32_16x16x32_bf16 v[128:131], v[48:51], a[32:35], v[128:131]
    v_mfma_f32_16x16x32_bf16 v[132:135], v[48:51], a[88:91], v[132:135]
    v_mfma_f32_16x16x32_bf16 v[136:139], v[48:51], a[144:147], v[136:139]
    v_mfma_f32_16x16x32_bf16 v[140:143], v[48:51], a[200:203], v[140:143]
    v_mfma_f32_16x16x32_bf16 v[144:147], v[104:107], a[32:35], v[144:147]
    v_mfma_f32_16x16x32_bf16 v[148:151], v[104:107], a[88:91], v[148:151]
    v_mfma_f32_16x16x32_bf16 v[152:155], v[104:107], a[144:147], v[152:155]
    v_mfma_f32_16x16x32_bf16 v[156:159], v[104:107], a[200:203], v[156:159]
    s_add_u32 s33, s31, 8192
    buffer_load_dwordx4 v[48:51], v5, s[4:7], s33 offen
    s_add_u32 s33, s31, 22528
    buffer_load_dwordx4 v[104:107], v5, s[4:7], s33 offen
    s_waitcnt vmcnt(31)
    v_mfma_f32_16x16x32_bf16 v[128:131], v[52:55], a[36:39], v[128:131]
    v_mfma_f32_16x16x32_bf16 v[132:135], v[52:55], a[92:95], v[132:135]
    v_mfma_f32_16x16x32_bf16 v[136:139], v[52:55], a[148:151], v[136:139]
    v_mfma_f32_16x16x32_bf16 v[140:143], v[52:55], a[204:207], v[140:143]
    v_mfma_f32_16x16x32_bf16 v[144:147], v[108:111], a[36:39], v[144:147]
    v_mfma_f32_16x16x32_bf16 v[148:151], v[108:111], a[92:95], v[148:151]
    v_mfma_f32_16x16x32_bf16 v[152:155], v[108:111], a[148:151], v[152:155]
    v_mfma_f32_16x16x32_bf16 v[156:159], v[108:111], a[204:207], v[156:159]
    s_add_u32 s33, s31, 9216
    buffer_load_dwordx4 v[52:55], v5, s[4:7], s33 offen
    s_add_u32 s33, s31, 23552
    buffer_load_dwordx4 v[108:111], v5, s[4:7], s33 offen
    s_waitcnt vmcnt(31)
    v_mfma_f32_16x16x32_bf16 v[128:131], v[56:59], a[40:43], v[128:131]
    v_mfma_f32_16x16x32_bf16 v[132:135], v[56:59], a[96:99], v[132:135]
    v_mfma_f32_16x16x32_bf16 v[136:139], v[56:59], a[152:155], v[136:139]
    v_mfma_f32_16x16x32_bf16 v[140:143], v[56:59], a[208:211], v[140:143]
    v_mfma_f32_16x16x32_bf16 v[144:147], v[112:115], a[40:43], v[144:147]
    v_mfma_f32_16x16x32_bf16 v[148:151], v[112:115], a[96:99], v[148:151]
    v_mfma_f32_16x16x32_bf16 v[152:155], v[112:115], a[152:155], v[152:155]
    v_mfma_f32_16x16x32_bf16 v[156:159], v[112:115], a[208:211], v[156:159]
    s_add_u32 s33, s31, 10240
    buffer_load_dwordx4 v[56:59], v5, s[4:7], s33 offen
    s_add_u32 s33, s31, 24576
    buffer_load_dwordx4 v[112:115], v5, s[4:7], s33 offen
    s_waitcnt vmcnt(31)
    v_mfma_f32_16x16x32_bf16 v[128:131], v[60:63], a[44:47], v[128:131]
    v_mfma_f32_16x16x32_bf16 v[132:135], v[60:63], a[100:103], v[132:135]
    v_mfma_f32_16x16x32_bf16 v[136:139], v[60:63], a[156:159], v[136:139]
    v_mfma_f32_16x16x32_bf16 v[140:143], v[60:63], a[212:215], v[140:143]
    v_mfma_f32_16x16x32_bf16 v[144:147], v[116:119], a[44:47], v[144:147]
    v_mfma_f32_16x16x32_bf16 v[148:151], v[116:119], a[100:103], v[148:151]
    v_mfma_f32_16x16x32_bf16 v[152:155], v[116:119], a[156:159], v[152:155]
    v_mfma_f32_16x16x32_bf16 v[156:159], v[116:119], a[212:215], v[156:159]
    s_add_u32 s33, s31, 11264
    buffer_load_dwordx4 v[60:63], v5, s[4:7], s33 offen
    s_add_u32 s33, s31, 25600
    buffer_load_dwordx4 v[116:119], v5, s[4:7], s33 offen
    s_waitcnt vmcnt(31)
    v_mfma_f32_16x16x32_bf16 v[128:131], v[64:67], a[48:51], v[128:131]
    v_mfma_f32_16x16x32_bf16 v[132:135], v[64:67], a[104:107], v[132:135]
    v_mfma_f32_16x16x32_bf16 v[136:139], v[64:67], a[160:163], v[136:139]
    v_mfma_f32_16x16x32_bf16 v[140:143], v[64:67], a[216:219], v[140:143]
    v_mfma_f32_16x16x32_bf16 v[144:147], v[120:123], a[48:51], v[144:147]
    v_mfma_f32_16x16x32_bf16 v[148:151], v[120:123], a[104:107], v[148:151]
    v_mfma_f32_16x16x32_bf16 v[152:155], v[120:123], a[160:163], v[152:155]
    v_mfma_f32_16x16x32_bf16 v[156:159], v[120:123], a[216:219], v[156:159]
    s_add_u32 s33, s31, 12288
    buffer_load_dwordx4 v[64:67], v5, s[4:7], s33 offen
    s_add_u32 s33, s31, 26624
    buffer_load_dwordx4 v[120:123], v5, s[4:7], s33 offen
    s_waitcnt vmcnt(31)
    v_mfma_f32_16x16x32_bf16 v[128:131], v[68:71], a[52:55], v[128:131]
    v_mfma_f32_16x16x32_bf16 v[132:135], v[68:71], a[108:111], v[132:135]
    v_mfma_f32_16x16x32_bf16 v[136:139], v[68:71], a[164:167], v[136:139]
    v_mfma_f32_16x16x32_bf16 v[140:143], v[68:71], a[220:223], v[140:143]
    v_mfma_f32_16x16x32_bf16 v[144:147], v[124:127], a[52:55], v[144:147]
    v_mfma_f32_16x16x32_bf16 v[148:151], v[124:127], a[108:111], v[148:151]
    v_mfma_f32_16x16x32_bf16 v[152:155], v[124:127], a[164:167], v[152:155]
    v_mfma_f32_16x16x32_bf16 v[156:159], v[124:127], a[220:223], v[156:159]
    s_add_u32 s33, s31, 13312
    buffer_load_dwordx4 v[68:71], v5, s[4:7], s33 offen
    s_add_u32 s33, s31, 27648
    buffer_load_dwordx4 v[124:127], v5, s[4:7], s33 offen
    s_waitcnt vmcnt(28)
    s_cmp_lt_u32 s32, 4
    s_cbranch_scc1 GS_1
    s_sub_u32 s33, s32, 4
    s_lshl_b32 s33, s33, 7
    s_add_u32 s33, s33, s36
    s_mov_b64 exec, 1
    buffer_atomic_add v7, v6, s[4:7], s33 offen
    s_mov_b64 exec, -1
    s_branch GS_1_b
GS_1:
    buffer_load_dword v9, v6, s[4:7], 0 offen
GS_1_b:
    s_mul_i32 s33, s32, 458752
    s_add_u32 s33, s33, s34
    v_cvt_pk_bf16_f32 v160, v128, v129
    v_cvt_pk_bf16_f32 v161, v130, v131
    v_cvt_pk_bf16_f32 v162, v144, v145
    v_cvt_pk_bf16_f32 v163, v146, v147
    s_add_u32 s35, s33, 0
    buffer_store_dwordx4 v[160:163], v8, s[4:7], s35 offen sc1
    v_cvt_pk_bf16_f32 v164, v132, v133
    v_cvt_pk_bf16_f32 v165, v134, v135
    v_cvt_pk_bf16_f32 v166, v148, v149
    v_cvt_pk_bf16_f32 v167, v150, v151
    s_add_u32 s35, s33, 1024
    buffer_store_dwordx4 v[164:167], v8, s[4:7], s35 offen sc1
    v_cvt_pk_bf16_f32 v168, v136, v137
    v_cvt_pk_bf16_f32 v169, v138, v139
    v_cvt_pk_bf16_f32 v170, v152, v153
    v_cvt_pk_bf16_f32 v171, v154, v155
    s_add_u32 s35, s33, 2048
    buffer_store_dwordx4 v[168:171], v8, s[4:7], s35 offen sc1
    v_cvt_pk_bf16_f32 v172, v140, v141
    v_cvt_pk_bf16_f32 v173, v142, v143
    v_cvt_pk_bf16_f32 v174, v156, v157
    v_cvt_pk_bf16_f32 v175, v158, v159
    s_add_u32 s35, s33, 3072
    buffer_store_dwordx4 v[172:175], v8, s[4:7], s35 offen sc1
    s_add_u32 s32, s32, 4
    s_cmp_lt_u32 s32, 64
    s_cbranch_scc1 K2_G0
    s_waitcnt vmcnt(0)
    s_sub_u32 s33, s32, 4
    s_lshl_b32 s33, s33, 7
    s_add_u32 s33, s33, s36
    s_mov_b64 exec, 1
    buffer_atomic_add v7, v6, s[4:7], s33 offen
    s_mov_b64 exec, -1
    s_branch K2_GDONE
K2_G1PRE:
    s_mul_i32 s34, s26, 28
    s_lshl_b32 s35, s27, 1
    s_add_u32 s34, s34, s35
    s_lshl_b32 s34, s34, 10
    s_add_u32 s34, s34, 44040192
    v_mov_b32 v8, v5
    s_mov_b32 s36, 100515840
    s_waitcnt vmcnt(0)
K2_G1:
    s_add_u32 s31, s31, 114688
    v_mov_b32 v128, 0
    v_mov_b32 v129, 0
    v_mov_b32 v130, 0
    v_mov_b32 v131, 0
    v_mov_b32 v132, 0
    v_mov_b32 v133, 0
    v_mov_b32 v134, 0
    v_mov_b32 v135, 0
    v_mov_b32 v136, 0
    v_mov_b32 v137, 0
    v_mov_b32 v138, 0
    v_mov_b32 v139, 0
    v_mov_b32 v140, 0
    v_mov_b32 v141, 0
    v_mov_b32 v142, 0
    v_mov_b32 v143, 0
    v_mov_b32 v144, 0
    v_mov_b32 v145, 0
    v_mov_b32 v146, 0
    v_mov_b32 v147, 0
    v_mov_b32 v148, 0
    v_mov_b32 v149, 0
    v_mov_b32 v150, 0
    v_mov_b32 v151, 0
    v_mov_b32 v152, 0
    v_mov_b32 v153, 0
    v_mov_b32 v154, 0
    v_mov_b32 v155, 0
    v_mov_b32 v156, 0
    v_mov_b32 v157, 0
    v_mov_b32 v158, 0
    v_mov_b32 v159, 0
    s_waitcnt vmcnt(31)
    v_mfma_f32_16x16x32_bf16 v[128:131], a[0:3], v[16:19], v[128:131]
    v_mfma_f32_16x16x32_bf16 v[132:135], a[56:59], v[16:19], v[132:135]
    v_mfma_f32_16x16x32_bf16 v[136:139], a[112:115], v[16:19], v[136:139]
    v_mfma_f32_16x16x32_bf16 v[140:143], a[168:171], v[16:19], v[140:143]
    v_mfma_f32_16x16x32_bf16 v[144:147], a[0:3], v[72:75], v[144:147]
    v_mfma_f32_16x16x32_bf16 v[148:151], a[56:59], v[72:75], v[148:151]
    v_mfma_f32_16x16x32_bf16 v[152:155], a[112:115], v[72:75], v[152:155]
    v_mfma_f32_16x16x32_bf16 v[156:159], a[168:171], v[72:75], v[156:159]
    s_add_u32 s33, s31, 0
    buffer_load_dwordx4 v[16:19], v5, s[4:7], s33 offen
    s_add_u32 s33, s31, 14336
    buffer_load_dwordx4 v[72:75], v5, s[4:7], s33 offen
    s_waitcnt vmcnt(31)
    v_mfma_f32_16x16x32_bf16 v[128:131], a[4:7], v[20:23], v[128:131]
    v_mfma_f32_16x16x32_bf16 v[132:135], a[60:63], v[20:23], v[132:135]
    v_mfma_f32_16x16x32_bf16 v[136:139], a[116:119], v[20:23], v[136:139]
    v_mfma_f32_16x16x32_bf16 v[140:143], a[172:175], v[20:23], v[140:143]
    v_mfma_f32_16x16x32_bf16 v[144:147], a[4:7], v[76:79], v[144:147]
    v_mfma_f32_16x16x32_bf16 v[148:151], a[60:63], v[76:79], v[148:151]
    v_mfma_f32_16x16x32_bf16 v[152:155], a[116:119], v[76:79], v[152:155]
    v_mfma_f32_16x16x32_bf16 v[156:159], a[172:175], v[76:79], v[156:159]
    s_add_u32 s33, s31, 1024
    buffer_load_dwordx4 v[20:23], v5, s[4:7], s33 offen
    s_add_u32 s33, s31, 15360
    buffer_load_dwordx4 v[76:79], v5, s[4:7], s33 offen
    s_waitcnt vmcnt(31)
    v_mfma_f32_16x16x32_bf16 v[128:131], a[8:11], v[24:27], v[128:131]
    v_mfma_f32_16x16x32_bf16 v[132:135], a[64:67], v[24:27], v[132:135]
    v_mfma_f32_16x16x32_bf16 v[136:139], a[120:123], v[24:27], v[136:139]
    v_mfma_f32_16x16x32_bf16 v[140:143], a[176:179], v[24:27], v[140:143]
    v_mfma_f32_16x16x32_bf16 v[144:147], a[8:11], v[80:83], v[144:147]
    v_mfma_f32_16x16x32_bf16 v[148:151], a[64:67], v[80:83], v[148:151]
    v_mfma_f32_16x16x32_bf16 v[152:155], a[120:123], v[80:83], v[152:155]
    v_mfma_f32_16x16x32_bf16 v[156:159], a[176:179], v[80:83], v[156:159]
    s_add_u32 s33, s31, 2048
    buffer_load_dwordx4 v[24:27], v5, s[4:7], s33 offen
    s_add_u32 s33, s31, 16384
    buffer_load_dwordx4 v[80:83], v5, s[4:7], s33 offen
    s_waitcnt vmcnt(31)
    v_mfma_f32_16x16x32_bf16 v[128:131], a[12:15], v[28:31], v[128:131]
    v_mfma_f32_16x16x32_bf16 v[132:135], a[68:71], v[28:31], v[132:135]
    v_mfma_f32_16x16x32_bf16 v[136:139], a[124:127], v[28:31], v[136:139]
    v_mfma_f32_16x16x32_bf16 v[140:143], a[180:183], v[28:31], v[140:143]
    v_mfma_f32_16x16x32_bf16 v[144:147], a[12:15], v[84:87], v[144:147]
    v_mfma_f32_16x16x32_bf16 v[148:151], a[68:71], v[84:87], v[148:151]
    v_mfma_f32_16x16x32_bf16 v[152:155], a[124:127], v[84:87], v[152:155]
    v_mfma_f32_16x16x32_bf16 v[156:159], a[180:183], v[84:87], v[156:159]
    s_add_u32 s33, s31, 3072
    buffer_load_dwordx4 v[28:31], v5, s[4:7], s33 offen
    s_add_u32 s33, s31, 17408
    buffer_load_dwordx4 v[84:87], v5, s[4:7], s33 offen
    s_waitcnt vmcnt(31)
    v_mfma_f32_16x16x32_bf16 v[128:131], a[16:19], v[32:35], v[128:131]
    v_mfma_f32_16x16x32_bf16 v[132:135], a[72:75], v[32:35], v[132:135]
    v_mfma_f32_16x16x32_bf16 v[136:139], a[128:131], v[32:35], v[136:139]
    v_mfma_f32_16x16x32_bf16 v[140:143], a[184:187], v[32:35], v[140:143]
    v_mfma_f32_16x16x32_bf16 v[144:147], a[16:19], v[88:91], v[144:147]
    v_mfma_f32_16x16x32_bf16 v[148:151], a[72:75], v[88:91], v[148:151]
    v_mfma_f32_16x16x32_bf16 v[152:155], a[128:131], v[88:91], v[152:155]
    v_mfma_f32_16x16x32_bf16 v[156:159], a[184:187], v[88:91], v[156:159]
    s_add_u32 s33, s31, 4096
    buffer_load_dwordx4 v[32:35], v5, s[4:7], s33 offen
    s_add_u32 s33, s31, 18432
    buffer_load_dwordx4 v[88:91], v5, s[4:7], s33 offen
    s_waitcnt vmcnt(31)
    v_mfma_f32_16x16x32_bf16 v[128:131], a[20:23], v[36:39], v[128:131]
    v_mfma_f32_16x16x32_bf16 v[132:135], a[76:79], v[36:39], v[132:135]
    v_mfma_f32_16x16x32_bf16 v[136:139], a[132:135], v[36:39], v[136:139]
    v_mfma_f32_16x16x32_bf16 v[140:143], a[188:191], v[36:39], v[140:143]
    v_mfma_f32_16x16x32_bf16 v[144:147], a[20:23], v[92:95], v[144:147]
    v_mfma_f32_16x16x32_bf16 v[148:151], a[76:79], v[92:95], v[148:151]
    v_mfma_f32_16x16x32_bf16 v[152:155], a[132:135], v[92:95], v[152:155]
    v_mfma_f32_16x16x32_bf16 v[156:159], a[188:191], v[92:95], v[156:159]
    s_add_u32 s33, s31, 5120
    buffer_load_dwordx4 v[36:39], v5, s[4:7], s33 offen
    s_add_u32 s33, s31, 19456
    buffer_load_dwordx4 v[92:95], v5, s[4:7], s33 offen
    s_waitcnt vmcnt(31)
    v_mfma_f32_16x16x32_bf16 v[128:131], a[24:27], v[40:43], v[128:131]
    v_mfma_f32_16x16x32_bf16 v[132:135], a[80:83], v[40:43], v[132:135]
    v_mfma_f32_16x16x32_bf16 v[136:139], a[136:139], v[40:43], v[136:139]
    v_mfma_f32_16x16x32_bf16 v[140:143], a[192:195], v[40:43], v[140:143]
    v_mfma_f32_16x16x32_bf16 v[144:147], a[24:27], v[96:99], v[144:147]
    v_mfma_f32_16x16x32_bf16 v[148:151], a[80:83], v[96:99], v[148:151]
    v_mfma_f32_16x16x32_bf16 v[152:155], a[136:139], v[96:99], v[152:155]
    v_mfma_f32_16x16x32_bf16 v[156:159], a[192:195], v[96:99], v[156:159]
    s_add_u32 s33, s31, 6144
    buffer_load_dwordx4 v[40:43], v5, s[4:7], s33 offen
    s_add_u32 s33, s31, 20480
    buffer_load_dwordx4 v[96:99], v5, s[4:7], s33 offen
    s_waitcnt vmcnt(31)
    v_mfma_f32_16x16x32_bf16 v[128:131], a[28:31], v[44:47], v[128:131]
    v_mfma_f32_16x16x32_bf16 v[132:135], a[84:87], v[44:47], v[132:135]
    v_mfma_f32_16x16x32_bf16 v[136:139], a[140:143], v[44:47], v[136:139]
    v_mfma_f32_16x16x32_bf16 v[140:143], a[196:199], v[44:47], v[140:143]
    v_mfma_f32_16x16x32_bf16 v[144:147], a[28:31], v[100:103], v[144:147]
    v_mfma_f32_16x16x32_bf16 v[148:151], a[84:87], v[100:103], v[148:151]
    v_mfma_f32_16x16x32_bf16 v[152:155], a[140:143], v[100:103], v[152:155]
    v_mfma_f32_16x16x32_bf16 v[156:159], a[196:199], v[100:103], v[156:159]
    s_add_u32 s33, s31, 7168
    buffer_load_dwordx4 v[44:47], v5, s[4:7], s33 offen
    s_add_u32 s33, s31, 21504
    buffer_load_dwordx4 v[100:103], v5, s[4:7], s33 offen
    s_waitcnt vmcnt(31)
    v_mfma_f32_16x16x32_bf16 v[128:131], a[32:35], v[48:51], v[128:131]
    v_mfma_f32_16x16x32_bf16 v[132:135], a[88:91], v[48:51], v[132:135]
    v_mfma_f32_16x16x32_bf16 v[136:139], a[144:147], v[48:51], v[136:139]
    v_mfma_f32_16x16x32_bf16 v[140:143], a[200:203], v[48:51], v[140:143]
    v_mfma_f32_16x16x32_bf16 v[144:147], a[32:35], v[104:107], v[144:147]
    v_mfma_f32_16x16x32_bf16 v[148:151], a[88:91], v[104:107], v[148:151]
    v_mfma_f32_16x16x32_bf16 v[152:155], a[144:147], v[104:107], v[152:155]
    v_mfma_f32_16x16x32_bf16 v[156:159], a[200:203], v[104:107], v[156:159]
    s_add_u32 s33, s31, 8192
    buffer_load_dwordx4 v[48:51], v5, s[4:7], s33 offen
    s_add_u32 s33, s31, 22528
    buffer_load_dwordx4 v[104:107], v5, s[4:7], s33 offen
    s_waitcnt vmcnt(31)
    v_mfma_f32_16x16x32_bf16 v[128:131], a[36:39], v[52:55], v[128:131]
    v_mfma_f32_16x16x32_bf16 v[132:135], a[92:95], v[52:55], v[132:135]
    v_mfma_f32_16x16x32_bf16 v[136:139], a[148:151], v[52:55], v[136:139]
    v_mfma_f32_16x16x32_bf16 v[140:143], a[204:207], v[52:55], v[140:143]
    v_mfma_f32_16x16x32_bf16 v[144:147], a[36:39], v[108:111], v[144:147]
    v_mfma_f32_16x16x32_bf16 v[148:151], a[92:95], v[108:111], v[148:151]
    v_mfma_f32_16x16x32_bf16 v[152:155], a[148:151], v[108:111], v[152:155]
    v_mfma_f32_16x16x32_bf16 v[156:159], a[204:207], v[108:111], v[156:159]
    s_add_u32 s33, s31, 9216
    buffer_load_dwordx4 v[52:55], v5, s[4:7], s33 offen
    s_add_u32 s33, s31, 23552
    buffer_load_dwordx4 v[108:111], v5, s[4:7], s33 offen
    s_waitcnt vmcnt(31)
    v_mfma_f32_16x16x32_bf16 v[128:131], a[40:43], v[56:59], v[128:131]
    v_mfma_f32_16x16x32_bf16 v[132:135], a[96:99], v[56:59], v[132:135]
    v_mfma_f32_16x16x32_bf16 v[136:139], a[152:155], v[56:59], v[136:139]
    v_mfma_f32_16x16x32_bf16 v[140:143], a[208:211], v[56:59], v[140:143]
    v_mfma_f32_16x16x32_bf16 v[144:147], a[40:43], v[112:115], v[144:147]
    v_mfma_f32_16x16x32_bf16 v[148:151], a[96:99], v[112:115], v[148:151]
    v_mfma_f32_16x16x32_bf16 v[152:155], a[152:155], v[112:115], v[152:155]
    v_mfma_f32_16x16x32_bf16 v[156:159], a[208:211], v[112:115], v[156:159]
    s_add_u32 s33, s31, 10240
    buffer_load_dwordx4 v[56:59], v5, s[4:7], s33 offen
    s_add_u32 s33, s31, 24576
    buffer_load_dwordx4 v[112:115], v5, s[4:7], s33 offen
    s_waitcnt vmcnt(31)
    v_mfma_f32_16x16x32_bf16 v[128:131], a[44:47], v[60:63], v[128:131]
    v_mfma_f32_16x16x32_bf16 v[132:135], a[100:103], v[60:63], v[132:135]
    v_mfma_f32_16x16x32_bf16 v[136:139], a[156:159], v[60:63], v[136:139]
    v_mfma_f32_16x16x32_bf16 v[140:143], a[212:215], v[60:63], v[140:143]
    v_mfma_f32_16x16x32_bf16 v[144:147], a[44:47], v[116:119], v[144:147]
    v_mfma_f32_16x16x32_bf16 v[148:151], a[100:103], v[116:119], v[148:151]
    v_mfma_f32_16x16x32_bf16 v[152:155], a[156:159], v[116:119], v[152:155]
    v_mfma_f32_16x16x32_bf16 v[156:159], a[212:215], v[116:119], v[156:159]
    s_add_u32 s33, s31, 11264
    buffer_load_dwordx4 v[60:63], v5, s[4:7], s33 offen
    s_add_u32 s33, s31, 25600
    buffer_load_dwordx4 v[116:119], v5, s[4:7], s33 offen
    s_waitcnt vmcnt(31)
    v_mfma_f32_16x16x32_bf16 v[128:131], a[48:51], v[64:67], v[128:131]
    v_mfma_f32_16x16x32_bf16 v[132:135], a[104:107], v[64:67], v[132:135]
    v_mfma_f32_16x16x32_bf16 v[136:139], a[160:163], v[64:67], v[136:139]
    v_mfma_f32_16x16x32_bf16 v[140:143], a[216:219], v[64:67], v[140:143]
    v_mfma_f32_16x16x32_bf16 v[144:147], a[48:51], v[120:123], v[144:147]
    v_mfma_f32_16x16x32_bf16 v[148:151], a[104:107], v[120:123], v[148:151]
    v_mfma_f32_16x16x32_bf16 v[152:155], a[160:163], v[120:123], v[152:155]
    v_mfma_f32_16x16x32_bf16 v[156:159], a[216:219], v[120:123], v[156:159]
    s_add_u32 s33, s31, 12288
    buffer_load_dwordx4 v[64:67], v5, s[4:7], s33 offen
    s_add_u32 s33, s31, 26624
    buffer_load_dwordx4 v[120:123], v5, s[4:7], s33 offen
    s_waitcnt vmcnt(31)
    v_mfma_f32_16x16x32_bf16 v[128:131], a[52:55], v[68:71], v[128:131]
    v_mfma_f32_16x16x32_bf16 v[132:135], a[108:111], v[68:71], v[132:135]
    v_mfma_f32_16x16x32_bf16 v[136:139], a[164:167], v[68:71], v[136:139]
    v_mfma_f32_16x16x32_bf16 v[140:143], a[220:223], v[68:71], v[140:143]
    v_mfma_f32_16x16x32_bf16 v[144:147], a[52:55], v[124:127], v[144:147]
    v_mfma_f32_16x16x32_bf16 v[148:151], a[108:111], v[124:127], v[148:151]
    v_mfma_f32_16x16x32_bf16 v[152:155], a[164:167], v[124:127], v[152:155]
    v_mfma_f32_16x16x32_bf16 v[156:159], a[220:223], v[124:127], v[156:159]
    s_add_u32 s33, s31, 13312
    buffer_load_dwordx4 v[68:71], v5, s[4:7], s33 offen
    s_add_u32 s33, s31, 27648
    buffer_load_dwordx4 v[124:127], v5, s[4:7], s33 offen
    s_waitcnt vmcnt(28)
    s_cmp_lt_u32 s32, 4
    s_cbranch_scc1 GS_2
    s_sub_u32 s33, s32, 4
    s_lshl_b32 s33, s33, 7
    s_add_u32 s33, s33, s36
    s_mov_b64 exec, 1
    buffer_atomic_add v7, v6, s[4:7], s33 offen
    s_mov_b64 exec, -1
    s_branch GS_2_b
GS_2:
    buffer_load_dword v9, v6, s[4:7], 0 offen
GS_2_b:
    s_mul_i32 s33, s32, 458752
    s_add_u32 s33, s33, s34
    v_cvt_pk_bf16_f32 v160, v128, v129
    v_cvt_pk_bf16_f32 v161, v130, v131
    v_cvt_pk_bf16_f32 v162, v132, v133
    v_cvt_pk_bf16_f32 v163, v134, v135
    s_add_u32 s35, s33, 0
    buffer_store_dwordx4 v[160:163], v8, s[4:7], s35 offen sc1
    v_cvt_pk_bf16_f32 v164, v136, v137
    v_cvt_pk_bf16_f32 v165, v138, v139
    v_cvt_pk_bf16_f32 v166, v140, v141
    v_cvt_pk_bf16_f32 v167, v142, v143
    s_add_u32 s35, s33, 1024
    buffer_store_dwordx4 v[164:167], v8, s[4:7], s35 offen sc1
    v_cvt_pk_bf16_f32 v168, v144, v145
    v_cvt_pk_bf16_f32 v169, v146, v147
    v_cvt_pk_bf16_f32 v170, v148, v149
    v_cvt_pk_bf16_f32 v171, v150, v151
    s_add_u32 s35, s33, 14336
    buffer_store_dwordx4 v[168:171], v8, s[4:7], s35 offen sc1
    v_cvt_pk_bf16_f32 v172, v152, v153
    v_cvt_pk_bf16_f32 v173, v154, v155
    v_cvt_pk_bf16_f32 v174, v156, v157
    v_cvt_pk_bf16_f32 v175, v158, v159
    s_add_u32 s35, s33, 15360
    buffer_store_dwordx4 v[172:175], v8, s[4:7], s35 offen sc1
    s_add_u32 s32, s32, 4
    s_cmp_lt_u32 s32, 64
    s_cbranch_scc1 K2_G1
    s_waitcnt vmcnt(0)
    s_sub_u32 s33, s32, 4
    s_lshl_b32 s33, s33, 7
    s_add_u32 s33, s33, s36
    s_mov_b64 exec, 1
    buffer_atomic_add v7, v6, s[4:7], s33 offen
    s_mov_b64 exec, -1
K2_GDONE:
    v_mov_b32 v15, 0
    v_mov_b32 v19, 1
    s_cmp_ge_u32 s21, 128
    s_cbranch_scc1 W_F
    s_lshr_b32 s24, s21, 1
    s_and_b32 s25, s21, 1
    s_load_dwordx2 s[56:57], s[0:1], 0
    s_waitcnt lgkmcnt(0)
    s_and_b32 s57, s57, 0xffff
    s_mov_b32 s58, 1835008
    s_mov_b32 s59, 0x00020000
    s_load_dwordx2 s[52:53], s[0:1], 128
    s_waitcnt lgkmcnt(0)
    s_and_b32 s53, s53, 0xffff
    s_mov_b32 s54, 896
    s_mov_b32 s55, 0x00020000
    v_lshrrev_b32 v6, 3, v0
    v_and_b32 v7, 7, v0
    v_mul_u32_u24 v8, 112, v7
    v_mul_u32_u24 v9, 896, v6
    v_add_u32 v9, v9, v8
    s_mul_i32 s26, s24, 28672
    buffer_load_dwordx4 v[20:23], v9, s[56:59], s26 offen offset:0
    buffer_load_dwordx4 v[48:51], v8, s[52:55], 0 offen offset:0
    buffer_load_dwordx4 v[24:27], v9, s[56:59], s26 offen offset:16
    buffer_load_dwordx4 v[52:55], v8, s[52:55], 0 offen offset:16
    buffer_load_dwordx4 v[28:31], v9, s[56:59], s26 offen offset:32
    buffer_load_dwordx4 v[56:59], v8, s[52:55], 0 offen offset:32
    buffer_load_dwordx4 v[32:35], v9, s[56:59], s26 offen offset:48
    buffer_load_dwordx4 v[60:63], v8, s[52:55], 0 offen offset:48
    buffer_load_dwordx4 v[36:39], v9, s[56:59], s26 offen offset:64
    buffer_load_dwordx4 v[64:67], v8, s[52:55], 0 offen offset:64
    buffer_load_dwordx4 v[40:43], v9, s[56:59], s26 offen offset:80
    buffer_load_dwordx4 v[68:71], v8, s[52:55], 0 offen offset:80
    buffer_load_dwordx4 v[44:47], v9, s[56:59], s26 offen offset:96
    buffer_load_dwordx4 v[72:75], v8, s[52:55], 0 offen offset:96
    v_mov_b32 v9, 0
    s_waitcnt vmcnt(0)
    v_lshlrev_b32 v10, 16, v20
    v_and_b32 v11, 0xffff0000, v20
    v_lshlrev_b32 v12, 16, v48
    v_and_b32 v13, 0xffff0000, v48
    v_mul_f32 v10, v10, v12
    v_mul_f32 v11, v11, v13
    v_cvt_pk_bf16_f32 v10, v10, v11
    v_and_b32 v11, 0xffff0000, v10
    v_lshlrev_b32 v10, 16, v10
    v_add_f32 v9, v9, v10
    v_add_f32 v9, v9, v11
    v_lshlrev_b32 v10, 16, v21
    v_and_b32 v11, 0xffff0000, v21
    v_lshlrev_b32 v12, 16, v49
    v_and_b32 v13, 0xffff0000, v49
    v_mul_f32 v10, v10, v12
    v_mul_f32 v11, v11, v13
    v_cvt_pk_bf16_f32 v10, v10, v11
    v_and_b32 v11, 0xffff0000, v10
    v_lshlrev_b32 v10, 16, v10
    v_add_f32 v9, v9, v10
    v_add_f32 v9, v9, v11
    v_lshlrev_b32 v10, 16, v22
    v_and_b32 v11, 0xffff0000, v22
    v_lshlrev_b32 v12, 16, v50
    v_and_b32 v13, 0xffff0000, v50
    v_mul_f32 v10, v10, v12
    v_mul_f32 v11, v11, v13
    v_cvt_pk_bf16_f32 v10, v10, v11
    v_and_b32 v11, 0xffff0000, v10
    v_lshlrev_b32 v10, 16, v10
    v_add_f32 v9, v9, v10
    v_add_f32 v9, v9, v11
    v_lshlrev_b32 v10, 16, v23
    v_and_b32 v11, 0xffff0000, v23
    v_lshlrev_b32 v12, 16, v51
    v_and_b32 v13, 0xffff0000, v51
    v_mul_f32 v10, v10, v12
    v_mul_f32 v11, v11, v13
    v_cvt_pk_bf16_f32 v10, v10, v11
    v_and_b32 v11, 0xffff0000, v10
    v_lshlrev_b32 v10, 16, v10
    v_add_f32 v9, v9, v10
    v_add_f32 v9, v9, v11
    v_lshlrev_b32 v10, 16, v24
    v_and_b32 v11, 0xffff0000, v24
    v_lshlrev_b32 v12, 16, v52
    v_and_b32 v13, 0xffff0000, v52
    v_mul_f32 v10, v10, v12
    v_mul_f32 v11, v11, v13
    v_cvt_pk_bf16_f32 v10, v10, v11
    v_and_b32 v11, 0xffff0000, v10
    v_lshlrev_b32 v10, 16, v10
    v_add_f32 v9, v9, v10
    v_add_f32 v9, v9, v11
    v_lshlrev_b32 v10, 16, v25
    v_and_b32 v11, 0xffff0000, v25
    v_lshlrev_b32 v12, 16, v53
    v_and_b32 v13, 0xffff0000, v53
    v_mul_f32 v10, v10, v12
    v_mul_f32 v11, v11, v13
    v_cvt_pk_bf16_f32 v10, v10, v11
    v_and_b32 v11, 0xffff0000, v10
    v_lshlrev_b32 v10, 16, v10
    v_add_f32 v9, v9, v10
    v_add_f32 v9, v9, v11
    v_lshlrev_b32 v10, 16, v26
    v_and_b32 v11, 0xffff0000, v26
    v_lshlrev_b32 v12, 16, v54
    v_and_b32 v13, 0xffff0000, v54
    v_mul_f32 v10, v10, v12
    v_mul_f32 v11, v11, v13
    v_cvt_pk_bf16_f32 v10, v10, v11
    v_and_b32 v11, 0xffff0000, v10
    v_lshlrev_b32 v10, 16, v10
    v_add_f32 v9, v9, v10
    v_add_f32 v9, v9, v11
    v_lshlrev_b32 v10, 16, v27
    v_and_b32 v11, 0xffff0000, v27
    v_lshlrev_b32 v12, 16, v55
    v_and_b32 v13, 0xffff0000, v55
    v_mul_f32 v10, v10, v12
    v_mul_f32 v11, v11, v13
    v_cvt_pk_bf16_f32 v10, v10, v11
    v_and_b32 v11, 0xffff0000, v10
    v_lshlrev_b32 v10, 16, v10
    v_add_f32 v9, v9, v10
    v_add_f32 v9, v9, v11
    v_lshlrev_b32 v10, 16, v28
    v_and_b32 v11, 0xffff0000, v28
    v_lshlrev_b32 v12, 16, v56
    v_and_b32 v13, 0xffff0000, v56
    v_mul_f32 v10, v10, v12
    v_mul_f32 v11, v11, v13
    v_cvt_pk_bf16_f32 v10, v10, v11
    v_and_b32 v11, 0xffff0000, v10
    v_lshlrev_b32 v10, 16, v10
    v_add_f32 v9, v9, v10
    v_add_f32 v9, v9, v11
    v_lshlrev_b32 v10, 16, v29
    v_and_b32 v11, 0xffff0000, v29
    v_lshlrev_b32 v12, 16, v57
    v_and_b32 v13, 0xffff0000, v57
    v_mul_f32 v10, v10, v12
    v_mul_f32 v11, v11, v13
    v_cvt_pk_bf16_f32 v10, v10, v11
    v_and_b32 v11, 0xffff0000, v10
    v_lshlrev_b32 v10, 16, v10
    v_add_f32 v9, v9, v10
    v_add_f32 v9, v9, v11
    v_lshlrev_b32 v10, 16, v30
    v_and_b32 v11, 0xffff0000, v30
    v_lshlrev_b32 v12, 16, v58
    v_and_b32 v13, 0xffff0000, v58
    v_mul_f32 v10, v10, v12
    v_mul_f32 v11, v11, v13
    v_cvt_pk_bf16_f32 v10, v10, v11
    v_and_b32 v11, 0xffff0000, v10
    v_lshlrev_b32 v10, 16, v10
    v_add_f32 v9, v9, v10
    v_add_f32 v9, v9, v11
    v_lshlrev_b32 v10, 16, v31
    v_and_b32 v11, 0xffff0000, v31
    v_lshlrev_b32 v12, 16, v59
    v_and_b32 v13, 0xffff0000, v59
    v_mul_f32 v10, v10, v12
    v_mul_f32 v11, v11, v13
    v_cvt_pk_bf16_f32 v10, v10, v11
    v_and_b32 v11, 0xffff0000, v10
    v_lshlrev_b32 v10, 16, v10
    v_add_f32 v9, v9, v10
    v_add_f32 v9, v9, v11
    v_lshlrev_b32 v10, 16, v32
    v_and_b32 v11, 0xffff0000, v32
    v_lshlrev_b32 v12, 16, v60
    v_and_b32 v13, 0xffff0000, v60
    v_mul_f32 v10, v10, v12
    v_mul_f32 v11, v11, v13
    v_cvt_pk_bf16_f32 v10, v10, v11
    v_and_b32 v11, 0xffff0000, v10
    v_lshlrev_b32 v10, 16, v10
    v_add_f32 v9, v9, v10
    v_add_f32 v9, v9, v11
    v_lshlrev_b32 v10, 16, v33
    v_and_b32 v11, 0xffff0000, v33
    v_lshlrev_b32 v12, 16, v61
    v_and_b32 v13, 0xffff0000, v61
    v_mul_f32 v10, v10, v12
    v_mul_f32 v11, v11, v13
    v_cvt_pk_bf16_f32 v10, v10, v11
    v_and_b32 v11, 0xffff0000, v10
    v_lshlrev_b32 v10, 16, v10
    v_add_f32 v9, v9, v10
    v_add_f32 v9, v9, v11
    v_lshlrev_b32 v10, 16, v34
    v_and_b32 v11, 0xffff0000, v34
    v_lshlrev_b32 v12, 16, v62
    v_and_b32 v13, 0xffff0000, v62
    v_mul_f32 v10, v10, v12
    v_mul_f32 v11, v11, v13
    v_cvt_pk_bf16_f32 v10, v10, v11
    v_and_b32 v11, 0xffff0000, v10
    v_lshlrev_b32 v10, 16, v10
    v_add_f32 v9, v9, v10
    v_add_f32 v9, v9, v11
    v_lshlrev_b32 v10, 16, v35
    v_and_b32 v11, 0xffff0000, v35
    v_lshlrev_b32 v12, 16, v63
    v_and_b32 v13, 0xffff0000, v63
    v_mul_f32 v10, v10, v12
    v_mul_f32 v11, v11, v13
    v_cvt_pk_bf16_f32 v10, v10, v11
    v_and_b32 v11, 0xffff0000, v10
    v_lshlrev_b32 v10, 16, v10
    v_add_f32 v9, v9, v10
    v_add_f32 v9, v9, v11
    v_lshlrev_b32 v10, 16, v36
    v_and_b32 v11, 0xffff0000, v36
    v_lshlrev_b32 v12, 16, v64
    v_and_b32 v13, 0xffff0000, v64
    v_mul_f32 v10, v10, v12
    v_mul_f32 v11, v11, v13
    v_cvt_pk_bf16_f32 v10, v10, v11
    v_and_b32 v11, 0xffff0000, v10
    v_lshlrev_b32 v10, 16, v10
    v_add_f32 v9, v9, v10
    v_add_f32 v9, v9, v11
    v_lshlrev_b32 v10, 16, v37
    v_and_b32 v11, 0xffff0000, v37
    v_lshlrev_b32 v12, 16, v65
    v_and_b32 v13, 0xffff0000, v65
    v_mul_f32 v10, v10, v12
    v_mul_f32 v11, v11, v13
    v_cvt_pk_bf16_f32 v10, v10, v11
    v_and_b32 v11, 0xffff0000, v10
    v_lshlrev_b32 v10, 16, v10
    v_add_f32 v9, v9, v10
    v_add_f32 v9, v9, v11
    v_lshlrev_b32 v10, 16, v38
    v_and_b32 v11, 0xffff0000, v38
    v_lshlrev_b32 v12, 16, v66
    v_and_b32 v13, 0xffff0000, v66
    v_mul_f32 v10, v10, v12
    v_mul_f32 v11, v11, v13
    v_cvt_pk_bf16_f32 v10, v10, v11
    v_and_b32 v11, 0xffff0000, v10
    v_lshlrev_b32 v10, 16, v10
    v_add_f32 v9, v9, v10
    v_add_f32 v9, v9, v11
    v_lshlrev_b32 v10, 16, v39
    v_and_b32 v11, 0xffff0000, v39
    v_lshlrev_b32 v12, 16, v67
    v_and_b32 v13, 0xffff0000, v67
    v_mul_f32 v10, v10, v12
    v_mul_f32 v11, v11, v13
    v_cvt_pk_bf16_f32 v10, v10, v11
    v_and_b32 v11, 0xffff0000, v10
    v_lshlrev_b32 v10, 16, v10
    v_add_f32 v9, v9, v10
    v_add_f32 v9, v9, v11
    v_lshlrev_b32 v10, 16, v40
    v_and_b32 v11, 0xffff0000, v40
    v_lshlrev_b32 v12, 16, v68
    v_and_b32 v13, 0xffff0000, v68
    v_mul_f32 v10, v10, v12
    v_mul_f32 v11, v11, v13
    v_cvt_pk_bf16_f32 v10, v10, v11
    v_and_b32 v11, 0xffff0000, v10
    v_lshlrev_b32 v10, 16, v10
    v_add_f32 v9, v9, v10
    v_add_f32 v9, v9, v11
    v_lshlrev_b32 v10, 16, v41
    v_and_b32 v11, 0xffff0000, v41
    v_lshlrev_b32 v12, 16, v69
    v_and_b32 v13, 0xffff0000, v69
    v_mul_f32 v10, v10, v12
    v_mul_f32 v11, v11, v13
    v_cvt_pk_bf16_f32 v10, v10, v11
    v_and_b32 v11, 0xffff0000, v10
    v_lshlrev_b32 v10, 16, v10
    v_add_f32 v9, v9, v10
    v_add_f32 v9, v9, v11
    v_lshlrev_b32 v10, 16, v42
    v_and_b32 v11, 0xffff0000, v42
    v_lshlrev_b32 v12, 16, v70
    v_and_b32 v13, 0xffff0000, v70
    v_mul_f32 v10, v10, v12
    v_mul_f32 v11, v11, v13
    v_cvt_pk_bf16_f32 v10, v10, v11
    v_and_b32 v11, 0xffff0000, v10
    v_lshlrev_b32 v10, 16, v10
    v_add_f32 v9, v9, v10
    v_add_f32 v9, v9, v11
    v_lshlrev_b32 v10, 16, v43
    v_and_b32 v11, 0xffff0000, v43
    v_lshlrev_b32 v12, 16, v71
    v_and_b32 v13, 0xffff0000, v71
    v_mul_f32 v10, v10, v12
    v_mul_f32 v11, v11, v13
    v_cvt_pk_bf16_f32 v10, v10, v11
    v_and_b32 v11, 0xffff0000, v10
    v_lshlrev_b32 v10, 16, v10
    v_add_f32 v9, v9, v10
    v_add_f32 v9, v9, v11
    v_lshlrev_b32 v10, 16, v44
    v_and_b32 v11, 0xffff0000, v44
    v_lshlrev_b32 v12, 16, v72
    v_and_b32 v13, 0xffff0000, v72
    v_mul_f32 v10, v10, v12
    v_mul_f32 v11, v11, v13
    v_cvt_pk_bf16_f32 v10, v10, v11
    v_and_b32 v11, 0xffff0000, v10
    v_lshlrev_b32 v10, 16, v10
    v_add_f32 v9, v9, v10
    v_add_f32 v9, v9, v11
    v_lshlrev_b32 v10, 16, v45
    v_and_b32 v11, 0xffff0000, v45
    v_lshlrev_b32 v12, 16, v73
    v_and_b32 v13, 0xffff0000, v73
    v_mul_f32 v10, v10, v12
    v_mul_f32 v11, v11, v13
    v_cvt_pk_bf16_f32 v10, v10, v11
    v_and_b32 v11, 0xffff0000, v10
    v_lshlrev_b32 v10, 16, v10
    v_add_f32 v9, v9, v10
    v_add_f32 v9, v9, v11
    v_lshlrev_b32 v10, 16, v46
    v_and_b32 v11, 0xffff0000, v46
    v_lshlrev_b32 v12, 16, v74
    v_and_b32 v13, 0xffff0000, v74
    v_mul_f32 v10, v10, v12
    v_mul_f32 v11, v11, v13
    v_cvt_pk_bf16_f32 v10, v10, v11
    v_and_b32 v11, 0xffff0000, v10
    v_lshlrev_b32 v10, 16, v10
    v_add_f32 v9, v9, v10
    v_add_f32 v9, v9, v11
    v_lshlrev_b32 v10, 16, v47
    v_and_b32 v11, 0xffff0000, v47
    v_lshlrev_b32 v12, 16, v75
    v_and_b32 v13, 0xffff0000, v75
    v_mul_f32 v10, v10, v12
    v_mul_f32 v11, v11, v13
    v_cvt_pk_bf16_f32 v10, v10, v11
    v_and_b32 v11, 0xffff0000, v10
    v_lshlrev_b32 v10, 16, v10
    v_add_f32 v9, v9, v10
    v_add_f32 v9, v9, v11
    s_nop 1
    v_add_f32_dpp v9, v9, v9 quad_perm:[1,0,3,2] row_mask:0xf bank_mask:0xf
    s_nop 1
    v_add_f32_dpp v9, v9, v9 quad_perm:[2,3,0,1] row_mask:0xf bank_mask:0xf
    s_nop 1
    v_add_f32_dpp v9, v9, v9 row_half_mirror row_mask:0xf bank_mask:0xf
    v_cvt_pk_bf16_f32 v9, v9, v9
    v_lshlrev_b32 v9, 16, v9
    v_mul_f32 v9, 0xbfb8aa3b, v9
    v_exp_f32 v9, v9
    s_nop 0
    v_add_f32 v9, 1.0, v9
    v_rcp_f32 v9, v9
    s_nop 0
    v_cvt_pk_bf16_f32 v9, v9, v9
    v_lshlrev_b32 v9, 16, v9
    v_sub_f32 v10, 1.0, v9
    v_cvt_pk_bf16_f32 v10, v10, v10
    v_lshlrev_b32 v10, 16, v10
    v_lshlrev_b32 v11, 2, v6
    ds_write_b32 v11, v9 offset:59392
    s_lshl_b32 s26, s24, 7
    s_add_u32 s26, s26, 100499456
    buffer_store_dword v10, v11, s[4:7], s26 offen sc1
    s_cmp_lt_u32 s20, 2
    s_cbranch_scc1 S5_BRE
    s_load_dwordx2 s[40:41], s[0:1], 32
    s_waitcnt lgkmcnt(0)
    s_and_b32 s41, s41, 0xffff
    s_mov_b32 s42, 401408
    s_mov_b32 s43, 0x00020000
    s_branch S5_BOK
S5_BRE:
    s_load_dwordx2 s[40:41], s[0:1], 24
    s_waitcnt lgkmcnt(0)
    s_and_b32 s41, s41, 0xffff
    s_mov_b32 s42, 401408
    s_mov_b32 s43, 0x00020000
S5_BOK:
    s_load_dwordx2 s[44:45], s[0:1], 40
    s_waitcnt lgkmcnt(0)
    s_and_b32 s45, s45, 0xffff
    s_mov_b32 s46, 401408
    s_mov_b32 s47, 0x00020000
    s_load_dwordx2 s[48:49], s[0:1], 48
    s_waitcnt lgkmcnt(0)
    s_and_b32 s49, s49, 0xffff
    s_mov_b32 s50, 401408
    s_mov_b32 s51, 0x00020000
    v_mul_u32_u24 v6, 896, v3
    v_lshl_add_u32 v6, v4, 4, v6
    s_mul_i32 s26, s25, 224
    s_and_b32 s27, s20, 1
    s_mul_i32 s27, s27, 112
    s_add_u32 s26, s26, s27
    s_mul_i32 s26, s26, 896
    s_mul_i32 s27, s20, 100352
    s_mul_i32 s36, s25, 448
    s_add_u32 s27, s27, s36
    s_add_u32 s28, s26, 0
    s_add_u32 s80, s27, 0
    s_add_u32 s29, s26, 14336
    s_add_u32 s81, s27, 14336
    s_add_u32 s30, s26, 28672
    s_add_u32 s82, s27, 28672
    s_add_u32 s31, s26, 43008
    s_add_u32 s83, s27, 43008
    s_add_u32 s32, s26, 57344
    s_add_u32 s84, s27, 57344
    s_add_u32 s33, s26, 71680
    s_add_u32 s85, s27, 71680
    s_add_u32 s34, s26, 86016
    s_add_u32 s86, s27, 86016
    s_mul_i32 s35, s24, 28672
    s_add_u32 s35, s35, 12845056
    s_waitcnt vmcnt(0)
    buffer_load_dwordx4 v[20:23], v5, s[4:7], s35 offen offset:0
    buffer_load_dwordx4 v[24:27], v5, s[4:7], s35 offen offset:1024
    buffer_load_dwordx4 v[28:31], v5, s[4:7], s35 offen offset:2048
    buffer_load_dwordx4 v[32:35], v5, s[4:7], s35 offen offset:3072
    s_add_u32 s35, s35, 4096
    buffer_load_dwordx4 v[36:39], v5, s[4:7], s35 offen offset:0
    buffer_load_dwordx4 v[40:43], v5, s[4:7], s35 offen offset:1024
    buffer_load_dwordx4 v[44:47], v5, s[4:7], s35 offen offset:2048
    buffer_load_dwordx4 v[48:51], v5, s[4:7], s35 offen offset:3072
    s_add_u32 s35, s35, 4096
    buffer_load_dwordx4 v[52:55], v5, s[4:7], s35 offen offset:0
    buffer_load_dwordx4 v[56:59], v5, s[4:7], s35 offen offset:1024
    buffer_load_dwordx4 v[60:63], v5, s[4:7], s35 offen offset:2048
    buffer_load_dwordx4 v[64:67], v5, s[4:7], s35 offen offset:3072
    s_add_u32 s35, s35, 4096
    buffer_load_dwordx4 v[68:71], v5, s[4:7], s35 offen offset:0
    buffer_load_dwordx4 v[72:75], v5, s[4:7], s35 offen offset:1024
    buffer_load_dwordx4 v[76:79], v5, s[4:7], s35 offen offset:2048
    buffer_load_dwordx4 v[80:83], v5, s[4:7], s35 offen offset:3072
    s_add_u32 s35, s35, 4096
    buffer_load_dwordx4 v[84:87], v5, s[4:7], s35 offen offset:0
    buffer_load_dwordx4 v[88:91], v5, s[4:7], s35 offen offset:1024
    buffer_load_dwordx4 v[92:95], v5, s[4:7], s35 offen offset:2048
    buffer_load_dwordx4 v[96:99], v5, s[4:7], s35 offen offset:3072
    s_add_u32 s35, s35, 4096
    buffer_load_dwordx4 v[100:103], v5, s[4:7], s35 offen offset:0
    buffer_load_dwordx4 v[104:107], v5, s[4:7], s35 offen offset:1024
    buffer_load_dwordx4 v[108:111], v5, s[4:7], s35 offen offset:2048
    buffer_load_dwordx4 v[112:115], v5, s[4:7], s35 offen offset:3072
    s_add_u32 s35, s35, 4096
    buffer_load_dwordx4 v[116:119], v5, s[4:7], s35 offen offset:0
    buffer_load_dwordx4 v[120:123], v5, s[4:7], s35 offen offset:1024
    buffer_load_dwordx4 v[124:127], v5, s[4:7], s35 offen offset:2048
    buffer_load_dwordx4 v[128:131], v5, s[4:7], s35 offen offset:3072
    buffer_load_dwordx4 a[0:3], v6, s[40:43], s28 offen offset:0
    buffer_load_dwordx4 a[4:7], v6, s[40:43], s29 offen offset:0
    buffer_load_dwordx4 a[8:11], v6, s[40:43], s30 offen offset:0
    buffer_load_dwordx4 a[12:15], v6, s[40:43], s31 offen offset:0
    buffer_load_dwordx4 a[16:19], v6, s[40:43], s32 offen offset:0
    buffer_load_dwordx4 a[20:23], v6, s[40:43], s33 offen offset:0
    buffer_load_dwordx4 a[24:27], v6, s[40:43], s34 offen offset:0
    buffer_load_dwordx4 a[28:31], v6, s[40:43], s28 offen offset:64
    buffer_load_dwordx4 a[32:35], v6, s[40:43], s29 offen offset:64
    buffer_load_dwordx4 a[36:39], v6, s[40:43], s30 offen offset:64
    buffer_load_dwordx4 a[40:43], v6, s[40:43], s31 offen offset:64
    buffer_load_dwordx4 a[44:47], v6, s[40:43], s32 offen offset:64
    buffer_load_dwordx4 a[48:51], v6, s[40:43], s33 offen offset:64
    buffer_load_dwordx4 a[52:55], v6, s[40:43], s34 offen offset:64
    buffer_load_dwordx4 a[56:59], v6, s[40:43], s28 offen offset:128
    buffer_load_dwordx4 a[60:63], v6, s[40:43], s29 offen offset:128
    buffer_load_dwordx4 a[64:67], v6, s[40:43], s30 offen offset:128
    buffer_load_dwordx4 a[68:71], v6, s[40:43], s31 offen offset:128
    buffer_load_dwordx4 a[72:75], v6, s[40:43], s32 offen offset:128
    buffer_load_dwordx4 a[76:79], v6, s[40:43], s33 offen offset:128
    buffer_load_dwordx4 a[80:83], v6, s[40:43], s34 offen offset:128
    buffer_load_dwordx4 a[84:87], v6, s[40:43], s28 offen offset:192
    buffer_load_dwordx4 a[88:91], v6, s[40:43], s29 offen offset:192
    buffer_load_dwordx4 a[92:95], v6, s[40:43], s30 offen offset:192
    buffer_load_dwordx4 a[96:99], v6, s[40:43], s31 offen offset:192
    buffer_load_dwordx4 a[100:103], v6, s[40:43], s32 offen offset:192
    buffer_load_dwordx4 a[104:107], v6, s[40:43], s33 offen offset:192
    buffer_load_dwordx4 a[108:111], v6, s[40:43], s34 offen offset:192
    buffer_load_dwordx4 a[112:115], v6, s[40:43], s28 offen offset:256
    buffer_load_dwordx4 a[116:119], v6, s[40:43], s29 offen offset:256
    buffer_load_dwordx4 a[120:123], v6, s[40:43], s30 offen offset:256
    buffer_load_dwordx4 a[124:127], v6, s[40:43], s31 offen offset:256
    buffer_load_dwordx4 a[128:131], v6, s[40:43], s32 offen offset:256
    buffer_load_dwordx4 a[132:135], v6, s[40:43], s33 offen offset:256
    buffer_load_dwordx4 a[136:139], v6, s[40:43], s34 offen offset:256
    buffer_load_dwordx4 a[140:143], v6, s[40:43], s28 offen offset:320
    buffer_load_dwordx4 a[144:147], v6, s[40:43], s29 offen offset:320
    buffer_load_dwordx4 a[148:151], v6, s[40:43], s30 offen offset:320
    buffer_load_dwordx4 a[152:155], v6, s[40:43], s31 offen offset:320
    buffer_load_dwordx4 a[156:159], v6, s[40:43], s32 offen offset:320
    buffer_load_dwordx4 a[160:163], v6, s[40:43], s33 offen offset:320
    buffer_load_dwordx4 a[164:167], v6, s[40:43], s34 offen offset:320
    buffer_load_dwordx4 a[168:171], v6, s[40:43], s28 offen offset:384
    buffer_load_dwordx4 a[172:175], v6, s[40:43], s29 offen offset:384
    buffer_load_dwordx4 a[176:179], v6, s[40:43], s30 offen offset:384
    buffer_load_dwordx4 a[180:183], v6, s[40:43], s31 offen offset:384
    buffer_load_dwordx4 a[184:187], v6, s[40:43], s32 offen offset:384
    buffer_load_dwordx4 a[188:191], v6, s[40:43], s33 offen offset:384
    buffer_load_dwordx4 a[192:195], v6, s[40:43], s34 offen offset:384
    v_mov_b32 v132, 0
    v_mov_b32 v133, 0
    v_mov_b32 v134, 0
    v_mov_b32 v135, 0
    v_mov_b32 v136, 0
    v_mov_b32 v137, 0
    v_mov_b32 v138, 0
    v_mov_b32 v139, 0
    v_mov_b32 v140, 0
    v_mov_b32 v141, 0
    v_mov_b32 v142, 0
    v_mov_b32 v143, 0
    v_mov_b32 v144, 0
    v_mov_b32 v145, 0
    v_mov_b32 v146, 0
    v_mov_b32 v147, 0
    v_mov_b32 v148, 0
    v_mov_b32 v149, 0
    v_mov_b32 v150, 0
    v_mov_b32 v151, 0
    v_mov_b32 v152, 0
    v_mov_b32 v153, 0
    v_mov_b32 v154, 0
    v_mov_b32 v155, 0
    v_mov_b32 v156, 0
    v_mov_b32 v157, 0
    v_mov_b32 v158, 0
    v_mov_b32 v159, 0
    v_mov_b32 v160, 0
    v_mov_b32 v161, 0
    v_mov_b32 v162, 0
    v_mov_b32 v163, 0
    v_mov_b32 v164, 0
    v_mov_b32 v165, 0
    v_mov_b32 v166, 0
    v_mov_b32 v167, 0
    v_mov_b32 v168, 0
    v_mov_b32 v169, 0
    v_mov_b32 v170, 0
    v_mov_b32 v171, 0
    v_mov_b32 v172, 0
    v_mov_b32 v173, 0
    v_mov_b32 v174, 0
    v_mov_b32 v175, 0
    v_mov_b32 v176, 0
    v_mov_b32 v177, 0
    v_mov_b32 v178, 0
    v_mov_b32 v179, 0
    v_mov_b32 v180, 0
    v_mov_b32 v181, 0
    v_mov_b32 v182, 0
    v_mov_b32 v183, 0
    v_mov_b32 v184, 0
    v_mov_b32 v185, 0
    v_mov_b32 v186, 0
    v_mov_b32 v187, 0
    s_waitcnt vmcnt(42)
    v_mfma_f32_16x16x32_bf16 v[132:135], a[0:3], v[20:23], v[132:135]
    v_mfma_f32_16x16x32_bf16 v[136:139], a[0:3], v[76:79], v[136:139]
    v_mfma_f32_16x16x32_bf16 v[140:143], a[4:7], v[20:23], v[140:143]
    v_mfma_f32_16x16x32_bf16 v[144:147], a[4:7], v[76:79], v[144:147]
    v_mfma_f32_16x16x32_bf16 v[148:151], a[8:11], v[20:23], v[148:151]
    v_mfma_f32_16x16x32_bf16 v[152:155], a[8:11], v[76:79], v[152:155]
    v_mfma_f32_16x16x32_bf16 v[156:159], a[12:15], v[20:23], v[156:159]
    v_mfma_f32_16x16x32_bf16 v[160:163], a[12:15], v[76:79], v[160:163]
    v_mfma_f32_16x16x32_bf16 v[164:167], a[16:19], v[20:23], v[164:167]
    v_mfma_f32_16x16x32_bf16 v[168:171], a[16:19], v[76:79], v[168:171]
    v_mfma_f32_16x16x32_bf16 v[172:175], a[20:23], v[20:23], v[172:175]
    v_mfma_f32_16x16x32_bf16 v[176:179], a[20:23], v[76:79], v[176:179]
    v_mfma_f32_16x16x32_bf16 v[180:183], a[24:27], v[20:23], v[180:183]
    v_mfma_f32_16x16x32_bf16 v[184:187], a[24:27], v[76:79], v[184:187]
    buffer_load_dwordx4 a[0:3], v6, s[40:43], s28 offen offset:448
    buffer_load_dwordx4 a[4:7], v6, s[40:43], s29 offen offset:448
    buffer_load_dwordx4 a[8:11], v6, s[40:43], s30 offen offset:448
    buffer_load_dwordx4 a[12:15], v6, s[40:43], s31 offen offset:448
    buffer_load_dwordx4 a[16:19], v6, s[40:43], s32 offen offset:448
    buffer_load_dwordx4 a[20:23], v6, s[40:43], s33 offen offset:448
    buffer_load_dwordx4 a[24:27], v6, s[40:43], s34 offen offset:448
    s_waitcnt vmcnt(42)
    v_mfma_f32_16x16x32_bf16 v[132:135], a[28:31], v[24:27], v[132:135]
    v_mfma_f32_16x16x32_bf16 v[136:139], a[28:31], v[80:83], v[136:139]
    v_mfma_f32_16x16x32_bf16 v[140:143], a[32:35], v[24:27], v[140:143]
    v_mfma_f32_16x16x32_bf16 v[144:147], a[32:35], v[80:83], v[144:147]
    v_mfma_f32_16x16x32_bf16 v[148:151], a[36:39], v[24:27], v[148:151]
    v_mfma_f32_16x16x32_bf16 v[152:155], a[36:39], v[80:83], v[152:155]
    v_mfma_f32_16x16x32_bf16 v[156:159], a[40:43], v[24:27], v[156:159]
    v_mfma_f32_16x16x32_bf16 v[160:163], a[40:43], v[80:83], v[160:163]
    v_mfma_f32_16x16x32_bf16 v[164:167], a[44:47], v[24:27], v[164:167]
    v_mfma_f32_16x16x32_bf16 v[168:171], a[44:47], v[80:83], v[168:171]
    v_mfma_f32_16x16x32_bf16 v[172:175], a[48:51], v[24:27], v[172:175]
    v_mfma_f32_16x16x32_bf16 v[176:179], a[48:51], v[80:83], v[176:179]
    v_mfma_f32_16x16x32_bf16 v[180:183], a[52:55], v[24:27], v[180:183]
    v_mfma_f32_16x16x32_bf16 v[184:187], a[52:55], v[80:83], v[184:187]
    buffer_load_dwordx4 a[28:31], v6, s[40:43], s28 offen offset:512
    buffer_load_dwordx4 a[32:35], v6, s[40:43], s29 offen offset:512
    buffer_load_dwordx4 a[36:39], v6, s[40:43], s30 offen offset:512
    buffer_load_dwordx4 a[40:43], v6, s[40:43], s31 offen offset:512
    buffer_load_dwordx4 a[44:47], v6, s[40:43], s32 offen offset:512
    buffer_load_dwordx4 a[48:51], v6, s[40:43], s33 offen offset:512
    buffer_load_dwordx4 a[52:55], v6, s[40:43], s34 offen offset:512
    s_waitcnt vmcnt(42)
    v_mfma_f32_16x16x32_bf16 v[132:135], a[56:59], v[28:31], v[132:135]
    v_mfma_f32_16x16x32_bf16 v[136:139], a[56:59], v[84:87], v[136:139]
    v_mfma_f32_16x16x32_bf16 v[140:143], a[60:63], v[28:31], v[140:143]
    v_mfma_f32_16x16x32_bf16 v[144:147], a[60:63], v[84:87], v[144:147]
    v_mfma_f32_16x16x32_bf16 v[148:151], a[64:67], v[28:31], v[148:151]
    v_mfma_f32_16x16x32_bf16 v[152:155], a[64:67], v[84:87], v[152:155]
    v_mfma_f32_16x16x32_bf16 v[156:159], a[68:71], v[28:31], v[156:159]
    v_mfma_f32_16x16x32_bf16 v[160:163], a[68:71], v[84:87], v[160:163]
    v_mfma_f32_16x16x32_bf16 v[164:167], a[72:75], v[28:31], v[164:167]
    v_mfma_f32_16x16x32_bf16 v[168:171], a[72:75], v[84:87], v[168:171]
    v_mfma_f32_16x16x32_bf16 v[172:175], a[76:79], v[28:31], v[172:175]
    v_mfma_f32_16x16x32_bf16 v[176:179], a[76:79], v[84:87], v[176:179]
    v_mfma_f32_16x16x32_bf16 v[180:183], a[80:83], v[28:31], v[180:183]
    v_mfma_f32_16x16x32_bf16 v[184:187], a[80:83], v[84:87], v[184:187]
    buffer_load_dwordx4 a[56:59], v6, s[40:43], s28 offen offset:576
    buffer_load_dwordx4 a[60:63], v6, s[40:43], s29 offen offset:576
    buffer_load_dwordx4 a[64:67], v6, s[40:43], s30 offen offset:576
    buffer_load_dwordx4 a[68:71], v6, s[40:43], s31 offen offset:576
    buffer_load_dwordx4 a[72:75], v6, s[40:43], s32 offen offset:576
    buffer_load_dwordx4 a[76:79], v6, s[40:43], s33 offen offset:576
    buffer_load_dwordx4 a[80:83], v6, s[40:43], s34 offen offset:576
    s_waitcnt vmcnt(42)
    v_mfma_f32_16x16x32_bf16 v[132:135], a[84:87], v[32:35], v[132:135]
    v_mfma_f32_16x16x32_bf16 v[136:139], a[84:87], v[88:91], v[136:139]
    v_mfma_f32_16x16x32_bf16 v[140:143], a[88:91], v[32:35], v[140:143]
    v_mfma_f32_16x16x32_bf16 v[144:147], a[88:91], v[88:91], v[144:147]
    v_mfma_f32_16x16x32_bf16 v[148:151], a[92:95], v[32:35], v[148:151]
    v_mfma_f32_16x16x32_bf16 v[152:155], a[92:95], v[88:91], v[152:155]
    v_mfma_f32_16x16x32_bf16 v[156:159], a[96:99], v[32:35], v[156:159]
    v_mfma_f32_16x16x32_bf16 v[160:163], a[96:99], v[88:91], v[160:163]
    v_mfma_f32_16x16x32_bf16 v[164:167], a[100:103], v[32:35], v[164:167]
    v_mfma_f32_16x16x32_bf16 v[168:171], a[100:103], v[88:91], v[168:171]
    v_mfma_f32_16x16x32_bf16 v[172:175], a[104:107], v[32:35], v[172:175]
    v_mfma_f32_16x16x32_bf16 v[176:179], a[104:107], v[88:91], v[176:179]
    v_mfma_f32_16x16x32_bf16 v[180:183], a[108:111], v[32:35], v[180:183]
    v_mfma_f32_16x16x32_bf16 v[184:187], a[108:111], v[88:91], v[184:187]
    buffer_load_dwordx4 a[84:87], v6, s[40:43], s28 offen offset:640
    buffer_load_dwordx4 a[88:91], v6, s[40:43], s29 offen offset:640
    buffer_load_dwordx4 a[92:95], v6, s[40:43], s30 offen offset:640
    buffer_load_dwordx4 a[96:99], v6, s[40:43], s31 offen offset:640
    buffer_load_dwordx4 a[100:103], v6, s[40:43], s32 offen offset:640
    buffer_load_dwordx4 a[104:107], v6, s[40:43], s33 offen offset:640
    buffer_load_dwordx4 a[108:111], v6, s[40:43], s34 offen offset:640
    s_waitcnt vmcnt(42)
    v_mfma_f32_16x16x32_bf16 v[132:135], a[112:115], v[36:39], v[132:135]
    v_mfma_f32_16x16x32_bf16 v[136:139], a[112:115], v[92:95], v[136:139]
    v_mfma_f32_16x16x32_bf16 v[140:143], a[116:119], v[36:39], v[140:143]
    v_mfma_f32_16x16x32_bf16 v[144:147], a[116:119], v[92:95], v[144:147]
    v_mfma_f32_16x16x32_bf16 v[148:151], a[120:123], v[36:39], v[148:151]
    v_mfma_f32_16x16x32_bf16 v[152:155], a[120:123], v[92:95], v[152:155]
    v_mfma_f32_16x16x32_bf16 v[156:159], a[124:127], v[36:39], v[156:159]
    v_mfma_f32_16x16x32_bf16 v[160:163], a[124:127], v[92:95], v[160:163]
    v_mfma_f32_16x16x32_bf16 v[164:167], a[128:131], v[36:39], v[164:167]
    v_mfma_f32_16x16x32_bf16 v[168:171], a[128:131], v[92:95], v[168:171]
    v_mfma_f32_16x16x32_bf16 v[172:175], a[132:135], v[36:39], v[172:175]
    v_mfma_f32_16x16x32_bf16 v[176:179], a[132:135], v[92:95], v[176:179]
    v_mfma_f32_16x16x32_bf16 v[180:183], a[136:139], v[36:39], v[180:183]
    v_mfma_f32_16x16x32_bf16 v[184:187], a[136:139], v[92:95], v[184:187]
    buffer_load_dwordx4 a[112:115], v6, s[40:43], s28 offen offset:704
    buffer_load_dwordx4 a[116:119], v6, s[40:43], s29 offen offset:704
    buffer_load_dwordx4 a[120:123], v6, s[40:43], s30 offen offset:704
    buffer_load_dwordx4 a[124:127], v6, s[40:43], s31 offen offset:704
    buffer_load_dwordx4 a[128:131], v6, s[40:43], s32 offen offset:704
    buffer_load_dwordx4 a[132:135], v6, s[40:43], s33 offen offset:704
    buffer_load_dwordx4 a[136:139], v6, s[40:43], s34 offen offset:704
    s_waitcnt vmcnt(42)
    v_mfma_f32_16x16x32_bf16 v[132:135], a[140:143], v[40:43], v[132:135]
    v_mfma_f32_16x16x32_bf16 v[136:139], a[140:143], v[96:99], v[136:139]
    v_mfma_f32_16x16x32_bf16 v[140:143], a[144:147], v[40:43], v[140:143]
    v_mfma_f32_16x16x32_bf16 v[144:147], a[144:147], v[96:99], v[144:147]
    v_mfma_f32_16x16x32_bf16 v[148:151], a[148:151], v[40:43], v[148:151]
    v_mfma_f32_16x16x32_bf16 v[152:155], a[148:151], v[96:99], v[152:155]
    v_mfma_f32_16x16x32_bf16 v[156:159], a[152:155], v[40:43], v[156:159]
    v_mfma_f32_16x16x32_bf16 v[160:163], a[152:155], v[96:99], v[160:163]
    v_mfma_f32_16x16x32_bf16 v[164:167], a[156:159], v[40:43], v[164:167]
    v_mfma_f32_16x16x32_bf16 v[168:171], a[156:159], v[96:99], v[168:171]
    v_mfma_f32_16x16x32_bf16 v[172:175], a[160:163], v[40:43], v[172:175]
    v_mfma_f32_16x16x32_bf16 v[176:179], a[160:163], v[96:99], v[176:179]
    v_mfma_f32_16x16x32_bf16 v[180:183], a[164:167], v[40:43], v[180:183]
    v_mfma_f32_16x16x32_bf16 v[184:187], a[164:167], v[96:99], v[184:187]
    buffer_load_dwordx4 a[140:143], v6, s[40:43], s28 offen offset:768
    buffer_load_dwordx4 a[144:147], v6, s[40:43], s29 offen offset:768
    buffer_load_dwordx4 a[148:151], v6, s[40:43], s30 offen offset:768
    buffer_load_dwordx4 a[152:155], v6, s[40:43], s31 offen offset:768
    buffer_load_dwordx4 a[156:159], v6, s[40:43], s32 offen offset:768
    buffer_load_dwordx4 a[160:163], v6, s[40:43], s33 offen offset:768
    buffer_load_dwordx4 a[164:167], v6, s[40:43], s34 offen offset:768
    s_waitcnt vmcnt(42)
    v_mfma_f32_16x16x32_bf16 v[132:135], a[168:171], v[44:47], v[132:135]
    v_mfma_f32_16x16x32_bf16 v[136:139], a[168:171], v[100:103], v[136:139]
    v_mfma_f32_16x16x32_bf16 v[140:143], a[172:175], v[44:47], v[140:143]
    v_mfma_f32_16x16x32_bf16 v[144:147], a[172:175], v[100:103], v[144:147]
    v_mfma_f32_16x16x32_bf16 v[148:151], a[176:179], v[44:47], v[148:151]
    v_mfma_f32_16x16x32_bf16 v[152:155], a[176:179], v[100:103], v[152:155]
    v_mfma_f32_16x16x32_bf16 v[156:159], a[180:183], v[44:47], v[156:159]
    v_mfma_f32_16x16x32_bf16 v[160:163], a[180:183], v[100:103], v[160:163]
    v_mfma_f32_16x16x32_bf16 v[164:167], a[184:187], v[44:47], v[164:167]
    v_mfma_f32_16x16x32_bf16 v[168:171], a[184:187], v[100:103], v[168:171]
    v_mfma_f32_16x16x32_bf16 v[172:175], a[188:191], v[44:47], v[172:175]
    v_mfma_f32_16x16x32_bf16 v[176:179], a[188:191], v[100:103], v[176:179]
    v_mfma_f32_16x16x32_bf16 v[180:183], a[192:195], v[44:47], v[180:183]
    v_mfma_f32_16x16x32_bf16 v[184:187], a[192:195], v[100:103], v[184:187]
    buffer_load_dwordx4 a[168:171], v6, s[40:43], s28 offen offset:832
    buffer_load_dwordx4 a[172:175], v6, s[40:43], s29 offen offset:832
    buffer_load_dwordx4 a[176:179], v6, s[40:43], s30 offen offset:832
    buffer_load_dwordx4 a[180:183], v6, s[40:43], s31 offen offset:832
    buffer_load_dwordx4 a[184:187], v6, s[40:43], s32 offen offset:832
    buffer_load_dwordx4 a[188:191], v6, s[40:43], s33 offen offset:832
    buffer_load_dwordx4 a[192:195], v6, s[40:43], s34 offen offset:832
    s_waitcnt vmcnt(42)
    v_mfma_f32_16x16x32_bf16 v[132:135], a[0:3], v[48:51], v[132:135]
    v_mfma_f32_16x16x32_bf16 v[136:139], a[0:3], v[104:107], v[136:139]
    v_mfma_f32_16x16x32_bf16 v[140:143], a[4:7], v[48:51], v[140:143]
    v_mfma_f32_16x16x32_bf16 v[144:147], a[4:7], v[104:107], v[144:147]
    v_mfma_f32_16x16x32_bf16 v[148:151], a[8:11], v[48:51], v[148:151]
    v_mfma_f32_16x16x32_bf16 v[152:155], a[8:11], v[104:107], v[152:155]
    v_mfma_f32_16x16x32_bf16 v[156:159], a[12:15], v[48:51], v[156:159]
    v_mfma_f32_16x16x32_bf16 v[160:163], a[12:15], v[104:107], v[160:163]
    v_mfma_f32_16x16x32_bf16 v[164:167], a[16:19], v[48:51], v[164:167]
    v_mfma_f32_16x16x32_bf16 v[168:171], a[16:19], v[104:107], v[168:171]
    v_mfma_f32_16x16x32_bf16 v[172:175], a[20:23], v[48:51], v[172:175]
    v_mfma_f32_16x16x32_bf16 v[176:179], a[20:23], v[104:107], v[176:179]
    v_mfma_f32_16x16x32_bf16 v[180:183], a[24:27], v[48:51], v[180:183]
    v_mfma_f32_16x16x32_bf16 v[184:187], a[24:27], v[104:107], v[184:187]
    buffer_load_dwordx4 a[0:3], v6, s[44:47], s80 offen offset:0
    buffer_load_dwordx4 a[4:7], v6, s[44:47], s81 offen offset:0
    buffer_load_dwordx4 a[8:11], v6, s[44:47], s82 offen offset:0
    buffer_load_dwordx4 a[12:15], v6, s[44:47], s83 offen offset:0
    buffer_load_dwordx4 a[16:19], v6, s[44:47], s84 offen offset:0
    buffer_load_dwordx4 a[20:23], v6, s[44:47], s85 offen offset:0
    buffer_load_dwordx4 a[24:27], v6, s[44:47], s86 offen offset:0
    s_waitcnt vmcnt(42)
    v_mfma_f32_16x16x32_bf16 v[132:135], a[28:31], v[52:55], v[132:135]
    v_mfma_f32_16x16x32_bf16 v[136:139], a[28:31], v[108:111], v[136:139]
    v_mfma_f32_16x16x32_bf16 v[140:143], a[32:35], v[52:55], v[140:143]
    v_mfma_f32_16x16x32_bf16 v[144:147], a[32:35], v[108:111], v[144:147]
    v_mfma_f32_16x16x32_bf16 v[148:151], a[36:39], v[52:55], v[148:151]
    v_mfma_f32_16x16x32_bf16 v[152:155], a[36:39], v[108:111], v[152:155]
    v_mfma_f32_16x16x32_bf16 v[156:159], a[40:43], v[52:55], v[156:159]
    v_mfma_f32_16x16x32_bf16 v[160:163], a[40:43], v[108:111], v[160:163]
    v_mfma_f32_16x16x32_bf16 v[164:167], a[44:47], v[52:55], v[164:167]
    v_mfma_f32_16x16x32_bf16 v[168:171], a[44:47], v[108:111], v[168:171]
    v_mfma_f32_16x16x32_bf16 v[172:175], a[48:51], v[52:55], v[172:175]
    v_mfma_f32_16x16x32_bf16 v[176:179], a[48:51], v[108:111], v[176:179]
    v_mfma_f32_16x16x32_bf16 v[180:183], a[52:55], v[52:55], v[180:183]
    v_mfma_f32_16x16x32_bf16 v[184:187], a[52:55], v[108:111], v[184:187]
    buffer_load_dwordx4 a[28:31], v6, s[44:47], s80 offen offset:64
    buffer_load_dwordx4 a[32:35], v6, s[44:47], s81 offen offset:64
    buffer_load_dwordx4 a[36:39], v6, s[44:47], s82 offen offset:64
    buffer_load_dwordx4 a[40:43], v6, s[44:47], s83 offen offset:64
    buffer_load_dwordx4 a[44:47], v6, s[44:47], s84 offen offset:64
    buffer_load_dwordx4 a[48:51], v6, s[44:47], s85 offen offset:64
    buffer_load_dwordx4 a[52:55], v6, s[44:47], s86 offen offset:64
    s_waitcnt vmcnt(42)
    v_mfma_f32_16x16x32_bf16 v[132:135], a[56:59], v[56:59], v[132:135]
    v_mfma_f32_16x16x32_bf16 v[136:139], a[56:59], v[112:115], v[136:139]
    v_mfma_f32_16x16x32_bf16 v[140:143], a[60:63], v[56:59], v[140:143]
    v_mfma_f32_16x16x32_bf16 v[144:147], a[60:63], v[112:115], v[144:147]
    v_mfma_f32_16x16x32_bf16 v[148:151], a[64:67], v[56:59], v[148:151]
    v_mfma_f32_16x16x32_bf16 v[152:155], a[64:67], v[112:115], v[152:155]
    v_mfma_f32_16x16x32_bf16 v[156:159], a[68:71], v[56:59], v[156:159]
    v_mfma_f32_16x16x32_bf16 v[160:163], a[68:71], v[112:115], v[160:163]
    v_mfma_f32_16x16x32_bf16 v[164:167], a[72:75], v[56:59], v[164:167]
    v_mfma_f32_16x16x32_bf16 v[168:171], a[72:75], v[112:115], v[168:171]
    v_mfma_f32_16x16x32_bf16 v[172:175], a[76:79], v[56:59], v[172:175]
    v_mfma_f32_16x16x32_bf16 v[176:179], a[76:79], v[112:115], v[176:179]
    v_mfma_f32_16x16x32_bf16 v[180:183], a[80:83], v[56:59], v[180:183]
    v_mfma_f32_16x16x32_bf16 v[184:187], a[80:83], v[112:115], v[184:187]
    buffer_load_dwordx4 a[56:59], v6, s[44:47], s80 offen offset:128
    buffer_load_dwordx4 a[60:63], v6, s[44:47], s81 offen offset:128
    buffer_load_dwordx4 a[64:67], v6, s[44:47], s82 offen offset:128
    buffer_load_dwordx4 a[68:71], v6, s[44:47], s83 offen offset:128
    buffer_load_dwordx4 a[72:75], v6, s[44:47], s84 offen offset:128
    buffer_load_dwordx4 a[76:79], v6, s[44:47], s85 offen offset:128
    buffer_load_dwordx4 a[80:83], v6, s[44:47], s86 offen offset:128
    s_waitcnt vmcnt(42)
    v_mfma_f32_16x16x32_bf16 v[132:135], a[84:87], v[60:63], v[132:135]
    v_mfma_f32_16x16x32_bf16 v[136:139], a[84:87], v[116:119], v[136:139]
    v_mfma_f32_16x16x32_bf16 v[140:143], a[88:91], v[60:63], v[140:143]
    v_mfma_f32_16x16x32_bf16 v[144:147], a[88:91], v[116:119], v[144:147]
    v_mfma_f32_16x16x32_bf16 v[148:151], a[92:95], v[60:63], v[148:151]
    v_mfma_f32_16x16x32_bf16 v[152:155], a[92:95], v[116:119], v[152:155]
    v_mfma_f32_16x16x32_bf16 v[156:159], a[96:99], v[60:63], v[156:159]
    v_mfma_f32_16x16x32_bf16 v[160:163], a[96:99], v[116:119], v[160:163]
    v_mfma_f32_16x16x32_bf16 v[164:167], a[100:103], v[60:63], v[164:167]
    v_mfma_f32_16x16x32_bf16 v[168:171], a[100:103], v[116:119], v[168:171]
    v_mfma_f32_16x16x32_bf16 v[172:175], a[104:107], v[60:63], v[172:175]
    v_mfma_f32_16x16x32_bf16 v[176:179], a[104:107], v[116:119], v[176:179]
    v_mfma_f32_16x16x32_bf16 v[180:183], a[108:111], v[60:63], v[180:183]
    v_mfma_f32_16x16x32_bf16 v[184:187], a[108:111], v[116:119], v[184:187]
    buffer_load_dwordx4 a[84:87], v6, s[44:47], s80 offen offset:192
    buffer_load_dwordx4 a[88:91], v6, s[44:47], s81 offen offset:192
    buffer_load_dwordx4 a[92:95], v6, s[44:47], s82 offen offset:192
    buffer_load_dwordx4 a[96:99], v6, s[44:47], s83 offen offset:192
    buffer_load_dwordx4 a[100:103], v6, s[44:47], s84 offen offset:192
    buffer_load_dwordx4 a[104:107], v6, s[44:47], s85 offen offset:192
    buffer_load_dwordx4 a[108:111], v6, s[44:47], s86 offen offset:192
    s_waitcnt vmcnt(42)
    v_mfma_f32_16x16x32_bf16 v[132:135], a[112:115], v[64:67], v[132:135]
    v_mfma_f32_16x16x32_bf16 v[136:139], a[112:115], v[120:123], v[136:139]
    v_mfma_f32_16x16x32_bf16 v[140:143], a[116:119], v[64:67], v[140:143]
    v_mfma_f32_16x16x32_bf16 v[144:147], a[116:119], v[120:123], v[144:147]
    v_mfma_f32_16x16x32_bf16 v[148:151], a[120:123], v[64:67], v[148:151]
    v_mfma_f32_16x16x32_bf16 v[152:155], a[120:123], v[120:123], v[152:155]
    v_mfma_f32_16x16x32_bf16 v[156:159], a[124:127], v[64:67], v[156:159]
    v_mfma_f32_16x16x32_bf16 v[160:163], a[124:127], v[120:123], v[160:163]
    v_mfma_f32_16x16x32_bf16 v[164:167], a[128:131], v[64:67], v[164:167]
    v_mfma_f32_16x16x32_bf16 v[168:171], a[128:131], v[120:123], v[168:171]
    v_mfma_f32_16x16x32_bf16 v[172:175], a[132:135], v[64:67], v[172:175]
    v_mfma_f32_16x16x32_bf16 v[176:179], a[132:135], v[120:123], v[176:179]
    v_mfma_f32_16x16x32_bf16 v[180:183], a[136:139], v[64:67], v[180:183]
    v_mfma_f32_16x16x32_bf16 v[184:187], a[136:139], v[120:123], v[184:187]
    buffer_load_dwordx4 a[112:115], v6, s[44:47], s80 offen offset:256
    buffer_load_dwordx4 a[116:119], v6, s[44:47], s81 offen offset:256
    buffer_load_dwordx4 a[120:123], v6, s[44:47], s82 offen offset:256
    buffer_load_dwordx4 a[124:127], v6, s[44:47], s83 offen offset:256
    buffer_load_dwordx4 a[128:131], v6, s[44:47], s84 offen offset:256
    buffer_load_dwordx4 a[132:135], v6, s[44:47], s85 offen offset:256
    buffer_load_dwordx4 a[136:139], v6, s[44:47], s86 offen offset:256
    s_waitcnt vmcnt(42)
    v_mfma_f32_16x16x32_bf16 v[132:135], a[140:143], v[68:71], v[132:135]
    v_mfma_f32_16x16x32_bf16 v[136:139], a[140:143], v[124:127], v[136:139]
    v_mfma_f32_16x16x32_bf16 v[140:143], a[144:147], v[68:71], v[140:143]
    v_mfma_f32_16x16x32_bf16 v[144:147], a[144:147], v[124:127], v[144:147]
    v_mfma_f32_16x16x32_bf16 v[148:151], a[148:151], v[68:71], v[148:151]
    v_mfma_f32_16x16x32_bf16 v[152:155], a[148:151], v[124:127], v[152:155]
    v_mfma_f32_16x16x32_bf16 v[156:159], a[152:155], v[68:71], v[156:159]
    v_mfma_f32_16x16x32_bf16 v[160:163], a[152:155], v[124:127], v[160:163]
    v_mfma_f32_16x16x32_bf16 v[164:167], a[156:159], v[68:71], v[164:167]
    v_mfma_f32_16x16x32_bf16 v[168:171], a[156:159], v[124:127], v[168:171]
    v_mfma_f32_16x16x32_bf16 v[172:175], a[160:163], v[68:71], v[172:175]
    v_mfma_f32_16x16x32_bf16 v[176:179], a[160:163], v[124:127], v[176:179]
    v_mfma_f32_16x16x32_bf16 v[180:183], a[164:167], v[68:71], v[180:183]
    v_mfma_f32_16x16x32_bf16 v[184:187], a[164:167], v[124:127], v[184:187]
    buffer_load_dwordx4 a[140:143], v6, s[44:47], s80 offen offset:320
    buffer_load_dwordx4 a[144:147], v6, s[44:47], s81 offen offset:320
    buffer_load_dwordx4 a[148:151], v6, s[44:47], s82 offen offset:320
    buffer_load_dwordx4 a[152:155], v6, s[44:47], s83 offen offset:320
    buffer_load_dwordx4 a[156:159], v6, s[44:47], s84 offen offset:320
    buffer_load_dwordx4 a[160:163], v6, s[44:47], s85 offen offset:320
    buffer_load_dwordx4 a[164:167], v6, s[44:47], s86 offen offset:320
    s_waitcnt vmcnt(42)
    v_mfma_f32_16x16x32_bf16 v[132:135], a[168:171], v[72:75], v[132:135]
    v_mfma_f32_16x16x32_bf16 v[136:139], a[168:171], v[128:131], v[136:139]
    v_mfma_f32_16x16x32_bf16 v[140:143], a[172:175], v[72:75], v[140:143]
    v_mfma_f32_16x16x32_bf16 v[144:147], a[172:175], v[128:131], v[144:147]
    v_mfma_f32_16x16x32_bf16 v[148:151], a[176:179], v[72:75], v[148:151]
    v_mfma_f32_16x16x32_bf16 v[152:155], a[176:179], v[128:131], v[152:155]
    v_mfma_f32_16x16x32_bf16 v[156:159], a[180:183], v[72:75], v[156:159]
    v_mfma_f32_16x16x32_bf16 v[160:163], a[180:183], v[128:131], v[160:163]
    v_mfma_f32_16x16x32_bf16 v[164:167], a[184:187], v[72:75], v[164:167]
    v_mfma_f32_16x16x32_bf16 v[168:171], a[184:187], v[128:131], v[168:171]
    v_mfma_f32_16x16x32_bf16 v[172:175], a[188:191], v[72:75], v[172:175]
    v_mfma_f32_16x16x32_bf16 v[176:179], a[188:191], v[128:131], v[176:179]
    v_mfma_f32_16x16x32_bf16 v[180:183], a[192:195], v[72:75], v[180:183]
    v_mfma_f32_16x16x32_bf16 v[184:187], a[192:195], v[128:131], v[184:187]
    buffer_load_dwordx4 a[168:171], v6, s[44:47], s80 offen offset:384
    buffer_load_dwordx4 a[172:175], v6, s[44:47], s81 offen offset:384
    buffer_load_dwordx4 a[176:179], v6, s[44:47], s82 offen offset:384
    buffer_load_dwordx4 a[180:183], v6, s[44:47], s83 offen offset:384
    buffer_load_dwordx4 a[184:187], v6, s[44:47], s84 offen offset:384
    buffer_load_dwordx4 a[188:191], v6, s[44:47], s85 offen offset:384
    buffer_load_dwordx4 a[192:195], v6, s[44:47], s86 offen offset:384
    v_mul_u32_u24 v7, 1808, v3
    v_lshl_add_u32 v7, v4, 4, v7
    s_mul_i32 s26, s20, 448
    v_add_u32 v7, s26, v7
    s_nop 7
    ds_write_b128 v7, v[132:135] offset:0
    ds_write_b128 v7, v[136:139] offset:28928
    ds_write_b128 v7, v[140:143] offset:64
    ds_write_b128 v7, v[144:147] offset:28992
    ds_write_b128 v7, v[148:151] offset:128
    ds_write_b128 v7, v[152:155] offset:29056
    ds_write_b128 v7, v[156:159] offset:192
    ds_write_b128 v7, v[160:163] offset:29120
    ds_write_b128 v7, v[164:167] offset:256
    ds_write_b128 v7, v[168:171] offset:29184
    ds_write_b128 v7, v[172:175] offset:320
    ds_write_b128 v7, v[176:179] offset:29248
    ds_write_b128 v7, v[180:183] offset:384
    ds_write_b128 v7, v[184:187] offset:29312
    s_load_dwordx2 s[52:53], s[0:1], 8
    s_waitcnt lgkmcnt(0)
    s_and_b32 s53, s53, 0xffff
    s_mov_b32 s54, 896
    s_mov_b32 s55, 0x00020000
    s_mul_i32 s26, s25, 448
    v_lshlrev_b32 v8, 1, v0
    buffer_load_ushort v10, v8, s[52:55], s26 offen
    s_waitcnt vmcnt(0)
    s_load_dwordx2 s[52:53], s[0:1], 16
    s_waitcnt lgkmcnt(0)
    s_and_b32 s53, s53, 0xffff
    s_mov_b32 s54, 896
    s_mov_b32 s55, 0x00020000
    buffer_load_ushort v11, v8, s[52:55], s26 offen
    s_waitcnt vmcnt(0)
    s_load_dwordx2 s[52:53], s[0:1], 56
    s_waitcnt lgkmcnt(0)
    s_and_b32 s53, s53, 0xffff
    s_mov_b32 s54, 896
    s_mov_b32 s55, 0x00020000
    buffer_load_ushort v12, v8, s[52:55], s26 offen
    s_waitcnt vmcnt(0) lgkmcnt(0)
    s_barrier
    v_cmp_gt_u32 vcc, 224, v0
    s_and_saveexec_b64 s[36:37], vcc
    v_lshlrev_b32 v7, 2, v0
    ds_read_b32 v20, v7 offset:0
    ds_read_b32 v21, v7 offset:896
    ds_read_b32 v22, v7 offset:1808
    ds_read_b32 v23, v7 offset:2704
    ds_read_b32 v24, v7 offset:3616
    ds_read_b32 v25, v7 offset:4512
    ds_read_b32 v26, v7 offset:5424
    ds_read_b32 v27, v7 offset:6320
    ds_read_b32 v28, v7 offset:7232
    ds_read_b32 v29, v7 offset:8128
    ds_read_b32 v30, v7 offset:9040
    ds_read_b32 v31, v7 offset:9936
    ds_read_b32 v32, v7 offset:10848
    ds_read_b32 v33, v7 offset:11744
    ds_read_b32 v34, v7 offset:12656
    ds_read_b32 v35, v7 offset:13552
    ds_read_b32 v36, v7 offset:14464
    ds_read_b32 v37, v7 offset:15360
    ds_read_b32 v38, v7 offset:16272
    ds_read_b32 v39, v7 offset:17168
    ds_read_b32 v40, v7 offset:18080
    ds_read_b32 v41, v7 offset:18976
    ds_read_b32 v42, v7 offset:19888
    ds_read_b32 v43, v7 offset:20784
    ds_read_b32 v44, v7 offset:21696
    ds_read_b32 v45, v7 offset:22592
    ds_read_b32 v46, v7 offset:23504
    ds_read_b32 v47, v7 offset:24400
    ds_read_b32 v48, v7 offset:25312
    ds_read_b32 v49, v7 offset:26208
    ds_read_b32 v50, v7 offset:27120
    ds_read_b32 v51, v7 offset:28016
    ds_read_b32 v52, v7 offset:28928
    ds_read_b32 v53, v7 offset:29824
    ds_read_b32 v54, v7 offset:30736
    ds_read_b32 v55, v7 offset:31632
    ds_read_b32 v56, v7 offset:32544
    ds_read_b32 v57, v7 offset:33440
    ds_read_b32 v58, v7 offset:34352
    ds_read_b32 v59, v7 offset:35248
    ds_read_b32 v60, v7 offset:36160
    ds_read_b32 v61, v7 offset:37056
    ds_read_b32 v62, v7 offset:37968
    ds_read_b32 v63, v7 offset:38864
    ds_read_b32 v64, v7 offset:39776
    ds_read_b32 v65, v7 offset:40672
    ds_read_b32 v66, v7 offset:41584
    ds_read_b32 v67, v7 offset:42480
    ds_read_b32 v68, v7 offset:43392
    ds_read_b32 v69, v7 offset:44288
    ds_read_b32 v70, v7 offset:45200
    ds_read_b32 v71, v7 offset:46096
    ds_read_b32 v72, v7 offset:47008
    ds_read_b32 v73, v7 offset:47904
    ds_read_b32 v74, v7 offset:48816
    ds_read_b32 v75, v7 offset:49712
    ds_read_b32 v76, v7 offset:50624
    ds_read_b32 v77, v7 offset:51520
    ds_read_b32 v78, v7 offset:52432
    ds_read_b32 v79, v7 offset:53328
    ds_read_b32 v80, v7 offset:54240
    ds_read_b32 v81, v7 offset:55136
    ds_read_b32 v82, v7 offset:56048
    ds_read_b32 v83, v7 offset:56944
    v_lshlrev_b32 v10, 16, v10
    v_lshlrev_b32 v11, 16, v11
    v_lshlrev_b32 v12, 16, v12
    v_mul_f32 v12, 0x3fb8aa3b, v12
    v_exp_f32 v12, v12
    s_nop 0
    v_cvt_pk_bf16_f32 v12, v12, v12
    v_lshlrev_b32 v12, 16, v12
    v_mul_f32 v13, v12, v10
    v_mul_f32 v14, v12, v11
    v_mul_f32 v13, 0x3fb8aa3b, v13
    v_exp_f32 v13, v13
    v_mul_f32 v14, 0.15915494, v14
    v_rndne_f32 v12, v14
    v_sub_f32 v14, v14, v12
    v_cos_f32 v12, v14
    v_sin_f32 v14, v14
    s_nop 0
    v_mul_f32 v85, v13, v12
    v_mul_f32 v86, v13, v14
    v_add_f32 v12, -1.0, v85
    v_mul_f32 v13, v10, v10
    v_fma_f32 v13, v11, v11, v13
    v_rcp_f32 v13, v13
    s_nop 0
    v_mul_f32 v87, v12, v10
    v_fma_f32 v87, v86, v11, v87
    v_mul_f32 v88, v86, v10
    v_fma_f32 v88, -v12, v11, v88
    v_mul_f32 v87, v87, v13
    v_mul_f32 v88, v88, v13
    s_waitcnt lgkmcnt(0)
    v_mov_b32 v90, 0
    v_mov_b32 v91, 0
    v_mul_f32 v12, v87, v20
    v_mul_f32 v13, v87, v21
    v_fma_f32 v12, -v88, v21, v12
    v_fma_f32 v21, v88, v20, v13
    v_mov_b32 v20, v12
    v_fma_f32 v92, v85, v90, v20
    v_fma_f32 v93, v85, v91, v21
    v_fma_f32 v92, -v86, v91, v92
    v_fma_f32 v91, v86, v90, v93
    v_mov_b32 v90, v92
    v_mul_f32 v12, v87, v22
    v_mul_f32 v13, v87, v23
    v_fma_f32 v12, -v88, v23, v12
    v_fma_f32 v23, v88, v22, v13
    v_mov_b32 v22, v12
    v_fma_f32 v92, v85, v90, v22
    v_fma_f32 v93, v85, v91, v23
    v_fma_f32 v92, -v86, v91, v92
    v_fma_f32 v91, v86, v90, v93
    v_mov_b32 v90, v92
    v_mul_f32 v12, v87, v24
    v_mul_f32 v13, v87, v25
    v_fma_f32 v12, -v88, v25, v12
    v_fma_f32 v25, v88, v24, v13
    v_mov_b32 v24, v12
    v_fma_f32 v92, v85, v90, v24
    v_fma_f32 v93, v85, v91, v25
    v_fma_f32 v92, -v86, v91, v92
    v_fma_f32 v91, v86, v90, v93
    v_mov_b32 v90, v92
    v_mul_f32 v12, v87, v26
    v_mul_f32 v13, v87, v27
    v_fma_f32 v12, -v88, v27, v12
    v_fma_f32 v27, v88, v26, v13
    v_mov_b32 v26, v12
    v_fma_f32 v92, v85, v90, v26
    v_fma_f32 v93, v85, v91, v27
    v_fma_f32 v92, -v86, v91, v92
    v_fma_f32 v91, v86, v90, v93
    v_mov_b32 v90, v92
    v_mul_f32 v12, v87, v28
    v_mul_f32 v13, v87, v29
    v_fma_f32 v12, -v88, v29, v12
    v_fma_f32 v29, v88, v28, v13
    v_mov_b32 v28, v12
    v_fma_f32 v92, v85, v90, v28
    v_fma_f32 v93, v85, v91, v29
    v_fma_f32 v92, -v86, v91, v92
    v_fma_f32 v91, v86, v90, v93
    v_mov_b32 v90, v92
    v_mul_f32 v12, v87, v30
    v_mul_f32 v13, v87, v31
    v_fma_f32 v12, -v88, v31, v12
    v_fma_f32 v31, v88, v30, v13
    v_mov_b32 v30, v12
    v_fma_f32 v92, v85, v90, v30
    v_fma_f32 v93, v85, v91, v31
    v_fma_f32 v92, -v86, v91, v92
    v_fma_f32 v91, v86, v90, v93
    v_mov_b32 v90, v92
    v_mul_f32 v12, v87, v32
    v_mul_f32 v13, v87, v33
    v_fma_f32 v12, -v88, v33, v12
    v_fma_f32 v33, v88, v32, v13
    v_mov_b32 v32, v12
    v_fma_f32 v92, v85, v90, v32
    v_fma_f32 v93, v85, v91, v33
    v_fma_f32 v92, -v86, v91, v92
    v_fma_f32 v91, v86, v90, v93
    v_mov_b32 v90, v92
    v_mul_f32 v12, v87, v34
    v_mul_f32 v13, v87, v35
    v_fma_f32 v12, -v88, v35, v12
    v_fma_f32 v35, v88, v34, v13
    v_mov_b32 v34, v12
    v_fma_f32 v92, v85, v90, v34
    v_fma_f32 v93, v85, v91, v35
    v_fma_f32 v92, -v86, v91, v92
    v_fma_f32 v91, v86, v90, v93
    v_mov_b32 v90, v92
    v_mul_f32 v12, v87, v36
    v_mul_f32 v13, v87, v37
    v_fma_f32 v12, -v88, v37, v12
    v_fma_f32 v37, v88, v36, v13
    v_mov_b32 v36, v12
    v_fma_f32 v92, v85, v90, v36
    v_fma_f32 v93, v85, v91, v37
    v_fma_f32 v92, -v86, v91, v92
    v_fma_f32 v91, v86, v90, v93
    v_mov_b32 v90, v92
    v_mul_f32 v12, v87, v38
    v_mul_f32 v13, v87, v39
    v_fma_f32 v12, -v88, v39, v12
    v_fma_f32 v39, v88, v38, v13
    v_mov_b32 v38, v12
    v_fma_f32 v92, v85, v90, v38
    v_fma_f32 v93, v85, v91, v39
    v_fma_f32 v92, -v86, v91, v92
    v_fma_f32 v91, v86, v90, v93
    v_mov_b32 v90, v92
    v_mul_f32 v12, v87, v40
    v_mul_f32 v13, v87, v41
    v_fma_f32 v12, -v88, v41, v12
    v_fma_f32 v41, v88, v40, v13
    v_mov_b32 v40, v12
    v_fma_f32 v92, v85, v90, v40
    v_fma_f32 v93, v85, v91, v41
    v_fma_f32 v92, -v86, v91, v92
    v_fma_f32 v91, v86, v90, v93
    v_mov_b32 v90, v92
    v_mul_f32 v12, v87, v42
    v_mul_f32 v13, v87, v43
    v_fma_f32 v12, -v88, v43, v12
    v_fma_f32 v43, v88, v42, v13
    v_mov_b32 v42, v12
    v_fma_f32 v92, v85, v90, v42
    v_fma_f32 v93, v85, v91, v43
    v_fma_f32 v92, -v86, v91, v92
    v_fma_f32 v91, v86, v90, v93
    v_mov_b32 v90, v92
    v_mul_f32 v12, v87, v44
    v_mul_f32 v13, v87, v45
    v_fma_f32 v12, -v88, v45, v12
    v_fma_f32 v45, v88, v44, v13
    v_mov_b32 v44, v12
    v_fma_f32 v92, v85, v90, v44
    v_fma_f32 v93, v85, v91, v45
    v_fma_f32 v92, -v86, v91, v92
    v_fma_f32 v91, v86, v90, v93
    v_mov_b32 v90, v92
    v_mul_f32 v12, v87, v46
    v_mul_f32 v13, v87, v47
    v_fma_f32 v12, -v88, v47, v12
    v_fma_f32 v47, v88, v46, v13
    v_mov_b32 v46, v12
    v_fma_f32 v92, v85, v90, v46
    v_fma_f32 v93, v85, v91, v47
    v_fma_f32 v92, -v86, v91, v92
    v_fma_f32 v91, v86, v90, v93
    v_mov_b32 v90, v92
    v_mul_f32 v12, v87, v48
    v_mul_f32 v13, v87, v49
    v_fma_f32 v12, -v88, v49, v12
    v_fma_f32 v49, v88, v48, v13
    v_mov_b32 v48, v12
    v_fma_f32 v92, v85, v90, v48
    v_fma_f32 v93, v85, v91, v49
    v_fma_f32 v92, -v86, v91, v92
    v_fma_f32 v91, v86, v90, v93
    v_mov_b32 v90, v92
    v_mul_f32 v12, v87, v50
    v_mul_f32 v13, v87, v51
    v_fma_f32 v12, -v88, v51, v12
    v_fma_f32 v51, v88, v50, v13
    v_mov_b32 v50, v12
    v_fma_f32 v92, v85, v90, v50
    v_fma_f32 v93, v85, v91, v51
    v_fma_f32 v92, -v86, v91, v92
    v_fma_f32 v91, v86, v90, v93
    v_mov_b32 v90, v92
    v_mul_f32 v12, v87, v52
    v_mul_f32 v13, v87, v53
    v_fma_f32 v12, -v88, v53, v12
    v_fma_f32 v53, v88, v52, v13
    v_mov_b32 v52, v12
    v_fma_f32 v92, v85, v90, v52
    v_fma_f32 v93, v85, v91, v53
    v_fma_f32 v92, -v86, v91, v92
    v_fma_f32 v91, v86, v90, v93
    v_mov_b32 v90, v92
    v_mul_f32 v12, v87, v54
    v_mul_f32 v13, v87, v55
    v_fma_f32 v12, -v88, v55, v12
    v_fma_f32 v55, v88, v54, v13
    v_mov_b32 v54, v12
    v_fma_f32 v92, v85, v90, v54
    v_fma_f32 v93, v85, v91, v55
    v_fma_f32 v92, -v86, v91, v92
    v_fma_f32 v91, v86, v90, v93
    v_mov_b32 v90, v92
    v_mul_f32 v12, v87, v56
    v_mul_f32 v13, v87, v57
    v_fma_f32 v12, -v88, v57, v12
    v_fma_f32 v57, v88, v56, v13
    v_mov_b32 v56, v12
    v_fma_f32 v92, v85, v90, v56
    v_fma_f32 v93, v85, v91, v57
    v_fma_f32 v92, -v86, v91, v92
    v_fma_f32 v91, v86, v90, v93
    v_mov_b32 v90, v92
    v_mul_f32 v12, v87, v58
    v_mul_f32 v13, v87, v59
    v_fma_f32 v12, -v88, v59, v12
    v_fma_f32 v59, v88, v58, v13
    v_mov_b32 v58, v12
    v_fma_f32 v92, v85, v90, v58
    v_fma_f32 v93, v85, v91, v59
    v_fma_f32 v92, -v86, v91, v92
    v_fma_f32 v91, v86, v90, v93
    v_mov_b32 v90, v92
    v_mul_f32 v12, v87, v60
    v_mul_f32 v13, v87, v61
    v_fma_f32 v12, -v88, v61, v12
    v_fma_f32 v61, v88, v60, v13
    v_mov_b32 v60, v12
    v_fma_f32 v92, v85, v90, v60
    v_fma_f32 v93, v85, v91, v61
    v_fma_f32 v92, -v86, v91, v92
    v_fma_f32 v91, v86, v90, v93
    v_mov_b32 v90, v92
    v_mul_f32 v12, v87, v62
    v_mul_f32 v13, v87, v63
    v_fma_f32 v12, -v88, v63, v12
    v_fma_f32 v63, v88, v62, v13
    v_mov_b32 v62, v12
    v_fma_f32 v92, v85, v90, v62
    v_fma_f32 v93, v85, v91, v63
    v_fma_f32 v92, -v86, v91, v92
    v_fma_f32 v91, v86, v90, v93
    v_mov_b32 v90, v92
    v_mul_f32 v12, v87, v64
    v_mul_f32 v13, v87, v65
    v_fma_f32 v12, -v88, v65, v12
    v_fma_f32 v65, v88, v64, v13
    v_mov_b32 v64, v12
    v_fma_f32 v92, v85, v90, v64
    v_fma_f32 v93, v85, v91, v65
    v_fma_f32 v92, -v86, v91, v92
    v_fma_f32 v91, v86, v90, v93
    v_mov_b32 v90, v92
    v_mul_f32 v12, v87, v66
    v_mul_f32 v13, v87, v67
    v_fma_f32 v12, -v88, v67, v12
    v_fma_f32 v67, v88, v66, v13
    v_mov_b32 v66, v12
    v_fma_f32 v92, v85, v90, v66
    v_fma_f32 v93, v85, v91, v67
    v_fma_f32 v92, -v86, v91, v92
    v_fma_f32 v91, v86, v90, v93
    v_mov_b32 v90, v92
    v_mul_f32 v12, v87, v68
    v_mul_f32 v13, v87, v69
    v_fma_f32 v12, -v88, v69, v12
    v_fma_f32 v69, v88, v68, v13
    v_mov_b32 v68, v12
    v_fma_f32 v92, v85, v90, v68
    v_fma_f32 v93, v85, v91, v69
    v_fma_f32 v92, -v86, v91, v92
    v_fma_f32 v91, v86, v90, v93
    v_mov_b32 v90, v92
    v_mul_f32 v12, v87, v70
    v_mul_f32 v13, v87, v71
    v_fma_f32 v12, -v88, v71, v12
    v_fma_f32 v71, v88, v70, v13
    v_mov_b32 v70, v12
    v_fma_f32 v92, v85, v90, v70
    v_fma_f32 v93, v85, v91, v71
    v_fma_f32 v92, -v86, v91, v92
    v_fma_f32 v91, v86, v90, v93
    v_mov_b32 v90, v92
    v_mul_f32 v12, v87, v72
    v_mul_f32 v13, v87, v73
    v_fma_f32 v12, -v88, v73, v12
    v_fma_f32 v73, v88, v72, v13
    v_mov_b32 v72, v12
    v_fma_f32 v92, v85, v90, v72
    v_fma_f32 v93, v85, v91, v73
    v_fma_f32 v92, -v86, v91, v92
    v_fma_f32 v91, v86, v90, v93
    v_mov_b32 v90, v92
    v_mul_f32 v12, v87, v74
    v_mul_f32 v13, v87, v75
    v_fma_f32 v12, -v88, v75, v12
    v_fma_f32 v75, v88, v74, v13
    v_mov_b32 v74, v12
    v_fma_f32 v92, v85, v90, v74
    v_fma_f32 v93, v85, v91, v75
    v_fma_f32 v92, -v86, v91, v92
    v_fma_f32 v91, v86, v90, v93
    v_mov_b32 v90, v92
    v_mul_f32 v12, v87, v76
    v_mul_f32 v13, v87, v77
    v_fma_f32 v12, -v88, v77, v12
    v_fma_f32 v77, v88, v76, v13
    v_mov_b32 v76, v12
    v_fma_f32 v92, v85, v90, v76
    v_fma_f32 v93, v85, v91, v77
    v_fma_f32 v92, -v86, v91, v92
    v_fma_f32 v91, v86, v90, v93
    v_mov_b32 v90, v92
    v_mul_f32 v12, v87, v78
    v_mul_f32 v13, v87, v79
    v_fma_f32 v12, -v88, v79, v12
    v_fma_f32 v79, v88, v78, v13
    v_mov_b32 v78, v12
    v_fma_f32 v92, v85, v90, v78
    v_fma_f32 v93, v85, v91, v79
    v_fma_f32 v92, -v86, v91, v92
    v_fma_f32 v91, v86, v90, v93
    v_mov_b32 v90, v92
    v_mul_f32 v12, v87, v80
    v_mul_f32 v13, v87, v81
    v_fma_f32 v12, -v88, v81, v12
    v_fma_f32 v81, v88, v80, v13
    v_mov_b32 v80, v12
    v_fma_f32 v92, v85, v90, v80
    v_fma_f32 v93, v85, v91, v81
    v_fma_f32 v92, -v86, v91, v92
    v_fma_f32 v91, v86, v90, v93
    v_mov_b32 v90, v92
    v_mul_f32 v12, v87, v82
    v_mul_f32 v13, v87, v83
    v_fma_f32 v12, -v88, v83, v12
    v_fma_f32 v83, v88, v82, v13
    v_mov_b32 v82, v12
    v_fma_f32 v92, v85, v90, v82
    v_fma_f32 v93, v85, v91, v83
    v_fma_f32 v92, -v86, v91, v92
    v_fma_f32 v91, v86, v90, v93
    v_mov_b32 v90, v92
    s_mul_i32 s26, s24, 3584
    s_mul_i32 s27, s25, 1792
    s_add_u32 s26, s26, s27
    s_add_u32 s26, s26, 92930048
    v_lshlrev_b32 v8, 3, v0
    buffer_store_dwordx2 v[90:91], v8, s[4:7], s26 offen sc1
    s_lshl_b32 s26, s24, 7
    s_add_u32 s26, s26, 100540416
    v_mov_b32 v15, 0
    v_mov_b32 v19, 1
    s_waitcnt vmcnt(0)
    s_mov_b64 s[38:39], exec
    s_mov_b64 exec, 1
    buffer_atomic_add v19, v15, s[4:7], s26 offen
    s_mov_b64 exec, s[38:39]
    v_mov_b32 v94, v85
    v_mov_b32 v95, v86
    v_mul_f32 v12, v94, v94
    v_mul_f32 v13, v94, v95
    v_fma_f32 v94, -v95, v95, v12
    v_add_f32 v95, v13, v13
    v_mul_f32 v12, v94, v94
    v_mul_f32 v13, v94, v95
    v_fma_f32 v94, -v95, v95, v12
    v_add_f32 v95, v13, v13
    v_mul_f32 v12, v94, v94
    v_mul_f32 v13, v94, v95
    v_fma_f32 v94, -v95, v95, v12
    v_add_f32 v95, v13, v13
    v_mul_f32 v12, v94, v94
    v_mul_f32 v13, v94, v95
    v_fma_f32 v94, -v95, v95, v12
    v_add_f32 v95, v13, v13
    v_mul_f32 v12, v94, v94
    v_mul_f32 v13, v94, v95
    v_fma_f32 v94, -v95, v95, v12
    v_add_f32 v95, v13, v13
    v_mov_b32 v90, 0
    v_mov_b32 v91, 0
    s_cmp_eq_u32 s24, 0
    s_cbranch_scc1 S5_NOC
    s_mov_b64 exec, s[36:37]
    v_lshlrev_b32 v9, 7, v1
    v_cmp_gt_u32 vcc, s24, v1
    v_mov_b32 v11, 0
    v_mov_b32 v12, 8
    s_nop 0
    v_cndmask_b32 v11, v11, v12, vcc
    s_mov_b32 s26, 100540416
S5_CE:
    buffer_load_dword v10, v9, s[4:7], s26 offen sc1
    s_waitcnt vmcnt(0)
    v_cmp_lt_u32 vcc, v10, v11
    s_cbranch_vccz S5_CE_ok
    s_sub_u32 s23, s23, 1
    s_cmp_gt_i32 s23, 0
    s_cbranch_scc1 S5_CE
S5_CE_ok:
    v_cmp_gt_u32 vcc, 224, v0
    s_and_saveexec_b64 s[36:37], vcc
    s_mul_i32 s26, s25, 1792
    s_add_u32 s26, s26, 92930048
    s_mov_b32 s27, 0
S5_CL:
    buffer_load_dwordx2 v[96:97], v8, s[4:7], s26 offen sc1
    s_add_u32 s26, s26, 3584
    buffer_load_dwordx2 v[98:99], v8, s[4:7], s26 offen sc1
    s_add_u32 s26, s26, 3584
    buffer_load_dwordx2 v[100:101], v8, s[4:7], s26 offen sc1
    s_add_u32 s26, s26, 3584
    buffer_load_dwordx2 v[102:103], v8, s[4:7], s26 offen sc1
    s_add_u32 s26, s26, 3584
    buffer_load_dwordx2 v[104:105], v8, s[4:7], s26 offen sc1
    s_add_u32 s26, s26, 3584
    buffer_load_dwordx2 v[106:107], v8, s[4:7], s26 offen sc1
    s_add_u32 s26, s26, 3584
    buffer_load_dwordx2 v[108:109], v8, s[4:7], s26 offen sc1
    s_add_u32 s26, s26, 3584
    buffer_load_dwordx2 v[110:111], v8, s[4:7], s26 offen sc1
    s_add_u32 s26, s26, 3584
    s_waitcnt vmcnt(0)
    v_fma_f32 v12, v94, v90, v96
    v_fma_f32 v13, v94, v91, v97
    v_fma_f32 v12, -v95, v91, v12
    v_fma_f32 v91, v95, v90, v13
    v_mov_b32 v90, v12
    s_add_u32 s27, s27, 1
    s_cmp_ge_u32 s27, s24
    s_cbranch_scc1 S5_NOC
    v_fma_f32 v12, v94, v90, v98
    v_fma_f32 v13, v94, v91, v99
    v_fma_f32 v12, -v95, v91, v12
    v_fma_f32 v91, v95, v90, v13
    v_mov_b32 v90, v12
    s_add_u32 s27, s27, 1
    s_cmp_ge_u32 s27, s24
    s_cbranch_scc1 S5_NOC
    v_fma_f32 v12, v94, v90, v100
    v_fma_f32 v13, v94, v91, v101
    v_fma_f32 v12, -v95, v91, v12
    v_fma_f32 v91, v95, v90, v13
    v_mov_b32 v90, v12
    s_add_u32 s27, s27, 1
    s_cmp_ge_u32 s27, s24
    s_cbranch_scc1 S5_NOC
    v_fma_f32 v12, v94, v90, v102
    v_fma_f32 v13, v94, v91, v103
    v_fma_f32 v12, -v95, v91, v12
    v_fma_f32 v91, v95, v90, v13
    v_mov_b32 v90, v12
    s_add_u32 s27, s27, 1
    s_cmp_ge_u32 s27, s24
    s_cbranch_scc1 S5_NOC
    v_fma_f32 v12, v94, v90, v104
    v_fma_f32 v13, v94, v91, v105
    v_fma_f32 v12, -v95, v91, v12
    v_fma_f32 v91, v95, v90, v13
    v_mov_b32 v90, v12
    s_add_u32 s27, s27, 1
    s_cmp_ge_u32 s27, s24
    s_cbranch_scc1 S5_NOC
    v_fma_f32 v12, v94, v90, v106
    v_fma_f32 v13, v94, v91, v107
    v_fma_f32 v12, -v95, v91, v12
    v_fma_f32 v91, v95, v90, v13
    v_mov_b32 v90, v12
    s_add_u32 s27, s27, 1
    s_cmp_ge_u32 s27, s24
    s_cbranch_scc1 S5_NOC
    v_fma_f32 v12, v94, v90, v108
    v_fma_f32 v13, v94, v91, v109
    v_fma_f32 v12, -v95, v91, v12
    v_fma_f32 v91, v95, v90, v13
    v_mov_b32 v90, v12
    s_add_u32 s27, s27, 1
    s_cmp_ge_u32 s27, s24
    s_cbranch_scc1 S5_NOC
    v_fma_f32 v12, v94, v90, v110
    v_fma_f32 v13, v94, v91, v111
    v_fma_f32 v12, -v95, v91, v12
    v_fma_f32 v91, v95, v90, v13
    v_mov_b32 v90, v12
    s_add_u32 s27, s27, 1
    s_cmp_ge_u32 s27, s24
    s_cbranch_scc1 S5_NOC
    s_branch S5_CL
S5_NOC:
    s_mov_b64 exec, s[36:37]
    s_barrier
    v_cmp_gt_u32 vcc, 224, v0
    s_and_saveexec_b64 s[36:37], vcc
    v_lshlrev_b32 v7, 1, v0
    v_fma_f32 v92, v85, v90, v20
    v_fma_f32 v93, v85, v91, v21
    v_fma_f32 v92, -v86, v91, v92
    v_fma_f32 v91, v86, v90, v93
    v_mov_b32 v90, v92
    v_cvt_pk_bf16_f32 v12, v90, -v91
    ds_write_b16 v7, v12 offset:0
    ds_write_b16_d16_hi v7, v12 offset:448
    v_fma_f32 v92, v85, v90, v22
    v_fma_f32 v93, v85, v91, v23
    v_fma_f32 v92, -v86, v91, v92
    v_fma_f32 v91, v86, v90, v93
    v_mov_b32 v90, v92
    v_cvt_pk_bf16_f32 v12, v90, -v91
    ds_write_b16 v7, v12 offset:912
    ds_write_b16_d16_hi v7, v12 offset:1360
    v_fma_f32 v92, v85, v90, v24
    v_fma_f32 v93, v85, v91, v25
    v_fma_f32 v92, -v86, v91, v92
    v_fma_f32 v91, v86, v90, v93
    v_mov_b32 v90, v92
    v_cvt_pk_bf16_f32 v12, v90, -v91
    ds_write_b16 v7, v12 offset:1824
    ds_write_b16_d16_hi v7, v12 offset:2272
    v_fma_f32 v92, v85, v90, v26
    v_fma_f32 v93, v85, v91, v27
    v_fma_f32 v92, -v86, v91, v92
    v_fma_f32 v91, v86, v90, v93
    v_mov_b32 v90, v92
    v_cvt_pk_bf16_f32 v12, v90, -v91
    ds_write_b16 v7, v12 offset:2736
    ds_write_b16_d16_hi v7, v12 offset:3184
    v_fma_f32 v92, v85, v90, v28
    v_fma_f32 v93, v85, v91, v29
    v_fma_f32 v92, -v86, v91, v92
    v_fma_f32 v91, v86, v90, v93
    v_mov_b32 v90, v92
    v_cvt_pk_bf16_f32 v12, v90, -v91
    ds_write_b16 v7, v12 offset:3648
    ds_write_b16_d16_hi v7, v12 offset:4096
    v_fma_f32 v92, v85, v90, v30
    v_fma_f32 v93, v85, v91, v31
    v_fma_f32 v92, -v86, v91, v92
    v_fma_f32 v91, v86, v90, v93
    v_mov_b32 v90, v92
    v_cvt_pk_bf16_f32 v12, v90, -v91
    ds_write_b16 v7, v12 offset:4560
    ds_write_b16_d16_hi v7, v12 offset:5008
    v_fma_f32 v92, v85, v90, v32
    v_fma_f32 v93, v85, v91, v33
    v_fma_f32 v92, -v86, v91, v92
    v_fma_f32 v91, v86, v90, v93
    v_mov_b32 v90, v92
    v_cvt_pk_bf16_f32 v12, v90, -v91
    ds_write_b16 v7, v12 offset:5472
    ds_write_b16_d16_hi v7, v12 offset:5920
    v_fma_f32 v92, v85, v90, v34
    v_fma_f32 v93, v85, v91, v35
    v_fma_f32 v92, -v86, v91, v92
    v_fma_f32 v91, v86, v90, v93
    v_mov_b32 v90, v92
    v_cvt_pk_bf16_f32 v12, v90, -v91
    ds_write_b16 v7, v12 offset:6384
    ds_write_b16_d16_hi v7, v12 offset:6832
    v_fma_f32 v92, v85, v90, v36
    v_fma_f32 v93, v85, v91, v37
    v_fma_f32 v92, -v86, v91, v92
    v_fma_f32 v91, v86, v90, v93
    v_mov_b32 v90, v92
    v_cvt_pk_bf16_f32 v12, v90, -v91
    ds_write_b16 v7, v12 offset:7296
    ds_write_b16_d16_hi v7, v12 offset:7744
    v_fma_f32 v92, v85, v90, v38
    v_fma_f32 v93, v85, v91, v39
    v_fma_f32 v92, -v86, v91, v92
    v_fma_f32 v91, v86, v90, v93
    v_mov_b32 v90, v92
    v_cvt_pk_bf16_f32 v12, v90, -v91
    ds_write_b16 v7, v12 offset:8208
    ds_write_b16_d16_hi v7, v12 offset:8656
    v_fma_f32 v92, v85, v90, v40
    v_fma_f32 v93, v85, v91, v41
    v_fma_f32 v92, -v86, v91, v92
    v_fma_f32 v91, v86, v90, v93
    v_mov_b32 v90, v92
    v_cvt_pk_bf16_f32 v12, v90, -v91
    ds_write_b16 v7, v12 offset:9120
    ds_write_b16_d16_hi v7, v12 offset:9568
    v_fma_f32 v92, v85, v90, v42
    v_fma_f32 v93, v85, v91, v43
    v_fma_f32 v92, -v86, v91, v92
    v_fma_f32 v91, v86, v90, v93
    v_mov_b32 v90, v92
    v_cvt_pk_bf16_f32 v12, v90, -v91
    ds_write_b16 v7, v12 offset:10032
    ds_write_b16_d16_hi v7, v12 offset:10480
    v_fma_f32 v92, v85, v90, v44
    v_fma_f32 v93, v85, v91, v45
    v_fma_f32 v92, -v86, v91, v92
    v_fma_f32 v91, v86, v90, v93
    v_mov_b32 v90, v92
    v_cvt_pk_bf16_f32 v12, v90, -v91
    ds_write_b16 v7, v12 offset:10944
    ds_write_b16_d16_hi v7, v12 offset:11392
    v_fma_f32 v92, v85, v90, v46
    v_fma_f32 v93, v85, v91, v47
    v_fma_f32 v92, -v86, v91, v92
    v_fma_f32 v91, v86, v90, v93
    v_mov_b32 v90, v92
    v_cvt_pk_bf16_f32 v12, v90, -v91
    ds_write_b16 v7, v12 offset:11856
    ds_write_b16_d16_hi v7, v12 offset:12304
    v_fma_f32 v92, v85, v90, v48
    v_fma_f32 v93, v85, v91, v49
    v_fma_f32 v92, -v86, v91, v92
    v_fma_f32 v91, v86, v90, v93
    v_mov_b32 v90, v92
    v_cvt_pk_bf16_f32 v12, v90, -v91
    ds_write_b16 v7, v12 offset:12768
    ds_write_b16_d16_hi v7, v12 offset:13216
    v_fma_f32 v92, v85, v90, v50
    v_fma_f32 v93, v85, v91, v51
    v_fma_f32 v92, -v86, v91, v92
    v_fma_f32 v91, v86, v90, v93
    v_mov_b32 v90, v92
    v_cvt_pk_bf16_f32 v12, v90, -v91
    ds_write_b16 v7, v12 offset:13680
    ds_write_b16_d16_hi v7, v12 offset:14128
    v_fma_f32 v92, v85, v90, v52
    v_fma_f32 v93, v85, v91, v53
    v_fma_f32 v92, -v86, v91, v92
    v_fma_f32 v91, v86, v90, v93
    v_mov_b32 v90, v92
    v_cvt_pk_bf16_f32 v12, v90, -v91
    ds_write_b16 v7, v12 offset:14592
    ds_write_b16_d16_hi v7, v12 offset:15040
    v_fma_f32 v92, v85, v90, v54
    v_fma_f32 v93, v85, v91, v55
    v_fma_f32 v92, -v86, v91, v92
    v_fma_f32 v91, v86, v90, v93
    v_mov_b32 v90, v92
    v_cvt_pk_bf16_f32 v12, v90, -v91
    ds_write_b16 v7, v12 offset:15504
    ds_write_b16_d16_hi v7, v12 offset:15952
    v_fma_f32 v92, v85, v90, v56
    v_fma_f32 v93, v85, v91, v57
    v_fma_f32 v92, -v86, v91, v92
    v_fma_f32 v91, v86, v90, v93
    v_mov_b32 v90, v92
    v_cvt_pk_bf16_f32 v12, v90, -v91
    ds_write_b16 v7, v12 offset:16416
    ds_write_b16_d16_hi v7, v12 offset:16864
    v_fma_f32 v92, v85, v90, v58
    v_fma_f32 v93, v85, v91, v59
    v_fma_f32 v92, -v86, v91, v92
    v_fma_f32 v91, v86, v90, v93
    v_mov_b32 v90, v92
    v_cvt_pk_bf16_f32 v12, v90, -v91
    ds_write_b16 v7, v12 offset:17328
    ds_write_b16_d16_hi v7, v12 offset:17776
    v_fma_f32 v92, v85, v90, v60
    v_fma_f32 v93, v85, v91, v61
    v_fma_f32 v92, -v86, v91, v92
    v_fma_f32 v91, v86, v90, v93
    v_mov_b32 v90, v92
    v_cvt_pk_bf16_f32 v12, v90, -v91
    ds_write_b16 v7, v12 offset:18240
    ds_write_b16_d16_hi v7, v12 offset:18688
    v_fma_f32 v92, v85, v90, v62
    v_fma_f32 v93, v85, v91, v63
    v_fma_f32 v92, -v86, v91, v92
    v_fma_f32 v91, v86, v90, v93
    v_mov_b32 v90, v92
    v_cvt_pk_bf16_f32 v12, v90, -v91
    ds_write_b16 v7, v12 offset:19152
    ds_write_b16_d16_hi v7, v12 offset:19600
    v_fma_f32 v92, v85, v90, v64
    v_fma_f32 v93, v85, v91, v65
    v_fma_f32 v92, -v86, v91, v92
    v_fma_f32 v91, v86, v90, v93
    v_mov_b32 v90, v92
    v_cvt_pk_bf16_f32 v12, v90, -v91
    ds_write_b16 v7, v12 offset:20064
    ds_write_b16_d16_hi v7, v12 offset:20512
    v_fma_f32 v92, v85, v90, v66
    v_fma_f32 v93, v85, v91, v67
    v_fma_f32 v92, -v86, v91, v92
    v_fma_f32 v91, v86, v90, v93
    v_mov_b32 v90, v92
    v_cvt_pk_bf16_f32 v12, v90, -v91
    ds_write_b16 v7, v12 offset:20976
    ds_write_b16_d16_hi v7, v12 offset:21424
    v_fma_f32 v92, v85, v90, v68
    v_fma_f32 v93, v85, v91, v69
    v_fma_f32 v92, -v86, v91, v92
    v_fma_f32 v91, v86, v90, v93
    v_mov_b32 v90, v92
    v_cvt_pk_bf16_f32 v12, v90, -v91
    ds_write_b16 v7, v12 offset:21888
    ds_write_b16_d16_hi v7, v12 offset:22336
    v_fma_f32 v92, v85, v90, v70
    v_fma_f32 v93, v85, v91, v71
    v_fma_f32 v92, -v86, v91, v92
    v_fma_f32 v91, v86, v90, v93
    v_mov_b32 v90, v92
    v_cvt_pk_bf16_f32 v12, v90, -v91
    ds_write_b16 v7, v12 offset:22800
    ds_write_b16_d16_hi v7, v12 offset:23248
    v_fma_f32 v92, v85, v90, v72
    v_fma_f32 v93, v85, v91, v73
    v_fma_f32 v92, -v86, v91, v92
    v_fma_f32 v91, v86, v90, v93
    v_mov_b32 v90, v92
    v_cvt_pk_bf16_f32 v12, v90, -v91
    ds_write_b16 v7, v12 offset:23712
    ds_write_b16_d16_hi v7, v12 offset:24160
    v_fma_f32 v92, v85, v90, v74
    v_fma_f32 v93, v85, v91, v75
    v_fma_f32 v92, -v86, v91, v92
    v_fma_f32 v91, v86, v90, v93
    v_mov_b32 v90, v92
    v_cvt_pk_bf16_f32 v12, v90, -v91
    ds_write_b16 v7, v12 offset:24624
    ds_write_b16_d16_hi v7, v12 offset:25072
    v_fma_f32 v92, v85, v90, v76
    v_fma_f32 v93, v85, v91, v77
    v_fma_f32 v92, -v86, v91, v92
    v_fma_f32 v91, v86, v90, v93
    v_mov_b32 v90, v92
    v_cvt_pk_bf16_f32 v12, v90, -v91
    ds_write_b16 v7, v12 offset:25536
    ds_write_b16_d16_hi v7, v12 offset:25984
    v_fma_f32 v92, v85, v90, v78
    v_fma_f32 v93, v85, v91, v79
    v_fma_f32 v92, -v86, v91, v92
    v_fma_f32 v91, v86, v90, v93
    v_mov_b32 v90, v92
    v_cvt_pk_bf16_f32 v12, v90, -v91
    ds_write_b16 v7, v12 offset:26448
    ds_write_b16_d16_hi v7, v12 offset:26896
    v_fma_f32 v92, v85, v90, v80
    v_fma_f32 v93, v85, v91, v81
    v_fma_f32 v92, -v86, v91, v92
    v_fma_f32 v91, v86, v90, v93
    v_mov_b32 v90, v92
    v_cvt_pk_bf16_f32 v12, v90, -v91
    ds_write_b16 v7, v12 offset:27360
    ds_write_b16_d16_hi v7, v12 offset:27808
    v_fma_f32 v92, v85, v90, v82
    v_fma_f32 v93, v85, v91, v83
    v_fma_f32 v92, -v86, v91, v92
    v_fma_f32 v91, v86, v90, v93
    v_mov_b32 v90, v92
    v_cvt_pk_bf16_f32 v12, v90, -v91
    ds_write_b16 v7, v12 offset:28272
    ds_write_b16_d16_hi v7, v12 offset:28720
    s_mov_b64 exec, s[36:37]
    s_waitcnt lgkmcnt(0)
    s_barrier
    v_mul_u32_u24 v7, 912, v3
    v_lshl_add_u32 v7, v4, 4, v7
    ds_read_b128 v[20:23], v7 offset:0
    ds_read_b128 v[24:27], v7 offset:64
    ds_read_b128 v[28:31], v7 offset:128
    ds_read_b128 v[32:35], v7 offset:192
    ds_read_b128 v[36:39], v7 offset:256
    ds_read_b128 v[40:43], v7 offset:320
    ds_read_b128 v[44:47], v7 offset:384
    ds_read_b128 v[48:51], v7 offset:448
    ds_read_b128 v[52:55], v7 offset:512
    ds_read_b128 v[56:59], v7 offset:576
    ds_read_b128 v[60:63], v7 offset:640
    ds_read_b128 v[64:67], v7 offset:704
    ds_read_b128 v[68:71], v7 offset:768
    ds_read_b128 v[72:75], v7 offset:832
    ds_read_b128 v[76:79], v7 offset:14592
    ds_read_b128 v[80:83], v7 offset:14656
    ds_read_b128 v[84:87], v7 offset:14720
    ds_read_b128 v[88:91], v7 offset:14784
    ds_read_b128 v[92:95], v7 offset:14848
    ds_read_b128 v[96:99], v7 offset:14912
    ds_read_b128 v[100:103], v7 offset:14976
    ds_read_b128 v[104:107], v7 offset:15040
    ds_read_b128 v[108:111], v7 offset:15104
    ds_read_b128 v[112:115], v7 offset:15168
    ds_read_b128 v[116:119], v7 offset:15232
    ds_read_b128 v[120:123], v7 offset:15296
    ds_read_b128 v[124:127], v7 offset:15360
    ds_read_b128 v[128:131], v7 offset:15424
    v_mov_b32 v132, 0
    v_mov_b32 v133, 0
    v_mov_b32 v134, 0
    v_mov_b32 v135, 0
    v_mov_b32 v136, 0
    v_mov_b32 v137, 0
    v_mov_b32 v138, 0
    v_mov_b32 v139, 0
    v_mov_b32 v140, 0
    v_mov_b32 v141, 0
    v_mov_b32 v142, 0
    v_mov_b32 v143, 0
    v_mov_b32 v144, 0
    v_mov_b32 v145, 0
    v_mov_b32 v146, 0
    v_mov_b32 v147, 0
    v_mov_b32 v148, 0
    v_mov_b32 v149, 0
    v_mov_b32 v150, 0
    v_mov_b32 v151, 0
    v_mov_b32 v152, 0
    v_mov_b32 v153, 0
    v_mov_b32 v154, 0
    v_mov_b32 v155, 0
    v_mov_b32 v156, 0
    v_mov_b32 v157, 0
    v_mov_b32 v158, 0
    v_mov_b32 v159, 0
    v_mov_b32 v160, 0
    v_mov_b32 v161, 0
    v_mov_b32 v162, 0
    v_mov_b32 v163, 0
    v_mov_b32 v164, 0
    v_mov_b32 v165, 0
    v_mov_b32 v166, 0
    v_mov_b32 v167, 0
    v_mov_b32 v168, 0
    v_mov_b32 v169, 0
    v_mov_b32 v170, 0
    v_mov_b32 v171, 0
    v_mov_b32 v172, 0
    v_mov_b32 v173, 0
    v_mov_b32 v174, 0
    v_mov_b32 v175, 0
    v_mov_b32 v176, 0
    v_mov_b32 v177, 0
    v_mov_b32 v178, 0
    v_mov_b32 v179, 0
    v_mov_b32 v180, 0
    v_mov_b32 v181, 0
    v_mov_b32 v182, 0
    v_mov_b32 v183, 0
    v_mov_b32 v184, 0
    v_mov_b32 v185, 0
    v_mov_b32 v186, 0
    v_mov_b32 v187, 0
    s_waitcnt vmcnt(0) lgkmcnt(0)
    v_mfma_f32_16x16x32_bf16 v[132:135], a[0:3], v[20:23], v[132:135]
    v_mfma_f32_16x16x32_bf16 v[136:139], a[0:3], v[76:79], v[136:139]
    v_mfma_f32_16x16x32_bf16 v[140:143], a[4:7], v[20:23], v[140:143]
    v_mfma_f32_16x16x32_bf16 v[144:147], a[4:7], v[76:79], v[144:147]
    v_mfma_f32_16x16x32_bf16 v[148:151], a[8:11], v[20:23], v[148:151]
    v_mfma_f32_16x16x32_bf16 v[152:155], a[8:11], v[76:79], v[152:155]
    v_mfma_f32_16x16x32_bf16 v[156:159], a[12:15], v[20:23], v[156:159]
    v_mfma_f32_16x16x32_bf16 v[160:163], a[12:15], v[76:79], v[160:163]
    v_mfma_f32_16x16x32_bf16 v[164:167], a[16:19], v[20:23], v[164:167]
    v_mfma_f32_16x16x32_bf16 v[168:171], a[16:19], v[76:79], v[168:171]
    v_mfma_f32_16x16x32_bf16 v[172:175], a[20:23], v[20:23], v[172:175]
    v_mfma_f32_16x16x32_bf16 v[176:179], a[20:23], v[76:79], v[176:179]
    v_mfma_f32_16x16x32_bf16 v[180:183], a[24:27], v[20:23], v[180:183]
    v_mfma_f32_16x16x32_bf16 v[184:187], a[24:27], v[76:79], v[184:187]
    buffer_load_dwordx4 a[0:3], v6, s[48:51], s80 offen offset:0
    buffer_load_dwordx4 a[4:7], v6, s[48:51], s81 offen offset:0
    buffer_load_dwordx4 a[8:11], v6, s[48:51], s82 offen offset:0
    buffer_load_dwordx4 a[12:15], v6, s[48:51], s83 offen offset:0
    buffer_load_dwordx4 a[16:19], v6, s[48:51], s84 offen offset:0
    buffer_load_dwordx4 a[20:23], v6, s[48:51], s85 offen offset:0
    buffer_load_dwordx4 a[24:27], v6, s[48:51], s86 offen offset:0
    v_mfma_f32_16x16x32_bf16 v[132:135], a[28:31], v[24:27], v[132:135]
    v_mfma_f32_16x16x32_bf16 v[136:139], a[28:31], v[80:83], v[136:139]
    v_mfma_f32_16x16x32_bf16 v[140:143], a[32:35], v[24:27], v[140:143]
    v_mfma_f32_16x16x32_bf16 v[144:147], a[32:35], v[80:83], v[144:147]
    v_mfma_f32_16x16x32_bf16 v[148:151], a[36:39], v[24:27], v[148:151]
    v_mfma_f32_16x16x32_bf16 v[152:155], a[36:39], v[80:83], v[152:155]
    v_mfma_f32_16x16x32_bf16 v[156:159], a[40:43], v[24:27], v[156:159]
    v_mfma_f32_16x16x32_bf16 v[160:163], a[40:43], v[80:83], v[160:163]
    v_mfma_f32_16x16x32_bf16 v[164:167], a[44:47], v[24:27], v[164:167]
    v_mfma_f32_16x16x32_bf16 v[168:171], a[44:47], v[80:83], v[168:171]
    v_mfma_f32_16x16x32_bf16 v[172:175], a[48:51], v[24:27], v[172:175]
    v_mfma_f32_16x16x32_bf16 v[176:179], a[48:51], v[80:83], v[176:179]
    v_mfma_f32_16x16x32_bf16 v[180:183], a[52:55], v[24:27], v[180:183]
    v_mfma_f32_16x16x32_bf16 v[184:187], a[52:55], v[80:83], v[184:187]
    buffer_load_dwordx4 a[28:31], v6, s[48:51], s80 offen offset:64
    buffer_load_dwordx4 a[32:35], v6, s[48:51], s81 offen offset:64
    buffer_load_dwordx4 a[36:39], v6, s[48:51], s82 offen offset:64
    buffer_load_dwordx4 a[40:43], v6, s[48:51], s83 offen offset:64
    buffer_load_dwordx4 a[44:47], v6, s[48:51], s84 offen offset:64
    buffer_load_dwordx4 a[48:51], v6, s[48:51], s85 offen offset:64
    buffer_load_dwordx4 a[52:55], v6, s[48:51], s86 offen offset:64
    v_mfma_f32_16x16x32_bf16 v[132:135], a[56:59], v[28:31], v[132:135]
    v_mfma_f32_16x16x32_bf16 v[136:139], a[56:59], v[84:87], v[136:139]
    v_mfma_f32_16x16x32_bf16 v[140:143], a[60:63], v[28:31], v[140:143]
    v_mfma_f32_16x16x32_bf16 v[144:147], a[60:63], v[84:87], v[144:147]
    v_mfma_f32_16x16x32_bf16 v[148:151], a[64:67], v[28:31], v[148:151]
    v_mfma_f32_16x16x32_bf16 v[152:155], a[64:67], v[84:87], v[152:155]
    v_mfma_f32_16x16x32_bf16 v[156:159], a[68:71], v[28:31], v[156:159]
    v_mfma_f32_16x16x32_bf16 v[160:163], a[68:71], v[84:87], v[160:163]
    v_mfma_f32_16x16x32_bf16 v[164:167], a[72:75], v[28:31], v[164:167]
    v_mfma_f32_16x16x32_bf16 v[168:171], a[72:75], v[84:87], v[168:171]
    v_mfma_f32_16x16x32_bf16 v[172:175], a[76:79], v[28:31], v[172:175]
    v_mfma_f32_16x16x32_bf16 v[176:179], a[76:79], v[84:87], v[176:179]
    v_mfma_f32_16x16x32_bf16 v[180:183], a[80:83], v[28:31], v[180:183]
    v_mfma_f32_16x16x32_bf16 v[184:187], a[80:83], v[84:87], v[184:187]
    buffer_load_dwordx4 a[56:59], v6, s[48:51], s80 offen offset:128
    buffer_load_dwordx4 a[60:63], v6, s[48:51], s81 offen offset:128
    buffer_load_dwordx4 a[64:67], v6, s[48:51], s82 offen offset:128
    buffer_load_dwordx4 a[68:71], v6, s[48:51], s83 offen offset:128
    buffer_load_dwordx4 a[72:75], v6, s[48:51], s84 offen offset:128
    buffer_load_dwordx4 a[76:79], v6, s[48:51], s85 offen offset:128
    buffer_load_dwordx4 a[80:83], v6, s[48:51], s86 offen offset:128
    v_mfma_f32_16x16x32_bf16 v[132:135], a[84:87], v[32:35], v[132:135]
    v_mfma_f32_16x16x32_bf16 v[136:139], a[84:87], v[88:91], v[136:139]
    v_mfma_f32_16x16x32_bf16 v[140:143], a[88:91], v[32:35], v[140:143]
    v_mfma_f32_16x16x32_bf16 v[144:147], a[88:91], v[88:91], v[144:147]
    v_mfma_f32_16x16x32_bf16 v[148:151], a[92:95], v[32:35], v[148:151]
    v_mfma_f32_16x16x32_bf16 v[152:155], a[92:95], v[88:91], v[152:155]
    v_mfma_f32_16x16x32_bf16 v[156:159], a[96:99], v[32:35], v[156:159]
    v_mfma_f32_16x16x32_bf16 v[160:163], a[96:99], v[88:91], v[160:163]
    v_mfma_f32_16x16x32_bf16 v[164:167], a[100:103], v[32:35], v[164:167]
    v_mfma_f32_16x16x32_bf16 v[168:171], a[100:103], v[88:91], v[168:171]
    v_mfma_f32_16x16x32_bf16 v[172:175], a[104:107], v[32:35], v[172:175]
    v_mfma_f32_16x16x32_bf16 v[176:179], a[104:107], v[88:91], v[176:179]
    v_mfma_f32_16x16x32_bf16 v[180:183], a[108:111], v[32:35], v[180:183]
    v_mfma_f32_16x16x32_bf16 v[184:187], a[108:111], v[88:91], v[184:187]
    buffer_load_dwordx4 a[84:87], v6, s[48:51], s80 offen offset:192
    buffer_load_dwordx4 a[88:91], v6, s[48:51], s81 offen offset:192
    buffer_load_dwordx4 a[92:95], v6, s[48:51], s82 offen offset:192
    buffer_load_dwordx4 a[96:99], v6, s[48:51], s83 offen offset:192
    buffer_load_dwordx4 a[100:103], v6, s[48:51], s84 offen offset:192
    buffer_load_dwordx4 a[104:107], v6, s[48:51], s85 offen offset:192
    buffer_load_dwordx4 a[108:111], v6, s[48:51], s86 offen offset:192
    v_mfma_f32_16x16x32_bf16 v[132:135], a[112:115], v[36:39], v[132:135]
    v_mfma_f32_16x16x32_bf16 v[136:139], a[112:115], v[92:95], v[136:139]
    v_mfma_f32_16x16x32_bf16 v[140:143], a[116:119], v[36:39], v[140:143]
    v_mfma_f32_16x16x32_bf16 v[144:147], a[116:119], v[92:95], v[144:147]
    v_mfma_f32_16x16x32_bf16 v[148:151], a[120:123], v[36:39], v[148:151]
    v_mfma_f32_16x16x32_bf16 v[152:155], a[120:123], v[92:95], v[152:155]
    v_mfma_f32_16x16x32_bf16 v[156:159], a[124:127], v[36:39], v[156:159]
    v_mfma_f32_16x16x32_bf16 v[160:163], a[124:127], v[92:95], v[160:163]
    v_mfma_f32_16x16x32_bf16 v[164:167], a[128:131], v[36:39], v[164:167]
    v_mfma_f32_16x16x32_bf16 v[168:171], a[128:131], v[92:95], v[168:171]
    v_mfma_f32_16x16x32_bf16 v[172:175], a[132:135], v[36:39], v[172:175]
    v_mfma_f32_16x16x32_bf16 v[176:179], a[132:135], v[92:95], v[176:179]
    v_mfma_f32_16x16x32_bf16 v[180:183], a[136:139], v[36:39], v[180:183]
    v_mfma_f32_16x16x32_bf16 v[184:187], a[136:139], v[92:95], v[184:187]
    buffer_load_dwordx4 a[112:115], v6, s[48:51], s80 offen offset:256
    buffer_load_dwordx4 a[116:119], v6, s[48:51], s81 offen offset:256
    buffer_load_dwordx4 a[120:123], v6, s[48:51], s82 offen offset:256
    buffer_load_dwordx4 a[124:127], v6, s[48:51], s83 offen offset:256
    buffer_load_dwordx4 a[128:131], v6, s[48:51], s84 offen offset:256
    buffer_load_dwordx4 a[132:135], v6, s[48:51], s85 offen offset:256
    buffer_load_dwordx4 a[136:139], v6, s[48:51], s86 offen offset:256
    v_mfma_f32_16x16x32_bf16 v[132:135], a[140:143], v[40:43], v[132:135]
    v_mfma_f32_16x16x32_bf16 v[136:139], a[140:143], v[96:99], v[136:139]
    v_mfma_f32_16x16x32_bf16 v[140:143], a[144:147], v[40:43], v[140:143]
    v_mfma_f32_16x16x32_bf16 v[144:147], a[144:147], v[96:99], v[144:147]
    v_mfma_f32_16x16x32_bf16 v[148:151], a[148:151], v[40:43], v[148:151]
    v_mfma_f32_16x16x32_bf16 v[152:155], a[148:151], v[96:99], v[152:155]
    v_mfma_f32_16x16x32_bf16 v[156:159], a[152:155], v[40:43], v[156:159]
    v_mfma_f32_16x16x32_bf16 v[160:163], a[152:155], v[96:99], v[160:163]
    v_mfma_f32_16x16x32_bf16 v[164:167], a[156:159], v[40:43], v[164:167]
    v_mfma_f32_16x16x32_bf16 v[168:171], a[156:159], v[96:99], v[168:171]
    v_mfma_f32_16x16x32_bf16 v[172:175], a[160:163], v[40:43], v[172:175]
    v_mfma_f32_16x16x32_bf16 v[176:179], a[160:163], v[96:99], v[176:179]
    v_mfma_f32_16x16x32_bf16 v[180:183], a[164:167], v[40:43], v[180:183]
    v_mfma_f32_16x16x32_bf16 v[184:187], a[164:167], v[96:99], v[184:187]
    buffer_load_dwordx4 a[140:143], v6, s[48:51], s80 offen offset:320
    buffer_load_dwordx4 a[144:147], v6, s[48:51], s81 offen offset:320
    buffer_load_dwordx4 a[148:151], v6, s[48:51], s82 offen offset:320
    buffer_load_dwordx4 a[152:155], v6, s[48:51], s83 offen offset:320
    buffer_load_dwordx4 a[156:159], v6, s[48:51], s84 offen offset:320
    buffer_load_dwordx4 a[160:163], v6, s[48:51], s85 offen offset:320
    buffer_load_dwordx4 a[164:167], v6, s[48:51], s86 offen offset:320
    v_mfma_f32_16x16x32_bf16 v[132:135], a[168:171], v[44:47], v[132:135]
    v_mfma_f32_16x16x32_bf16 v[136:139], a[168:171], v[100:103], v[136:139]
    v_mfma_f32_16x16x32_bf16 v[140:143], a[172:175], v[44:47], v[140:143]
    v_mfma_f32_16x16x32_bf16 v[144:147], a[172:175], v[100:103], v[144:147]
    v_mfma_f32_16x16x32_bf16 v[148:151], a[176:179], v[44:47], v[148:151]
    v_mfma_f32_16x16x32_bf16 v[152:155], a[176:179], v[100:103], v[152:155]
    v_mfma_f32_16x16x32_bf16 v[156:159], a[180:183], v[44:47], v[156:159]
    v_mfma_f32_16x16x32_bf16 v[160:163], a[180:183], v[100:103], v[160:163]
    v_mfma_f32_16x16x32_bf16 v[164:167], a[184:187], v[44:47], v[164:167]
    v_mfma_f32_16x16x32_bf16 v[168:171], a[184:187], v[100:103], v[168:171]
    v_mfma_f32_16x16x32_bf16 v[172:175], a[188:191], v[44:47], v[172:175]
    v_mfma_f32_16x16x32_bf16 v[176:179], a[188:191], v[100:103], v[176:179]
    v_mfma_f32_16x16x32_bf16 v[180:183], a[192:195], v[44:47], v[180:183]
    v_mfma_f32_16x16x32_bf16 v[184:187], a[192:195], v[100:103], v[184:187]
    buffer_load_dwordx4 a[168:171], v6, s[48:51], s80 offen offset:384
    buffer_load_dwordx4 a[172:175], v6, s[48:51], s81 offen offset:384
    buffer_load_dwordx4 a[176:179], v6, s[48:51], s82 offen offset:384
    buffer_load_dwordx4 a[180:183], v6, s[48:51], s83 offen offset:384
    buffer_load_dwordx4 a[184:187], v6, s[48:51], s84 offen offset:384
    buffer_load_dwordx4 a[188:191], v6, s[48:51], s85 offen offset:384
    buffer_load_dwordx4 a[192:195], v6, s[48:51], s86 offen offset:384
    s_waitcnt vmcnt(42)
    v_mfma_f32_16x16x32_bf16 v[132:135], a[0:3], v[48:51], v[132:135]
    v_mfma_f32_16x16x32_bf16 v[136:139], a[0:3], v[104:107], v[136:139]
    v_mfma_f32_16x16x32_bf16 v[140:143], a[4:7], v[48:51], v[140:143]
    v_mfma_f32_16x16x32_bf16 v[144:147], a[4:7], v[104:107], v[144:147]
    v_mfma_f32_16x16x32_bf16 v[148:151], a[8:11], v[48:51], v[148:151]
    v_mfma_f32_16x16x32_bf16 v[152:155], a[8:11], v[104:107], v[152:155]
    v_mfma_f32_16x16x32_bf16 v[156:159], a[12:15], v[48:51], v[156:159]
    v_mfma_f32_16x16x32_bf16 v[160:163], a[12:15], v[104:107], v[160:163]
    v_mfma_f32_16x16x32_bf16 v[164:167], a[16:19], v[48:51], v[164:167]
    v_mfma_f32_16x16x32_bf16 v[168:171], a[16:19], v[104:107], v[168:171]
    v_mfma_f32_16x16x32_bf16 v[172:175], a[20:23], v[48:51], v[172:175]
    v_mfma_f32_16x16x32_bf16 v[176:179], a[20:23], v[104:107], v[176:179]
    v_mfma_f32_16x16x32_bf16 v[180:183], a[24:27], v[48:51], v[180:183]
    v_mfma_f32_16x16x32_bf16 v[184:187], a[24:27], v[104:107], v[184:187]
    s_waitcnt vmcnt(35)
    v_mfma_f32_16x16x32_bf16 v[132:135], a[28:31], v[52:55], v[132:135]
    v_mfma_f32_16x16x32_bf16 v[136:139], a[28:31], v[108:111], v[136:139]
    v_mfma_f32_16x16x32_bf16 v[140:143], a[32:35], v[52:55], v[140:143]
    v_mfma_f32_16x16x32_bf16 v[144:147], a[32:35], v[108:111], v[144:147]
    v_mfma_f32_16x16x32_bf16 v[148:151], a[36:39], v[52:55], v[148:151]
    v_mfma_f32_16x16x32_bf16 v[152:155], a[36:39], v[108:111], v[152:155]
    v_mfma_f32_16x16x32_bf16 v[156:159], a[40:43], v[52:55], v[156:159]
    v_mfma_f32_16x16x32_bf16 v[160:163], a[40:43], v[108:111], v[160:163]
    v_mfma_f32_16x16x32_bf16 v[164:167], a[44:47], v[52:55], v[164:167]
    v_mfma_f32_16x16x32_bf16 v[168:171], a[44:47], v[108:111], v[168:171]
    v_mfma_f32_16x16x32_bf16 v[172:175], a[48:51], v[52:55], v[172:175]
    v_mfma_f32_16x16x32_bf16 v[176:179], a[48:51], v[108:111], v[176:179]
    v_mfma_f32_16x16x32_bf16 v[180:183], a[52:55], v[52:55], v[180:183]
    v_mfma_f32_16x16x32_bf16 v[184:187], a[52:55], v[108:111], v[184:187]
    s_waitcnt vmcnt(28)
    v_mfma_f32_16x16x32_bf16 v[132:135], a[56:59], v[56:59], v[132:135]
    v_mfma_f32_16x16x32_bf16 v[136:139], a[56:59], v[112:115], v[136:139]
    v_mfma_f32_16x16x32_bf16 v[140:143], a[60:63], v[56:59], v[140:143]
    v_mfma_f32_16x16x32_bf16 v[144:147], a[60:63], v[112:115], v[144:147]
    v_mfma_f32_16x16x32_bf16 v[148:151], a[64:67], v[56:59], v[148:151]
    v_mfma_f32_16x16x32_bf16 v[152:155], a[64:67], v[112:115], v[152:155]
    v_mfma_f32_16x16x32_bf16 v[156:159], a[68:71], v[56:59], v[156:159]
    v_mfma_f32_16x16x32_bf16 v[160:163], a[68:71], v[112:115], v[160:163]
    v_mfma_f32_16x16x32_bf16 v[164:167], a[72:75], v[56:59], v[164:167]
    v_mfma_f32_16x16x32_bf16 v[168:171], a[72:75], v[112:115], v[168:171]
    v_mfma_f32_16x16x32_bf16 v[172:175], a[76:79], v[56:59], v[172:175]
    v_mfma_f32_16x16x32_bf16 v[176:179], a[76:79], v[112:115], v[176:179]
    v_mfma_f32_16x16x32_bf16 v[180:183], a[80:83], v[56:59], v[180:183]
    v_mfma_f32_16x16x32_bf16 v[184:187], a[80:83], v[112:115], v[184:187]
    s_waitcnt vmcnt(21)
    v_mfma_f32_16x16x32_bf16 v[132:135], a[84:87], v[60:63], v[132:135]
    v_mfma_f32_16x16x32_bf16 v[136:139], a[84:87], v[116:119], v[136:139]
    v_mfma_f32_16x16x32_bf16 v[140:143], a[88:91], v[60:63], v[140:143]
    v_mfma_f32_16x16x32_bf16 v[144:147], a[88:91], v[116:119], v[144:147]
    v_mfma_f32_16x16x32_bf16 v[148:151], a[92:95], v[60:63], v[148:151]
    v_mfma_f32_16x16x32_bf16 v[152:155], a[92:95], v[116:119], v[152:155]
    v_mfma_f32_16x16x32_bf16 v[156:159], a[96:99], v[60:63], v[156:159]
    v_mfma_f32_16x16x32_bf16 v[160:163], a[96:99], v[116:119], v[160:163]
    v_mfma_f32_16x16x32_bf16 v[164:167], a[100:103], v[60:63], v[164:167]
    v_mfma_f32_16x16x32_bf16 v[168:171], a[100:103], v[116:119], v[168:171]
    v_mfma_f32_16x16x32_bf16 v[172:175], a[104:107], v[60:63], v[172:175]
    v_mfma_f32_16x16x32_bf16 v[176:179], a[104:107], v[116:119], v[176:179]
    v_mfma_f32_16x16x32_bf16 v[180:183], a[108:111], v[60:63], v[180:183]
    v_mfma_f32_16x16x32_bf16 v[184:187], a[108:111], v[116:119], v[184:187]
    s_waitcnt vmcnt(14)
    v_mfma_f32_16x16x32_bf16 v[132:135], a[112:115], v[64:67], v[132:135]
    v_mfma_f32_16x16x32_bf16 v[136:139], a[112:115], v[120:123], v[136:139]
    v_mfma_f32_16x16x32_bf16 v[140:143], a[116:119], v[64:67], v[140:143]
    v_mfma_f32_16x16x32_bf16 v[144:147], a[116:119], v[120:123], v[144:147]
    v_mfma_f32_16x16x32_bf16 v[148:151], a[120:123], v[64:67], v[148:151]
    v_mfma_f32_16x16x32_bf16 v[152:155], a[120:123], v[120:123], v[152:155]
    v_mfma_f32_16x16x32_bf16 v[156:159], a[124:127], v[64:67], v[156:159]
    v_mfma_f32_16x16x32_bf16 v[160:163], a[124:127], v[120:123], v[160:163]
    v_mfma_f32_16x16x32_bf16 v[164:167], a[128:131], v[64:67], v[164:167]
    v_mfma_f32_16x16x32_bf16 v[168:171], a[128:131], v[120:123], v[168:171]
    v_mfma_f32_16x16x32_bf16 v[172:175], a[132:135], v[64:67], v[172:175]
    v_mfma_f32_16x16x32_bf16 v[176:179], a[132:135], v[120:123], v[176:179]
    v_mfma_f32_16x16x32_bf16 v[180:183], a[136:139], v[64:67], v[180:183]
    v_mfma_f32_16x16x32_bf16 v[184:187], a[136:139], v[120:123], v[184:187]
    s_waitcnt vmcnt(7)
    v_mfma_f32_16x16x32_bf16 v[132:135], a[140:143], v[68:71], v[132:135]
    v_mfma_f32_16x16x32_bf16 v[136:139], a[140:143], v[124:127], v[136:139]
    v_mfma_f32_16x16x32_bf16 v[140:143], a[144:147], v[68:71], v[140:143]
    v_mfma_f32_16x16x32_bf16 v[144:147], a[144:147], v[124:127], v[144:147]
    v_mfma_f32_16x16x32_bf16 v[148:151], a[148:151], v[68:71], v[148:151]
    v_mfma_f32_16x16x32_bf16 v[152:155], a[148:151], v[124:127], v[152:155]
    v_mfma_f32_16x16x32_bf16 v[156:159], a[152:155], v[68:71], v[156:159]
    v_mfma_f32_16x16x32_bf16 v[160:163], a[152:155], v[124:127], v[160:163]
    v_mfma_f32_16x16x32_bf16 v[164:167], a[156:159], v[68:71], v[164:167]
    v_mfma_f32_16x16x32_bf16 v[168:171], a[156:159], v[124:127], v[168:171]
    v_mfma_f32_16x16x32_bf16 v[172:175], a[160:163], v[68:71], v[172:175]
    v_mfma_f32_16x16x32_bf16 v[176:179], a[160:163], v[124:127], v[176:179]
    v_mfma_f32_16x16x32_bf16 v[180:183], a[164:167], v[68:71], v[180:183]
    v_mfma_f32_16x16x32_bf16 v[184:187], a[164:167], v[124:127], v[184:187]
    s_waitcnt vmcnt(0)
    v_mfma_f32_16x16x32_bf16 v[132:135], a[168:171], v[72:75], v[132:135]
    v_mfma_f32_16x16x32_bf16 v[136:139], a[168:171], v[128:131], v[136:139]
    v_mfma_f32_16x16x32_bf16 v[140:143], a[172:175], v[72:75], v[140:143]
    v_mfma_f32_16x16x32_bf16 v[144:147], a[172:175], v[128:131], v[144:147]
    v_mfma_f32_16x16x32_bf16 v[148:151], a[176:179], v[72:75], v[148:151]
    v_mfma_f32_16x16x32_bf16 v[152:155], a[176:179], v[128:131], v[152:155]
    v_mfma_f32_16x16x32_bf16 v[156:159], a[180:183], v[72:75], v[156:159]
    v_mfma_f32_16x16x32_bf16 v[160:163], a[180:183], v[128:131], v[160:163]
    v_mfma_f32_16x16x32_bf16 v[164:167], a[184:187], v[72:75], v[164:167]
    v_mfma_f32_16x16x32_bf16 v[168:171], a[184:187], v[128:131], v[168:171]
    v_mfma_f32_16x16x32_bf16 v[172:175], a[188:191], v[72:75], v[172:175]
    v_mfma_f32_16x16x32_bf16 v[176:179], a[188:191], v[128:131], v[176:179]
    v_mfma_f32_16x16x32_bf16 v[180:183], a[192:195], v[72:75], v[180:183]
    v_mfma_f32_16x16x32_bf16 v[184:187], a[192:195], v[128:131], v[184:187]
    v_lshlrev_b32 v7, 2, v3
    ds_read_b32 v8, v7 offset:59392
    ds_read_b32 v9, v7 offset:59456
    s_nop 7
    v_add_f32 v132, v132, v132
    v_add_f32 v133, v133, v133
    v_add_f32 v134, v134, v134
    v_add_f32 v135, v135, v135
    v_add_f32 v136, v136, v136
    v_add_f32 v137, v137, v137
    v_add_f32 v138, v138, v138
    v_add_f32 v139, v139, v139
    v_add_f32 v140, v140, v140
    v_add_f32 v141, v141, v141
    v_add_f32 v142, v142, v142
    v_add_f32 v143, v143, v143
    v_add_f32 v144, v144, v144
    v_add_f32 v145, v145, v145
    v_add_f32 v146, v146, v146
    v_add_f32 v147, v147, v147
    v_add_f32 v148, v148, v148
    v_add_f32 v149, v149, v149
    v_add_f32 v150, v150, v150
    v_add_f32 v151, v151, v151
    v_add_f32 v152, v152, v152
    v_add_f32 v153, v153, v153
    v_add_f32 v154, v154, v154
    v_add_f32 v155, v155, v155
    v_add_f32 v156, v156, v156
    v_add_f32 v157, v157, v157
    v_add_f32 v158, v158, v158
    v_add_f32 v159, v159, v159
    v_add_f32 v160, v160, v160
    v_add_f32 v161, v161, v161
    v_add_f32 v162, v162, v162
    v_add_f32 v163, v163, v163
    v_add_f32 v164, v164, v164
    v_add_f32 v165, v165, v165
    v_add_f32 v166, v166, v166
    v_add_f32 v167, v167, v167
    v_add_f32 v168, v168, v168
    v_add_f32 v169, v169, v169
    v_add_f32 v170, v170, v170
    v_add_f32 v171, v171, v171
    v_add_f32 v172, v172, v172
    v_add_f32 v173, v173, v173
    v_add_f32 v174, v174, v174
    v_add_f32 v175, v175, v175
    v_add_f32 v176, v176, v176
    v_add_f32 v177, v177, v177
    v_add_f32 v178, v178, v178
    v_add_f32 v179, v179, v179
    v_add_f32 v180, v180, v180
    v_add_f32 v181, v181, v181
    v_add_f32 v182, v182, v182
    v_add_f32 v183, v183, v183
    v_add_f32 v184, v184, v184
    v_add_f32 v185, v185, v185
    v_add_f32 v186, v186, v186
    v_add_f32 v187, v187, v187
    s_cmp_eq_u32 s25, 0
    s_cbranch_scc0 S5_NOD
    s_load_dwordx2 s[52:53], s[0:1], 64
    s_waitcnt lgkmcnt(0)
    s_and_b32 s53, s53, 0xffff
    s_mov_b32 s54, 896
    s_mov_b32 s55, 0x00020000
    v_mul_u32_u24 v6, 896, v3
    v_lshl_add_u32 v6, v4, 3, v6
    v_lshlrev_b32 v7, 3, v4
    s_mul_i32 s26, s24, 28672
    s_mul_i32 s27, s20, 224
    s_add_u32 s26, s26, s27
    s_add_u32 s28, s26, 14336
    buffer_load_dwordx2 v[20:21], v6, s[56:59], s26 offen offset:0
    buffer_load_dwordx2 v[22:23], v6, s[56:59], s28 offen offset:0
    buffer_load_dwordx2 v[48:49], v7, s[52:55], s27 offen offset:0
    buffer_load_dwordx2 v[24:25], v6, s[56:59], s26 offen offset:32
    buffer_load_dwordx2 v[26:27], v6, s[56:59], s28 offen offset:32
    buffer_load_dwordx2 v[50:51], v7, s[52:55], s27 offen offset:32
    buffer_load_dwordx2 v[28:29], v6, s[56:59], s26 offen offset:64
    buffer_load_dwordx2 v[30:31], v6, s[56:59], s28 offen offset:64
    buffer_load_dwordx2 v[52:53], v7, s[52:55], s27 offen offset:64
    buffer_load_dwordx2 v[32:33], v6, s[56:59], s26 offen offset:96
    buffer_load_dwordx2 v[34:35], v6, s[56:59], s28 offen offset:96
    buffer_load_dwordx2 v[54:55], v7, s[52:55], s27 offen offset:96
    buffer_load_dwordx2 v[36:37], v6, s[56:59], s26 offen offset:128
    buffer_load_dwordx2 v[38:39], v6, s[56:59], s28 offen offset:128
    buffer_load_dwordx2 v[56:57], v7, s[52:55], s27 offen offset:128
    buffer_load_dwordx2 v[40:41], v6, s[56:59], s26 offen offset:160
    buffer_load_dwordx2 v[42:43], v6, s[56:59], s28 offen offset:160
    buffer_load_dwordx2 v[58:59], v7, s[52:55], s27 offen offset:160
    buffer_load_dwordx2 v[44:45], v6, s[56:59], s26 offen offset:192
    buffer_load_dwordx2 v[46:47], v6, s[56:59], s28 offen offset:192
    buffer_load_dwordx2 v[60:61], v7, s[52:55], s27 offen offset:192
    s_waitcnt vmcnt(0)
    v_lshlrev_b32 v10, 16, v20
    v_and_b32 v11, 0xffff0000, v20
    v_lshlrev_b32 v12, 16, v48
    v_and_b32 v13, 0xffff0000, v48
    v_mul_f32 v10, v10, v12
    v_mul_f32 v11, v11, v13
    v_cvt_pk_bf16_f32 v10, v10, v11
    v_and_b32 v11, 0xffff0000, v10
    v_lshlrev_b32 v10, 16, v10
    v_add_f32 v132, v132, v10
    v_add_f32 v133, v133, v11
    v_lshlrev_b32 v10, 16, v21
    v_and_b32 v11, 0xffff0000, v21
    v_lshlrev_b32 v12, 16, v49
    v_and_b32 v13, 0xffff0000, v49
    v_mul_f32 v10, v10, v12
    v_mul_f32 v11, v11, v13
    v_cvt_pk_bf16_f32 v10, v10, v11
    v_and_b32 v11, 0xffff0000, v10
    v_lshlrev_b32 v10, 16, v10
    v_add_f32 v134, v134, v10
    v_add_f32 v135, v135, v11
    v_lshlrev_b32 v10, 16, v22
    v_and_b32 v11, 0xffff0000, v22
    v_lshlrev_b32 v12, 16, v48
    v_and_b32 v13, 0xffff0000, v48
    v_mul_f32 v10, v10, v12
    v_mul_f32 v11, v11, v13
    v_cvt_pk_bf16_f32 v10, v10, v11
    v_and_b32 v11, 0xffff0000, v10
    v_lshlrev_b32 v10, 16, v10
    v_add_f32 v136, v136, v10
    v_add_f32 v137, v137, v11
    v_lshlrev_b32 v10, 16, v23
    v_and_b32 v11, 0xffff0000, v23
    v_lshlrev_b32 v12, 16, v49
    v_and_b32 v13, 0xffff0000, v49
    v_mul_f32 v10, v10, v12
    v_mul_f32 v11, v11, v13
    v_cvt_pk_bf16_f32 v10, v10, v11
    v_and_b32 v11, 0xffff0000, v10
    v_lshlrev_b32 v10, 16, v10
    v_add_f32 v138, v138, v10
    v_add_f32 v139, v139, v11
    v_lshlrev_b32 v10, 16, v24
    v_and_b32 v11, 0xffff0000, v24
    v_lshlrev_b32 v12, 16, v50
    v_and_b32 v13, 0xffff0000, v50
    v_mul_f32 v10, v10, v12
    v_mul_f32 v11, v11, v13
    v_cvt_pk_bf16_f32 v10, v10, v11
    v_and_b32 v11, 0xffff0000, v10
    v_lshlrev_b32 v10, 16, v10
    v_add_f32 v140, v140, v10
    v_add_f32 v141, v141, v11
    v_lshlrev_b32 v10, 16, v25
    v_and_b32 v11, 0xffff0000, v25
    v_lshlrev_b32 v12, 16, v51
    v_and_b32 v13, 0xffff0000, v51
    v_mul_f32 v10, v10, v12
    v_mul_f32 v11, v11, v13
    v_cvt_pk_bf16_f32 v10, v10, v11
    v_and_b32 v11, 0xffff0000, v10
    v_lshlrev_b32 v10, 16, v10
    v_add_f32 v142, v142, v10
    v_add_f32 v143, v143, v11
    v_lshlrev_b32 v10, 16, v26
    v_and_b32 v11, 0xffff0000, v26
    v_lshlrev_b32 v12, 16, v50
    v_and_b32 v13, 0xffff0000, v50
    v_mul_f32 v10, v10, v12
    v_mul_f32 v11, v11, v13
    v_cvt_pk_bf16_f32 v10, v10, v11
    v_and_b32 v11, 0xffff0000, v10
    v_lshlrev_b32 v10, 16, v10
    v_add_f32 v144, v144, v10
    v_add_f32 v145, v145, v11
    v_lshlrev_b32 v10, 16, v27
    v_and_b32 v11, 0xffff0000, v27
    v_lshlrev_b32 v12, 16, v51
    v_and_b32 v13, 0xffff0000, v51
    v_mul_f32 v10, v10, v12
    v_mul_f32 v11, v11, v13
    v_cvt_pk_bf16_f32 v10, v10, v11
    v_and_b32 v11, 0xffff0000, v10
    v_lshlrev_b32 v10, 16, v10
    v_add_f32 v146, v146, v10
    v_add_f32 v147, v147, v11
    v_lshlrev_b32 v10, 16, v28
    v_and_b32 v11, 0xffff0000, v28
    v_lshlrev_b32 v12, 16, v52
    v_and_b32 v13, 0xffff0000, v52
    v_mul_f32 v10, v10, v12
    v_mul_f32 v11, v11, v13
    v_cvt_pk_bf16_f32 v10, v10, v11
    v_and_b32 v11, 0xffff0000, v10
    v_lshlrev_b32 v10, 16, v10
    v_add_f32 v148, v148, v10
    v_add_f32 v149, v149, v11
    v_lshlrev_b32 v10, 16, v29
    v_and_b32 v11, 0xffff0000, v29
    v_lshlrev_b32 v12, 16, v53
    v_and_b32 v13, 0xffff0000, v53
    v_mul_f32 v10, v10, v12
    v_mul_f32 v11, v11, v13
    v_cvt_pk_bf16_f32 v10, v10, v11
    v_and_b32 v11, 0xffff0000, v10
    v_lshlrev_b32 v10, 16, v10
    v_add_f32 v150, v150, v10
    v_add_f32 v151, v151, v11
    v_lshlrev_b32 v10, 16, v30
    v_and_b32 v11, 0xffff0000, v30
    v_lshlrev_b32 v12, 16, v52
    v_and_b32 v13, 0xffff0000, v52
    v_mul_f32 v10, v10, v12
    v_mul_f32 v11, v11, v13
    v_cvt_pk_bf16_f32 v10, v10, v11
    v_and_b32 v11, 0xffff0000, v10
    v_lshlrev_b32 v10, 16, v10
    v_add_f32 v152, v152, v10
    v_add_f32 v153, v153, v11
    v_lshlrev_b32 v10, 16, v31
    v_and_b32 v11, 0xffff0000, v31
    v_lshlrev_b32 v12, 16, v53
    v_and_b32 v13, 0xffff0000, v53
    v_mul_f32 v10, v10, v12
    v_mul_f32 v11, v11, v13
    v_cvt_pk_bf16_f32 v10, v10, v11
    v_and_b32 v11, 0xffff0000, v10
    v_lshlrev_b32 v10, 16, v10
    v_add_f32 v154, v154, v10
    v_add_f32 v155, v155, v11
    v_lshlrev_b32 v10, 16, v32
    v_and_b32 v11, 0xffff0000, v32
    v_lshlrev_b32 v12, 16, v54
    v_and_b32 v13, 0xffff0000, v54
    v_mul_f32 v10, v10, v12
    v_mul_f32 v11, v11, v13
    v_cvt_pk_bf16_f32 v10, v10, v11
    v_and_b32 v11, 0xffff0000, v10
    v_lshlrev_b32 v10, 16, v10
    v_add_f32 v156, v156, v10
    v_add_f32 v157, v157, v11
    v_lshlrev_b32 v10, 16, v33
    v_and_b32 v11, 0xffff0000, v33
    v_lshlrev_b32 v12, 16, v55
    v_and_b32 v13, 0xffff0000, v55
    v_mul_f32 v10, v10, v12
    v_mul_f32 v11, v11, v13
    v_cvt_pk_bf16_f32 v10, v10, v11
    v_and_b32 v11, 0xffff0000, v10
    v_lshlrev_b32 v10, 16, v10
    v_add_f32 v158, v158, v10
    v_add_f32 v159, v159, v11
    v_lshlrev_b32 v10, 16, v34
    v_and_b32 v11, 0xffff0000, v34
    v_lshlrev_b32 v12, 16, v54
    v_and_b32 v13, 0xffff0000, v54
    v_mul_f32 v10, v10, v12
    v_mul_f32 v11, v11, v13
    v_cvt_pk_bf16_f32 v10, v10, v11
    v_and_b32 v11, 0xffff0000, v10
    v_lshlrev_b32 v10, 16, v10
    v_add_f32 v160, v160, v10
    v_add_f32 v161, v161, v11
    v_lshlrev_b32 v10, 16, v35
    v_and_b32 v11, 0xffff0000, v35
    v_lshlrev_b32 v12, 16, v55
    v_and_b32 v13, 0xffff0000, v55
    v_mul_f32 v10, v10, v12
    v_mul_f32 v11, v11, v13
    v_cvt_pk_bf16_f32 v10, v10, v11
    v_and_b32 v11, 0xffff0000, v10
    v_lshlrev_b32 v10, 16, v10
    v_add_f32 v162, v162, v10
    v_add_f32 v163, v163, v11
    v_lshlrev_b32 v10, 16, v36
    v_and_b32 v11, 0xffff0000, v36
    v_lshlrev_b32 v12, 16, v56
    v_and_b32 v13, 0xffff0000, v56
    v_mul_f32 v10, v10, v12
    v_mul_f32 v11, v11, v13
    v_cvt_pk_bf16_f32 v10, v10, v11
    v_and_b32 v11, 0xffff0000, v10
    v_lshlrev_b32 v10, 16, v10
    v_add_f32 v164, v164, v10
    v_add_f32 v165, v165, v11
    v_lshlrev_b32 v10, 16, v37
    v_and_b32 v11, 0xffff0000, v37
    v_lshlrev_b32 v12, 16, v57
    v_and_b32 v13, 0xffff0000, v57
    v_mul_f32 v10, v10, v12
    v_mul_f32 v11, v11, v13
    v_cvt_pk_bf16_f32 v10, v10, v11
    v_and_b32 v11, 0xffff0000, v10
    v_lshlrev_b32 v10, 16, v10
    v_add_f32 v166, v166, v10
    v_add_f32 v167, v167, v11
    v_lshlrev_b32 v10, 16, v38
    v_and_b32 v11, 0xffff0000, v38
    v_lshlrev_b32 v12, 16, v56
    v_and_b32 v13, 0xffff0000, v56
    v_mul_f32 v10, v10, v12
    v_mul_f32 v11, v11, v13
    v_cvt_pk_bf16_f32 v10, v10, v11
    v_and_b32 v11, 0xffff0000, v10
    v_lshlrev_b32 v10, 16, v10
    v_add_f32 v168, v168, v10
    v_add_f32 v169, v169, v11
    v_lshlrev_b32 v10, 16, v39
    v_and_b32 v11, 0xffff0000, v39
    v_lshlrev_b32 v12, 16, v57
    v_and_b32 v13, 0xffff0000, v57
    v_mul_f32 v10, v10, v12
    v_mul_f32 v11, v11, v13
    v_cvt_pk_bf16_f32 v10, v10, v11
    v_and_b32 v11, 0xffff0000, v10
    v_lshlrev_b32 v10, 16, v10
    v_add_f32 v170, v170, v10
    v_add_f32 v171, v171, v11
    v_lshlrev_b32 v10, 16, v40
    v_and_b32 v11, 0xffff0000, v40
    v_lshlrev_b32 v12, 16, v58
    v_and_b32 v13, 0xffff0000, v58
    v_mul_f32 v10, v10, v12
    v_mul_f32 v11, v11, v13
    v_cvt_pk_bf16_f32 v10, v10, v11
    v_and_b32 v11, 0xffff0000, v10
    v_lshlrev_b32 v10, 16, v10
    v_add_f32 v172, v172, v10
    v_add_f32 v173, v173, v11
    v_lshlrev_b32 v10, 16, v41
    v_and_b32 v11, 0xffff0000, v41
    v_lshlrev_b32 v12, 16, v59
    v_and_b32 v13, 0xffff0000, v59
    v_mul_f32 v10, v10, v12
    v_mul_f32 v11, v11, v13
    v_cvt_pk_bf16_f32 v10, v10, v11
    v_and_b32 v11, 0xffff0000, v10
    v_lshlrev_b32 v10, 16, v10
    v_add_f32 v174, v174, v10
    v_add_f32 v175, v175, v11
    v_lshlrev_b32 v10, 16, v42
    v_and_b32 v11, 0xffff0000, v42
    v_lshlrev_b32 v12, 16, v58
    v_and_b32 v13, 0xffff0000, v58
    v_mul_f32 v10, v10, v12
    v_mul_f32 v11, v11, v13
    v_cvt_pk_bf16_f32 v10, v10, v11
    v_and_b32 v11, 0xffff0000, v10
    v_lshlrev_b32 v10, 16, v10
    v_add_f32 v176, v176, v10
    v_add_f32 v177, v177, v11
    v_lshlrev_b32 v10, 16, v43
    v_and_b32 v11, 0xffff0000, v43
    v_lshlrev_b32 v12, 16, v59
    v_and_b32 v13, 0xffff0000, v59
    v_mul_f32 v10, v10, v12
    v_mul_f32 v11, v11, v13
    v_cvt_pk_bf16_f32 v10, v10, v11
    v_and_b32 v11, 0xffff0000, v10
    v_lshlrev_b32 v10, 16, v10
    v_add_f32 v178, v178, v10
    v_add_f32 v179, v179, v11
    v_lshlrev_b32 v10, 16, v44
    v_and_b32 v11, 0xffff0000, v44
    v_lshlrev_b32 v12, 16, v60
    v_and_b32 v13, 0xffff0000, v60
    v_mul_f32 v10, v10, v12
    v_mul_f32 v11, v11, v13
    v_cvt_pk_bf16_f32 v10, v10, v11
    v_and_b32 v11, 0xffff0000, v10
    v_lshlrev_b32 v10, 16, v10
    v_add_f32 v180, v180, v10
    v_add_f32 v181, v181, v11
    v_lshlrev_b32 v10, 16, v45
    v_and_b32 v11, 0xffff0000, v45
    v_lshlrev_b32 v12, 16, v61
    v_and_b32 v13, 0xffff0000, v61
    v_mul_f32 v10, v10, v12
    v_mul_f32 v11, v11, v13
    v_cvt_pk_bf16_f32 v10, v10, v11
    v_and_b32 v11, 0xffff0000, v10
    v_lshlrev_b32 v10, 16, v10
    v_add_f32 v182, v182, v10
    v_add_f32 v183, v183, v11
    v_lshlrev_b32 v10, 16, v46
    v_and_b32 v11, 0xffff0000, v46
    v_lshlrev_b32 v12, 16, v60
    v_and_b32 v13, 0xffff0000, v60
    v_mul_f32 v10, v10, v12
    v_mul_f32 v11, v11, v13
    v_cvt_pk_bf16_f32 v10, v10, v11
    v_and_b32 v11, 0xffff0000, v10
    v_lshlrev_b32 v10, 16, v10
    v_add_f32 v184, v184, v10
    v_add_f32 v185, v185, v11
    v_lshlrev_b32 v10, 16, v47
    v_and_b32 v11, 0xffff0000, v47
    v_lshlrev_b32 v12, 16, v61
    v_and_b32 v13, 0xffff0000, v61
    v_mul_f32 v10, v10, v12
    v_mul_f32 v11, v11, v13
    v_cvt_pk_bf16_f32 v10, v10, v11
    v_and_b32 v11, 0xffff0000, v10
    v_lshlrev_b32 v10, 16, v10
    v_add_f32 v186, v186, v10
    v_add_f32 v187, v187, v11
S5_NOD:
    s_waitcnt lgkmcnt(0)
    s_mul_i32 s26, s25, 3670016
    s_mul_i32 s27, s24, 57344
    s_add_u32 s26, s26, s27
    s_mul_i32 s27, s20, 14336
    s_add_u32 s26, s26, s27
    s_add_u32 s26, s26, 93159424
    v_mul_f32 v132, v8, v132
    v_mul_f32 v133, v8, v133
    v_mul_f32 v134, v8, v134
    v_mul_f32 v135, v8, v135
    buffer_store_dwordx4 v[132:135], v5, s[4:7], s26 offen offset:0 sc1
    v_mul_f32 v136, v9, v136
    v_mul_f32 v137, v9, v137
    v_mul_f32 v138, v9, v138
    v_mul_f32 v139, v9, v139
    buffer_store_dwordx4 v[136:139], v5, s[4:7], s26 offen offset:1024 sc1
    v_mul_f32 v140, v8, v140
    v_mul_f32 v141, v8, v141
    v_mul_f32 v142, v8, v142
    v_mul_f32 v143, v8, v143
    buffer_store_dwordx4 v[140:143], v5, s[4:7], s26 offen offset:2048 sc1
    v_mul_f32 v144, v9, v144
    v_mul_f32 v145, v9, v145
    v_mul_f32 v146, v9, v146
    v_mul_f32 v147, v9, v147
    buffer_store_dwordx4 v[144:147], v5, s[4:7], s26 offen offset:3072 sc1
    v_mul_f32 v148, v8, v148
    v_mul_f32 v149, v8, v149
    v_mul_f32 v150, v8, v150
    v_mul_f32 v151, v8, v151
    s_add_u32 s26, s26, 4096
    buffer_store_dwordx4 v[148:151], v5, s[4:7], s26 offen offset:0 sc1
    v_mul_f32 v152, v9, v152
    v_mul_f32 v153, v9, v153
    v_mul_f32 v154, v9, v154
    v_mul_f32 v155, v9, v155
    buffer_store_dwordx4 v[152:155], v5, s[4:7], s26 offen offset:1024 sc1
    v_mul_f32 v156, v8, v156
    v_mul_f32 v157, v8, v157
    v_mul_f32 v158, v8, v158
    v_mul_f32 v159, v8, v159
    buffer_store_dwordx4 v[156:159], v5, s[4:7], s26 offen offset:2048 sc1
    v_mul_f32 v160, v9, v160
    v_mul_f32 v161, v9, v161
    v_mul_f32 v162, v9, v162
    v_mul_f32 v163, v9, v163
    buffer_store_dwordx4 v[160:163], v5, s[4:7], s26 offen offset:3072 sc1
    v_mul_f32 v164, v8, v164
    v_mul_f32 v165, v8, v165
    v_mul_f32 v166, v8, v166
    v_mul_f32 v167, v8, v167
    s_add_u32 s26, s26, 4096
    buffer_store_dwordx4 v[164:167], v5, s[4:7], s26 offen offset:0 sc1
    v_mul_f32 v168, v9, v168
    v_mul_f32 v169, v9, v169
    v_mul_f32 v170, v9, v170
    v_mul_f32 v171, v9, v171
    buffer_store_dwordx4 v[168:171], v5, s[4:7], s26 offen offset:1024 sc1
    v_mul_f32 v172, v8, v172
    v_mul_f32 v173, v8, v173
    v_mul_f32 v174, v8, v174
    v_mul_f32 v175, v8, v175
    buffer_store_dwordx4 v[172:175], v5, s[4:7], s26 offen offset:2048 sc1
    v_mul_f32 v176, v9, v176
    v_mul_f32 v177, v9, v177
    v_mul_f32 v178, v9, v178
    v_mul_f32 v179, v9, v179
    buffer_store_dwordx4 v[176:179], v5, s[4:7], s26 offen offset:3072 sc1
    v_mul_f32 v180, v8, v180
    v_mul_f32 v181, v8, v181
    v_mul_f32 v182, v8, v182
    v_mul_f32 v183, v8, v183
    s_add_u32 s26, s26, 4096
    buffer_store_dwordx4 v[180:183], v5, s[4:7], s26 offen offset:0 sc1
    v_mul_f32 v184, v9, v184
    v_mul_f32 v185, v9, v185
    v_mul_f32 v186, v9, v186
    v_mul_f32 v187, v9, v187
    buffer_store_dwordx4 v[184:187], v5, s[4:7], s26 offen offset:1024 sc1
    s_lshl_b32 s26, s24, 7
    s_add_u32 s26, s26, 100548608
    s_waitcnt vmcnt(0)
    s_mov_b64 s[38:39], exec
    s_mov_b64 exec, 1
    buffer_atomic_add v19, v15, s[4:7], s26 offen
    s_mov_b64 exec, s[38:39]
    s_waitcnt lgkmcnt(0)
    s_barrier
W_F:
    v_mov_b32 v15, 0
    v_mov_b32 v19, 1
    s_cmp_ge_u32 s21, 220
    s_cbranch_scc1 K2_END
    s_mul_i32 s24, s21, 5958
    s_lshr_b32 s24, s24, 16
    s_mul_i32 s25, s24, 11
    s_sub_u32 s26, s21, s25
    s_cmp_lt_u32 s26, 4
    s_cbranch_scc0 W_F2
    s_lshl_b32 s27, s26, 2
    s_add_u32 s27, s27, s20
    v_lshlrev_b32 v9, 4, v0
    v_mov_b32 v6, v9
    v_add_u32 v7, 4096, v9
    v_cmp_gt_u32 vcc, 192, v0
    v_mov_b32 v10, 536870912
    s_nop 1
    v_cndmask_b32 v7, v10, v7, vcc
    v_lshrrev_b32 v10, 1, v4
    v_lshlrev_b32 v10, 8, v10
    v_and_b32 v11, 7, v3
    v_lshl_add_u32 v10, v11, 4, v10
    v_and_b32 v11, 1, v4
    v_lshl_add_u32 v16, v11, 3, v10
    v_cmp_gt_u32 vcc, 2, v4
    v_mov_b32 v10, 0
    v_mov_b32 v11, 1.0
    s_nop 0
    v_cndmask_b32 v17, v10, v11, vcc
    v_lshl_add_u32 v10, v4, 2, 0
    v_cmp_le_u32 s[44:45], v10, v3
    v_lshl_add_u32 v10, v4, 2, 1
    v_cmp_le_u32 s[46:47], v10, v3
    v_lshl_add_u32 v10, v4, 2, 2
    v_cmp_le_u32 s[48:49], v10, v3
    v_lshl_add_u32 v10, v4, 2, 3
    v_cmp_le_u32 s[50:51], v10, v3
    v_mov_b32 v14, 112
    v_mov_b32 v18, 0xf149f2ca
    v_lshlrev_b32 v8, 4, v1
    s_and_b32 s28, s27, 1
    s_lshl_b32 s28, s28, 3
    v_add_u32 v8, s28, v8
F1_LOOP:
    s_mul_i32 s28, s24, 28672
    s_add_u32 s28, s28, 12845056
    buffer_load_dwordx4 a[0:3], v5, s[4:7], s28 offen offset:0
    buffer_load_dwordx4 a[4:7], v5, s[4:7], s28 offen offset:1024
    buffer_load_dwordx4 a[8:11], v5, s[4:7], s28 offen offset:2048
    buffer_load_dwordx4 a[12:15], v5, s[4:7], s28 offen offset:3072
    s_add_u32 s28, s28, 4096
    buffer_load_dwordx4 a[16:19], v5, s[4:7], s28 offen offset:0
    buffer_load_dwordx4 a[20:23], v5, s[4:7], s28 offen offset:1024
    buffer_load_dwordx4 a[24:27], v5, s[4:7], s28 offen offset:2048
    buffer_load_dwordx4 a[28:31], v5, s[4:7], s28 offen offset:3072
    s_add_u32 s28, s28, 4096
    buffer_load_dwordx4 a[32:35], v5, s[4:7], s28 offen offset:0
    buffer_load_dwordx4 a[36:39], v5, s[4:7], s28 offen offset:1024
    buffer_load_dwordx4 a[40:43], v5, s[4:7], s28 offen offset:2048
    buffer_load_dwordx4 a[44:47], v5, s[4:7], s28 offen offset:3072
    s_add_u32 s28, s28, 4096
    buffer_load_dwordx4 a[48:51], v5, s[4:7], s28 offen offset:0
    buffer_load_dwordx4 a[52:55], v5, s[4:7], s28 offen offset:1024
    buffer_load_dwordx4 a[56:59], v5, s[4:7], s28 offen offset:2048
    buffer_load_dwordx4 a[60:63], v5, s[4:7], s28 offen offset:3072
    s_add_u32 s28, s28, 4096
    buffer_load_dwordx4 a[64:67], v5, s[4:7], s28 offen offset:0
    buffer_load_dwordx4 a[68:71], v5, s[4:7], s28 offen offset:1024
    buffer_load_dwordx4 a[72:75], v5, s[4:7], s28 offen offset:2048
    buffer_load_dwordx4 a[76:79], v5, s[4:7], s28 offen offset:3072
    s_add_u32 s28, s28, 4096
    buffer_load_dwordx4 a[80:83], v5, s[4:7], s28 offen offset:0
    buffer_load_dwordx4 a[84:87], v5, s[4:7], s28 offen offset:1024
    buffer_load_dwordx4 a[88:91], v5, s[4:7], s28 offen offset:2048
    buffer_load_dwordx4 a[92:95], v5, s[4:7], s28 offen offset:3072
    s_add_u32 s28, s28, 4096
    buffer_load_dwordx4 a[96:99], v5, s[4:7], s28 offen offset:0
    buffer_load_dwordx4 a[100:103], v5, s[4:7], s28 offen offset:1024
    buffer_load_dwordx4 a[104:107], v5, s[4:7], s28 offen offset:2048
    buffer_load_dwordx4 a[108:111], v5, s[4:7], s28 offen offset:3072
    s_lshl_b32 s28, s24, 7
    s_add_u32 s28, s28, 100515840
F1_CT:
    buffer_load_dword v10, v15, s[4:7], s28 offen sc1
    s_waitcnt vmcnt(0)
    v_cmp_lt_u32 vcc, v10, v14
    s_cbranch_vccz F1_CT_ok
    s_sub_u32 s23, s23, 1
    s_cmp_gt_i32 s23, 0
    s_cbranch_scc1 F1_CT
F1_CT_ok:
    s_mul_i32 s28, s24, 458752
    s_mul_i32 s29, s27, 28672
    s_add_u32 s28, s28, s29
    s_add_u32 s28, s28, 44040192
    buffer_load_dwordx4 v[20:23], v5, s[4:7], s28 offen offset:0 sc1
    buffer_load_dwordx4 v[24:27], v5, s[4:7], s28 offen offset:1024 sc1
    buffer_load_dwordx4 v[28:31], v5, s[4:7], s28 offen offset:2048 sc1
    buffer_load_dwordx4 v[32:35], v5, s[4:7], s28 offen offset:3072 sc1
    s_add_u32 s28, s28, 4096
    buffer_load_dwordx4 v[36:39], v5, s[4:7], s28 offen offset:0 sc1
    buffer_load_dwordx4 v[40:43], v5, s[4:7], s28 offen offset:1024 sc1
    buffer_load_dwordx4 v[44:47], v5, s[4:7], s28 offen offset:2048 sc1
    buffer_load_dwordx4 v[48:51], v5, s[4:7], s28 offen offset:3072 sc1
    s_add_u32 s28, s28, 4096
    buffer_load_dwordx4 v[52:55], v5, s[4:7], s28 offen offset:0 sc1
    buffer_load_dwordx4 v[56:59], v5, s[4:7], s28 offen offset:1024 sc1
    buffer_load_dwordx4 v[60:63], v5, s[4:7], s28 offen offset:2048 sc1
    buffer_load_dwordx4 v[64:67], v5, s[4:7], s28 offen offset:3072 sc1
    s_add_u32 s28, s28, 4096
    buffer_load_dwordx4 v[68:71], v5, s[4:7], s28 offen offset:0 sc1
    buffer_load_dwordx4 v[72:75], v5, s[4:7], s28 offen offset:1024 sc1
    buffer_load_dwordx4 v[76:79], v5, s[4:7], s28 offen offset:2048 sc1
    buffer_load_dwordx4 v[80:83], v5, s[4:7], s28 offen offset:3072 sc1
    s_add_u32 s28, s28, 4096
    buffer_load_dwordx4 v[84:87], v5, s[4:7], s28 offen offset:0 sc1
    buffer_load_dwordx4 v[88:91], v5, s[4:7], s28 offen offset:1024 sc1
    buffer_load_dwordx4 v[92:95], v5, s[4:7], s28 offen offset:2048 sc1
    buffer_load_dwordx4 v[96:99], v5, s[4:7], s28 offen offset:3072 sc1
    s_add_u32 s28, s28, 4096
    buffer_load_dwordx4 v[100:103], v5, s[4:7], s28 offen offset:0 sc1
    buffer_load_dwordx4 v[104:107], v5, s[4:7], s28 offen offset:1024 sc1
    buffer_load_dwordx4 v[108:111], v5, s[4:7], s28 offen offset:2048 sc1
    buffer_load_dwordx4 v[112:115], v5, s[4:7], s28 offen offset:3072 sc1
    s_add_u32 s28, s28, 4096
    buffer_load_dwordx4 v[116:119], v5, s[4:7], s28 offen offset:0 sc1
    buffer_load_dwordx4 v[120:123], v5, s[4:7], s28 offen offset:1024 sc1
    buffer_load_dwordx4 v[124:127], v5, s[4:7], s28 offen offset:2048 sc1
    buffer_load_dwordx4 v[128:131], v5, s[4:7], s28 offen offset:3072 sc1
    v_mov_b32 v188, 0
    v_mov_b32 v189, 0
    v_mov_b32 v190, 0
    v_mov_b32 v191, 0
    v_mov_b32 v192, 0
    v_mov_b32 v193, 0
    v_mov_b32 v194, 0
    v_mov_b32 v195, 0
    v_mov_b32 v196, 0
    v_mov_b32 v197, 0
    v_mov_b32 v198, 0
    v_mov_b32 v199, 0
    v_mov_b32 v200, 0
    v_mov_b32 v201, 0
    v_mov_b32 v202, 0
    v_mov_b32 v203, 0
    v_mov_b32 v204, 0
    v_mov_b32 v205, 0
    v_mov_b32 v206, 0
    v_mov_b32 v207, 0
    s_waitcnt vmcnt(0)
    v_mfma_f32_16x16x32_bf16 v[188:191], a[0:3], v[20:23], v[188:191]
    v_mfma_f32_16x16x32_bf16 v[196:199], a[0:3], v[76:79], v[196:199]
    v_mfma_f32_16x16x32_bf16 v[200:203], a[56:59], v[76:79], v[200:203]
    v_mfma_f32_16x16x32_bf16 v[188:191], a[4:7], v[24:27], v[188:191]
    v_mfma_f32_16x16x32_bf16 v[196:199], a[4:7], v[80:83], v[196:199]
    v_mfma_f32_16x16x32_bf16 v[200:203], a[60:63], v[80:83], v[200:203]
    v_mfma_f32_16x16x32_bf16 v[188:191], a[8:11], v[28:31], v[188:191]
    v_mfma_f32_16x16x32_bf16 v[196:199], a[8:11], v[84:87], v[196:199]
    v_mfma_f32_16x16x32_bf16 v[200:203], a[64:67], v[84:87], v[200:203]
    v_mfma_f32_16x16x32_bf16 v[188:191], a[12:15], v[32:35], v[188:191]
    v_mfma_f32_16x16x32_bf16 v[196:199], a[12:15], v[88:91], v[196:199]
    v_mfma_f32_16x16x32_bf16 v[200:203], a[68:71], v[88:91], v[200:203]
    v_mfma_f32_16x16x32_bf16 v[188:191], a[16:19], v[36:39], v[188:191]
    v_mfma_f32_16x16x32_bf16 v[196:199], a[16:19], v[92:95], v[196:199]
    v_mfma_f32_16x16x32_bf16 v[200:203], a[72:75], v[92:95], v[200:203]
    v_mfma_f32_16x16x32_bf16 v[188:191], a[20:23], v[40:43], v[188:191]
    v_mfma_f32_16x16x32_bf16 v[196:199], a[20:23], v[96:99], v[196:199]
    v_mfma_f32_16x16x32_bf16 v[200:203], a[76:79], v[96:99], v[200:203]
    v_mfma_f32_16x16x32_bf16 v[188:191], a[24:27], v[44:47], v[188:191]
    v_mfma_f32_16x16x32_bf16 v[196:199], a[24:27], v[100:103], v[196:199]
    v_mfma_f32_16x16x32_bf16 v[200:203], a[80:83], v[100:103], v[200:203]
    v_mfma_f32_16x16x32_bf16 v[188:191], a[28:31], v[48:51], v[188:191]
    v_mfma_f32_16x16x32_bf16 v[196:199], a[28:31], v[104:107], v[196:199]
    v_mfma_f32_16x16x32_bf16 v[200:203], a[84:87], v[104:107], v[200:203]
    v_mfma_f32_16x16x32_bf16 v[188:191], a[32:35], v[52:55], v[188:191]
    v_mfma_f32_16x16x32_bf16 v[196:199], a[32:35], v[108:111], v[196:199]
    v_mfma_f32_16x16x32_bf16 v[200:203], a[88:91], v[108:111], v[200:203]
    v_mfma_f32_16x16x32_bf16 v[188:191], a[36:39], v[56:59], v[188:191]
    v_mfma_f32_16x16x32_bf16 v[196:199], a[36:39], v[112:115], v[196:199]
    v_mfma_f32_16x16x32_bf16 v[200:203], a[92:95], v[112:115], v[200:203]
    v_mfma_f32_16x16x32_bf16 v[188:191], a[40:43], v[60:63], v[188:191]
    v_mfma_f32_16x16x32_bf16 v[196:199], a[40:43], v[116:119], v[196:199]
    v_mfma_f32_16x16x32_bf16 v[200:203], a[96:99], v[116:119], v[200:203]
    v_mfma_f32_16x16x32_bf16 v[188:191], a[44:47], v[64:67], v[188:191]
    v_mfma_f32_16x16x32_bf16 v[196:199], a[44:47], v[120:123], v[196:199]
    v_mfma_f32_16x16x32_bf16 v[200:203], a[100:103], v[120:123], v[200:203]
    v_mfma_f32_16x16x32_bf16 v[188:191], a[48:51], v[68:71], v[188:191]
    v_mfma_f32_16x16x32_bf16 v[196:199], a[48:51], v[124:127], v[196:199]
    v_mfma_f32_16x16x32_bf16 v[200:203], a[104:107], v[124:127], v[200:203]
    v_mfma_f32_16x16x32_bf16 v[188:191], a[52:55], v[72:75], v[188:191]
    v_mfma_f32_16x16x32_bf16 v[196:199], a[52:55], v[128:131], v[196:199]
    v_mfma_f32_16x16x32_bf16 v[200:203], a[108:111], v[128:131], v[200:203]
    s_mul_i32 s28, s24, 7168
    s_add_u32 s28, s28, 73859072
F1_PM:
    buffer_load_dwordx4 v[208:211], v6, s[4:7], s28 offen sc1
    buffer_load_dwordx4 v[212:215], v7, s[4:7], s28 offen sc1
    s_waitcnt vmcnt(0)
    v_max3_u32 v10, v208, v209, v210
    v_max3_u32 v11, v211, v212, v213
    v_max3_u32 v10, v10, v214, v215
    v_max_u32 v10, v10, v11
    v_cmp_eq_u32 vcc, -1, v10
    s_cbranch_vccz F1_PM_ok
    s_sub_u32 s23, s23, 1
    s_cmp_gt_i32 s23, 0
    s_cbranch_scc1 F1_PM
F1_PM_ok:
    ds_write_b128 v9, v[208:211]
    ds_write_b128 v9, v[212:215] offset:4096
    s_waitcnt lgkmcnt(0)
    s_barrier
    ds_read_b32 v132, v16 offset:0
    ds_read_b32 v133, v16 offset:128
    ds_read_b32 v134, v16 offset:4
    ds_read_b32 v135, v16 offset:132
    ds_read_b32 v136, v16 offset:512
    ds_read_b32 v137, v16 offset:640
    ds_read_b32 v138, v16 offset:516
    ds_read_b32 v139, v16 offset:644
    ds_read_b32 v140, v16 offset:1024
    ds_read_b32 v141, v16 offset:1152
    ds_read_b32 v142, v16 offset:1028
    ds_read_b32 v143, v16 offset:1156
    ds_read_b32 v144, v16 offset:1536
    ds_read_b32 v145, v16 offset:1664
    ds_read_b32 v146, v16 offset:1540
    ds_read_b32 v147, v16 offset:1668
    ds_read_b32 v148, v16 offset:2048
    ds_read_b32 v149, v16 offset:2176
    ds_read_b32 v150, v16 offset:2052
    ds_read_b32 v151, v16 offset:2180
    ds_read_b32 v152, v16 offset:2560
    ds_read_b32 v153, v16 offset:2688
    ds_read_b32 v154, v16 offset:2564
    ds_read_b32 v155, v16 offset:2692
    ds_read_b32 v156, v16 offset:3072
    ds_read_b32 v157, v16 offset:3200
    ds_read_b32 v158, v16 offset:3076
    ds_read_b32 v159, v16 offset:3204
    ds_read_b32 v160, v16 offset:3584
    ds_read_b32 v161, v16 offset:3712
    ds_read_b32 v162, v16 offset:3588
    ds_read_b32 v163, v16 offset:3716
    ds_read_b32 v164, v16 offset:4096
    ds_read_b32 v165, v16 offset:4224
    ds_read_b32 v166, v16 offset:4100
    ds_read_b32 v167, v16 offset:4228
    ds_read_b32 v168, v16 offset:4608
    ds_read_b32 v169, v16 offset:4736
    ds_read_b32 v170, v16 offset:4612
    ds_read_b32 v171, v16 offset:4740
    ds_read_b32 v172, v16 offset:5120
    ds_read_b32 v173, v16 offset:5248
    ds_read_b32 v174, v16 offset:5124
    ds_read_b32 v175, v16 offset:5252
    ds_read_b32 v176, v16 offset:5632
    ds_read_b32 v177, v16 offset:5760
    ds_read_b32 v178, v16 offset:5636
    ds_read_b32 v179, v16 offset:5764
    ds_read_b32 v180, v16 offset:6144
    ds_read_b32 v181, v16 offset:6272
    ds_read_b32 v182, v16 offset:6148
    ds_read_b32 v183, v16 offset:6276
    ds_read_b32 v184, v16 offset:6656
    ds_read_b32 v185, v16 offset:6784
    ds_read_b32 v186, v16 offset:6660
    ds_read_b32 v187, v16 offset:6788
    s_waitcnt lgkmcnt(0)
    s_barrier
    v_mfma_f32_16x16x32_bf16 v[192:195], v[132:135], v[20:23], v[192:195]
    v_mfma_f32_16x16x32_bf16 v[204:207], v[132:135], v[76:79], v[204:207]
    v_mfma_f32_16x16x32_bf16 v[192:195], v[136:139], v[24:27], v[192:195]
    v_mfma_f32_16x16x32_bf16 v[204:207], v[136:139], v[80:83], v[204:207]
    v_mfma_f32_16x16x32_bf16 v[192:195], v[140:143], v[28:31], v[192:195]
    v_mfma_f32_16x16x32_bf16 v[204:207], v[140:143], v[84:87], v[204:207]
    v_mfma_f32_16x16x32_bf16 v[192:195], v[144:147], v[32:35], v[192:195]
    v_mfma_f32_16x16x32_bf16 v[204:207], v[144:147], v[88:91], v[204:207]
    v_mfma_f32_16x16x32_bf16 v[192:195], v[148:151], v[36:39], v[192:195]
    v_mfma_f32_16x16x32_bf16 v[204:207], v[148:151], v[92:95], v[204:207]
    v_mfma_f32_16x16x32_bf16 v[192:195], v[152:155], v[40:43], v[192:195]
    v_mfma_f32_16x16x32_bf16 v[204:207], v[152:155], v[96:99], v[204:207]
    v_mfma_f32_16x16x32_bf16 v[192:195], v[156:159], v[44:47], v[192:195]
    v_mfma_f32_16x16x32_bf16 v[204:207], v[156:159], v[100:103], v[204:207]
    v_mfma_f32_16x16x32_bf16 v[192:195], v[160:163], v[48:51], v[192:195]
    v_mfma_f32_16x16x32_bf16 v[204:207], v[160:163], v[104:107], v[204:207]
    v_mfma_f32_16x16x32_bf16 v[192:195], v[164:167], v[52:55], v[192:195]
    v_mfma_f32_16x16x32_bf16 v[204:207], v[164:167], v[108:111], v[204:207]
    v_mfma_f32_16x16x32_bf16 v[192:195], v[168:171], v[56:59], v[192:195]
    v_mfma_f32_16x16x32_bf16 v[204:207], v[168:171], v[112:115], v[204:207]
    v_mfma_f32_16x16x32_bf16 v[192:195], v[172:175], v[60:63], v[192:195]
    v_mfma_f32_16x16x32_bf16 v[204:207], v[172:175], v[116:119], v[204:207]
    v_mfma_f32_16x16x32_bf16 v[192:195], v[176:179], v[64:67], v[192:195]
    v_mfma_f32_16x16x32_bf16 v[204:207], v[176:179], v[120:123], v[204:207]
    v_mfma_f32_16x16x32_bf16 v[192:195], v[180:183], v[68:71], v[192:195]
    v_mfma_f32_16x16x32_bf16 v[204:207], v[180:183], v[124:127], v[204:207]
    v_mfma_f32_16x16x32_bf16 v[192:195], v[184:187], v[72:75], v[192:195]
    v_mfma_f32_16x16x32_bf16 v[204:207], v[184:187], v[128:131], v[204:207]
    s_nop 7
    s_nop 1
    s_mul_i32 s28, s24, 49152
    s_add_u32 s28, s28, 89784320
    s_lshl_b32 s29, s27, 10
    s_add_u32 s29, s29, s28
    s_lshr_b32 s30, s27, 1
    s_add_u32 s30, s30, 16
    s_lshl_b32 s30, s30, 10
    s_add_u32 s30, s30, s28
    v_cndmask_b32 v188, v18, v188, s[44:45]
    v_cndmask_b32 v189, v18, v189, s[46:47]
    v_cndmask_b32 v190, v18, v190, s[48:49]
    v_cndmask_b32 v191, v18, v191, s[50:51]
    v_max_f32 v10, v188, v189
    v_max3_f32 v10, v10, v190, v191
    v_max3_f32 v10, v10, v192, v193
    v_max3_f32 v10, v10, v194, v195
    v_mov_b32 v11, v10
    s_nop 1
    v_permlane16_swap_b32 v11, v10
    s_nop 1
    v_max_f32 v10, v11, v10
    v_mov_b32 v11, v10
    s_nop 1
    v_permlane32_swap_b32 v11, v10
    s_nop 1
    v_max_f32 v10, v11, v10
    v_mul_f32 v10, 0xbfb8aa3b, v10
    v_mov_b32 v12, 0x3fb8aa3b
    v_fma_f32 v188, v188, v12, v10
    v_fma_f32 v189, v189, v12, v10
    v_fma_f32 v190, v190, v12, v10
    v_fma_f32 v191, v191, v12, v10
    v_fma_f32 v192, v192, v12, v10
    v_fma_f32 v193, v193, v12, v10
    v_fma_f32 v194, v194, v12, v10
    v_fma_f32 v195, v195, v12, v10
    v_exp_f32 v188, v188
    v_exp_f32 v189, v189
    v_exp_f32 v190, v190
    v_exp_f32 v191, v191
    v_exp_f32 v192, v192
    v_exp_f32 v193, v193
    v_exp_f32 v194, v194
    v_exp_f32 v195, v195
    s_nop 0
    v_add_f32 v10, v192, v193
    v_add_f32 v10, v10, v194
    v_add_f32 v10, v10, v195
    v_mul_f32 v10, v10, v17
    v_add_f32 v10, v10, v188
    v_add_f32 v10, v10, v189
    v_add_f32 v10, v10, v190
    v_add_f32 v10, v10, v191
    v_mov_b32 v11, v10
    s_nop 1
    v_permlane16_swap_b32 v11, v10
    s_nop 1
    v_add_f32 v10, v11, v10
    v_mov_b32 v11, v10
    s_nop 1
    v_permlane32_swap_b32 v11, v10
    s_nop 1
    v_add_f32 v10, v11, v10
    v_rcp_f32 v10, v10
    s_nop 0
    v_mul_f32 v188, v188, v10
    v_mul_f32 v189, v189, v10
    v_mul_f32 v190, v190, v10
    v_mul_f32 v191, v191, v10
    v_mul_f32 v192, v192, v10
    v_mul_f32 v193, v193, v10
    v_mul_f32 v194, v194, v10
    v_mul_f32 v195, v195, v10
    v_cvt_pk_bf16_f32 v208, v188, v189
    v_cvt_pk_bf16_f32 v209, v190, v191
    v_mov_b32 v210, 0
    v_mov_b32 v211, 0
    v_cvt_pk_bf16_f32 v212, v192, v193
    v_cvt_pk_bf16_f32 v213, v194, v195
    buffer_store_dwordx4 v[208:211], v5, s[4:7], s29 offen sc1
    buffer_store_dwordx2 v[212:213], v8, s[4:7], s30 offen sc1
    s_add_u32 s29, s29, 24576
    s_add_u32 s30, s30, 24576
    v_cndmask_b32 v200, v18, v200, s[44:45]
    v_cndmask_b32 v201, v18, v201, s[46:47]
    v_cndmask_b32 v202, v18, v202, s[48:49]
    v_cndmask_b32 v203, v18, v203, s[50:51]
    v_max_f32 v10, v196, v197
    v_max3_f32 v10, v10, v198, v199
    v_max3_f32 v10, v10, v200, v201
    v_max3_f32 v10, v10, v202, v203
    v_max3_f32 v10, v10, v204, v205
    v_max3_f32 v10, v10, v206, v207
    v_mov_b32 v11, v10
    s_nop 1
    v_permlane16_swap_b32 v11, v10
    s_nop 1
    v_max_f32 v10, v11, v10
    v_mov_b32 v11, v10
    s_nop 1
    v_permlane32_swap_b32 v11, v10
    s_nop 1
    v_max_f32 v10, v11, v10
    v_mul_f32 v10, 0xbfb8aa3b, v10
    v_mov_b32 v12, 0x3fb8aa3b
    v_fma_f32 v196, v196, v12, v10
    v_fma_f32 v197, v197, v12, v10
    v_fma_f32 v198, v198, v12, v10
    v_fma_f32 v199, v199, v12, v10
    v_fma_f32 v200, v200, v12, v10
    v_fma_f32 v201, v201, v12, v10
    v_fma_f32 v202, v202, v12, v10
    v_fma_f32 v203, v203, v12, v10
    v_fma_f32 v204, v204, v12, v10
    v_fma_f32 v205, v205, v12, v10
    v_fma_f32 v206, v206, v12, v10
    v_fma_f32 v207, v207, v12, v10
    v_exp_f32 v196, v196
    v_exp_f32 v197, v197
    v_exp_f32 v198, v198
    v_exp_f32 v199, v199
    v_exp_f32 v200, v200
    v_exp_f32 v201, v201
    v_exp_f32 v202, v202
    v_exp_f32 v203, v203
    v_exp_f32 v204, v204
    v_exp_f32 v205, v205
    v_exp_f32 v206, v206
    v_exp_f32 v207, v207
    s_nop 0
    v_add_f32 v10, v204, v205
    v_add_f32 v10, v10, v206
    v_add_f32 v10, v10, v207
    v_mul_f32 v10, v10, v17
    v_add_f32 v10, v10, v196
    v_add_f32 v10, v10, v197
    v_add_f32 v10, v10, v198
    v_add_f32 v10, v10, v199
    v_add_f32 v10, v10, v200
    v_add_f32 v10, v10, v201
    v_add_f32 v10, v10, v202
    v_add_f32 v10, v10, v203
    v_mov_b32 v11, v10
    s_nop 1
    v_permlane16_swap_b32 v11, v10
    s_nop 1
    v_add_f32 v10, v11, v10
    v_mov_b32 v11, v10
    s_nop 1
    v_permlane32_swap_b32 v11, v10
    s_nop 1
    v_add_f32 v10, v11, v10
    v_rcp_f32 v10, v10
    s_nop 0
    v_mul_f32 v196, v196, v10
    v_mul_f32 v197, v197, v10
    v_mul_f32 v198, v198, v10
    v_mul_f32 v199, v199, v10
    v_mul_f32 v200, v200, v10
    v_mul_f32 v201, v201, v10
    v_mul_f32 v202, v202, v10
    v_mul_f32 v203, v203, v10
    v_mul_f32 v204, v204, v10
    v_mul_f32 v205, v205, v10
    v_mul_f32 v206, v206, v10
    v_mul_f32 v207, v207, v10
    v_cvt_pk_bf16_f32 v216, v196, v197
    v_cvt_pk_bf16_f32 v217, v198, v199
    v_cvt_pk_bf16_f32 v218, v200, v201
    v_cvt_pk_bf16_f32 v219, v202, v203
    v_cvt_pk_bf16_f32 v220, v204, v205
    v_cvt_pk_bf16_f32 v221, v206, v207
    buffer_store_dwordx4 v[216:219], v5, s[4:7], s29 offen sc1
    buffer_store_dwordx2 v[220:221], v8, s[4:7], s30 offen sc1
    s_lshl_b32 s28, s24, 7
    s_add_u32 s28, s28, 100532224
    s_waitcnt vmcnt(0)
    s_mov_b64 s[38:39], exec
    s_mov_b64 exec, 1
    buffer_atomic_add v19, v15, s[4:7], s28 offen
    s_mov_b64 exec, s[38:39]
    s_add_u32 s24, s24, 20
    s_cmp_lt_u32 s24, 64
    s_cbranch_scc1 F1_LOOP
    s_branch K2_END
W_F2:
    s_load_dwordx2 s[40:41], s[0:1], 136
    s_waitcnt lgkmcnt(0)
    s_and_b32 s41, s41, 0xffff
    s_mov_b32 s42, 3670016
    s_mov_b32 s43, 0x00020000
    s_sub_u32 s27, s26, 4
    s_lshl_b32 s27, s27, 2
    s_add_u32 s27, s27, s20
    v_cmp_eq_u32 vcc, 1, v1
    v_mov_b32 v10, 0
    v_mov_b32 v11, 40960
    s_nop 0
    v_cndmask_b32 v6, v10, v11, vcc
    v_mov_b32 v11, 8192
    v_cndmask_b32 v7, v10, v11, vcc
    v_mov_b32 v10, 112
    v_mov_b32 v11, 8
    v_cndmask_b32 v8, v10, v11, vcc
    v_mov_b32 v10, 56
    v_mov_b32 v11, 16
    v_cndmask_b32 v9, v10, v11, vcc
    v_mov_b32 v7, 16
    v_mov_b32 v9, 14
    v_lshlrev_b32 v16, 4, v1
    v_mul_u32_u24 v17, 1792, v3
    v_lshl_add_u32 v17, v4, 4, v17
    v_lshlrev_b32 v18, 2, v3
F2_LOOP:
    s_lshl_b32 s28, s24, 7
    s_add_u32 s28, s28, 100507648
F2_W1:
    buffer_load_dword v10, v6, s[4:7], s28 offen sc1
    s_waitcnt vmcnt(0)
    v_cmp_lt_u32 vcc, v10, v8
    s_cbranch_vccz F2_W1_ok
    s_sub_u32 s23, s23, 1
    s_cmp_gt_i32 s23, 0
    s_cbranch_scc1 F2_W1
F2_W1_ok:
    s_mul_i32 s28, s24, 458752
    s_lshl_b32 s29, s27, 10
    s_add_u32 s28, s28, s29
    s_add_u32 s28, s28, 14680064
    buffer_load_dwordx4 v[20:23], v16, s[4:7], s28 offen sc1
    s_add_u32 s28, s28, 28672
    buffer_load_dwordx4 v[24:27], v16, s[4:7], s28 offen sc1
    s_add_u32 s28, s28, 28672
    buffer_load_dwordx4 v[28:31], v16, s[4:7], s28 offen sc1
    s_add_u32 s28, s28, 28672
    buffer_load_dwordx4 v[32:35], v16, s[4:7], s28 offen sc1
    s_add_u32 s28, s28, 28672
    buffer_load_dwordx4 v[36:39], v16, s[4:7], s28 offen sc1
    s_add_u32 s28, s28, 28672
    buffer_load_dwordx4 v[40:43], v16, s[4:7], s28 offen sc1
    s_add_u32 s28, s28, 28672
    buffer_load_dwordx4 v[44:47], v16, s[4:7], s28 offen sc1
    s_add_u32 s28, s28, 28672
    buffer_load_dwordx4 v[48:51], v16, s[4:7], s28 offen sc1
    s_add_u32 s28, s28, 28672
    buffer_load_dwordx4 v[52:55], v16, s[4:7], s28 offen sc1
    s_add_u32 s28, s28, 28672
    buffer_load_dwordx4 v[56:59], v16, s[4:7], s28 offen sc1
    s_add_u32 s28, s28, 28672
    buffer_load_dwordx4 v[60:63], v16, s[4:7], s28 offen sc1
    s_add_u32 s28, s28, 28672
    buffer_load_dwordx4 v[64:67], v16, s[4:7], s28 offen sc1
    s_add_u32 s28, s28, 28672
    buffer_load_dwordx4 v[68:71], v16, s[4:7], s28 offen sc1
    s_add_u32 s28, s28, 28672
    buffer_load_dwordx4 v[72:75], v16, s[4:7], s28 offen sc1
    s_add_u32 s28, s28, 28672
    buffer_load_dwordx4 v[76:79], v16, s[4:7], s28 offen sc1
    s_add_u32 s28, s28, 28672
    buffer_load_dwordx4 v[80:83], v16, s[4:7], s28 offen sc1
    s_add_u32 s28, s28, 28672
    s_mul_i32 s28, s24, 57344
    s_lshl_b32 s29, s27, 11
    s_add_u32 s28, s28, s29
    s_add_u32 s28, s28, 93159424
    s_add_u32 s29, s28, 3670016
    buffer_load_dwordx4 v[124:127], v5, s[4:7], s28 offen offset:0 sc1
    buffer_load_dwordx4 v[132:135], v5, s[4:7], s29 offen offset:0 sc1
    buffer_load_dwordx4 v[128:131], v5, s[4:7], s28 offen offset:1024 sc1
    buffer_load_dwordx4 v[136:139], v5, s[4:7], s29 offen offset:1024 sc1
    s_lshl_b32 s28, s24, 7
    s_add_u32 s28, s28, 100499456
    buffer_load_dword v140, v18, s[4:7], s28 offen sc1
    buffer_load_dword v141, v18, s[4:7], s28 offen offset:64 sc1
    s_lshl_b32 s28, s24, 7
    s_add_u32 s28, s28, 100532224
F2_W2:
    buffer_load_dword v10, v15, s[4:7], s28 offen sc1
    s_waitcnt vmcnt(0)
    v_cmp_lt_u32 vcc, v10, v7
    s_cbranch_vccz F2_W2_ok
    s_sub_u32 s23, s23, 1
    s_cmp_gt_i32 s23, 0
    s_cbranch_scc1 F2_W2
F2_W2_ok:
    s_lshl_b32 s28, s24, 7
    s_add_u32 s28, s28, 100524032
F2_W3:
    buffer_load_dword v10, v15, s[4:7], s28 offen sc1
    s_waitcnt vmcnt(0)
    v_cmp_lt_u32 vcc, v10, v9
    s_cbranch_vccz F2_W3_ok
    s_sub_u32 s23, s23, 1
    s_cmp_gt_i32 s23, 0
    s_cbranch_scc1 F2_W3
F2_W3_ok:
    s_mul_i32 s28, s24, 49152
    s_add_u32 s28, s28, 89784320
    s_mul_i32 s29, s20, 12288
    s_add_u32 s28, s28, s29
    v_add_u32 v14, s29, v5
    buffer_load_dwordx4 v[144:147], v5, s[4:7], s28 offen offset:0 sc1
    buffer_load_dwordx4 v[148:151], v5, s[4:7], s28 offen offset:1024 sc1
    buffer_load_dwordx4 v[152:155], v5, s[4:7], s28 offen offset:2048 sc1
    buffer_load_dwordx4 v[156:159], v5, s[4:7], s28 offen offset:3072 sc1
    s_add_u32 s28, s28, 4096
    buffer_load_dwordx4 v[160:163], v5, s[4:7], s28 offen offset:0 sc1
    buffer_load_dwordx4 v[164:167], v5, s[4:7], s28 offen offset:1024 sc1
    buffer_load_dwordx4 v[168:171], v5, s[4:7], s28 offen offset:2048 sc1
    buffer_load_dwordx4 v[172:175], v5, s[4:7], s28 offen offset:3072 sc1
    s_add_u32 s28, s28, 4096
    buffer_load_dwordx4 v[176:179], v5, s[4:7], s28 offen offset:0 sc1
    buffer_load_dwordx4 v[180:183], v5, s[4:7], s28 offen offset:1024 sc1
    buffer_load_dwordx4 v[184:187], v5, s[4:7], s28 offen offset:2048 sc1
    buffer_load_dwordx4 v[188:191], v5, s[4:7], s28 offen offset:3072 sc1
    s_mul_i32 s28, s24, 229376
    s_lshl_b32 s29, s27, 13
    s_add_u32 s28, s28, s29
    s_add_u32 s28, s28, 75104256
    s_add_u32 s29, s28, 4096
    buffer_load_dwordx4 v[84:87], v5, s[4:7], s28 offen offset:0 sc1
    buffer_load_dwordx4 v[88:91], v5, s[4:7], s28 offen offset:1024 sc1
    buffer_load_dwordx4 v[92:95], v5, s[4:7], s28 offen offset:2048 sc1
    buffer_load_dwordx4 v[96:99], v5, s[4:7], s28 offen offset:3072 sc1
    buffer_load_dwordx4 v[100:103], v5, s[4:7], s29 offen offset:0 sc1
    buffer_load_dwordx4 v[104:107], v5, s[4:7], s29 offen offset:1024 sc1
    buffer_load_dwordx4 v[108:111], v5, s[4:7], s29 offen offset:2048 sc1
    buffer_load_dwordx4 v[112:115], v5, s[4:7], s29 offen offset:3072 sc1
    v_mov_b32 v116, 0
    v_mov_b32 v117, 0
    v_mov_b32 v118, 0
    v_mov_b32 v119, 0
    v_mov_b32 v120, 0
    v_mov_b32 v121, 0
    v_mov_b32 v122, 0
    v_mov_b32 v123, 0
    s_waitcnt vmcnt(8)
    ds_write_b128 v14, v[144:147] offset:0
    ds_write_b128 v14, v[148:151] offset:1024
    ds_write_b128 v14, v[152:155] offset:2048
    ds_write_b128 v14, v[156:159] offset:3072
    ds_write_b128 v14, v[160:163] offset:4096
    ds_write_b128 v14, v[164:167] offset:5120
    ds_write_b128 v14, v[168:171] offset:6144
    ds_write_b128 v14, v[172:175] offset:7168
    ds_write_b128 v14, v[176:179] offset:8192
    ds_write_b128 v14, v[180:183] offset:9216
    ds_write_b128 v14, v[184:187] offset:10240
    ds_write_b128 v14, v[188:191] offset:11264
    s_waitcnt lgkmcnt(0)
    s_barrier
    ds_read_b128 a[0:3], v5 offset:0
    ds_read_b128 a[4:7], v5 offset:1024
    ds_read_b128 a[8:11], v5 offset:2048
    ds_read_b128 a[12:15], v5 offset:3072
    ds_read_b128 a[16:19], v5 offset:4096
    ds_read_b128 a[20:23], v5 offset:5120
    ds_read_b128 a[24:27], v5 offset:6144
    ds_read_b128 a[28:31], v5 offset:7168
    ds_read_b128 a[32:35], v5 offset:8192
    ds_read_b128 a[36:39], v5 offset:9216
    ds_read_b128 a[40:43], v5 offset:10240
    ds_read_b128 a[44:47], v5 offset:11264
    ds_read_b128 a[48:51], v5 offset:12288
    ds_read_b128 a[52:55], v5 offset:13312
    ds_read_b128 a[56:59], v5 offset:14336
    ds_read_b128 a[60:63], v5 offset:15360
    ds_read_b128 a[64:67], v5 offset:16384
    ds_read_b128 a[68:71], v5 offset:17408
    ds_read_b128 a[72:75], v5 offset:18432
    ds_read_b128 a[76:79], v5 offset:19456
    ds_read_b128 a[80:83], v5 offset:20480
    ds_read_b128 a[84:87], v5 offset:21504
    ds_read_b128 a[88:91], v5 offset:22528
    ds_read_b128 a[92:95], v5 offset:23552
    ds_read_b128 a[96:99], v5 offset:24576
    ds_read_b128 a[100:103], v5 offset:25600
    ds_read_b128 a[104:107], v5 offset:26624
    ds_read_b128 a[108:111], v5 offset:27648
    ds_read_b128 a[112:115], v5 offset:28672
    ds_read_b128 a[116:119], v5 offset:29696
    ds_read_b128 a[120:123], v5 offset:30720
    ds_read_b128 a[124:127], v5 offset:31744
    ds_read_b128 a[128:131], v5 offset:32768
    ds_read_b128 a[132:135], v5 offset:33792
    ds_read_b128 a[136:139], v5 offset:34816
    ds_read_b128 a[140:143], v5 offset:35840
    ds_read_b128 a[144:147], v5 offset:36864
    ds_read_b128 a[148:151], v5 offset:37888
    ds_read_b128 a[152:155], v5 offset:38912
    ds_read_b128 a[156:159], v5 offset:39936
    ds_read_b128 a[160:163], v5 offset:40960
    ds_read_b128 a[164:167], v5 offset:41984
    ds_read_b128 a[168:171], v5 offset:43008
    ds_read_b128 a[172:175], v5 offset:44032
    ds_read_b128 a[176:179], v5 offset:45056
    ds_read_b128 a[180:183], v5 offset:46080
    ds_read_b128 a[184:187], v5 offset:47104
    ds_read_b128 a[188:191], v5 offset:48128
    s_waitcnt vmcnt(0) lgkmcnt(0)
    s_barrier
    v_mfma_f32_16x16x32_bf16 v[116:119], v[20:23], a[0:3], v[116:119]
    v_mfma_f32_16x16x32_bf16 v[120:123], v[20:23], a[96:99], v[120:123]
    v_mfma_f32_16x16x32_bf16 v[116:119], v[24:27], a[4:7], v[116:119]
    v_mfma_f32_16x16x32_bf16 v[120:123], v[24:27], a[100:103], v[120:123]
    v_mfma_f32_16x16x32_bf16 v[116:119], v[28:31], a[8:11], v[116:119]
    v_mfma_f32_16x16x32_bf16 v[120:123], v[28:31], a[104:107], v[120:123]
    v_mfma_f32_16x16x32_bf16 v[116:119], v[32:35], a[12:15], v[116:119]
    v_mfma_f32_16x16x32_bf16 v[120:123], v[32:35], a[108:111], v[120:123]
    v_mfma_f32_16x16x32_bf16 v[116:119], v[36:39], a[16:19], v[116:119]
    v_mfma_f32_16x16x32_bf16 v[120:123], v[36:39], a[112:115], v[120:123]
    v_mfma_f32_16x16x32_bf16 v[116:119], v[40:43], a[20:23], v[116:119]
    v_mfma_f32_16x16x32_bf16 v[120:123], v[40:43], a[116:119], v[120:123]
    v_mfma_f32_16x16x32_bf16 v[116:119], v[44:47], a[24:27], v[116:119]
    v_mfma_f32_16x16x32_bf16 v[120:123], v[44:47], a[120:123], v[120:123]
    v_mfma_f32_16x16x32_bf16 v[116:119], v[48:51], a[28:31], v[116:119]
    v_mfma_f32_16x16x32_bf16 v[120:123], v[48:51], a[124:127], v[120:123]
    v_mfma_f32_16x16x32_bf16 v[116:119], v[52:55], a[32:35], v[116:119]
    v_mfma_f32_16x16x32_bf16 v[120:123], v[52:55], a[128:131], v[120:123]
    v_mfma_f32_16x16x32_bf16 v[116:119], v[56:59], a[36:39], v[116:119]
    v_mfma_f32_16x16x32_bf16 v[120:123], v[56:59], a[132:135], v[120:123]
    v_mfma_f32_16x16x32_bf16 v[116:119], v[60:63], a[40:43], v[116:119]
    v_mfma_f32_16x16x32_bf16 v[120:123], v[60:63], a[136:139], v[120:123]
    v_mfma_f32_16x16x32_bf16 v[116:119], v[64:67], a[44:47], v[116:119]
    v_mfma_f32_16x16x32_bf16 v[120:123], v[64:67], a[140:143], v[120:123]
    v_mfma_f32_16x16x32_bf16 v[116:119], v[68:71], a[48:51], v[116:119]
    v_mfma_f32_16x16x32_bf16 v[120:123], v[68:71], a[144:147], v[120:123]
    v_mfma_f32_16x16x32_bf16 v[116:119], v[72:75], a[52:55], v[116:119]
    v_mfma_f32_16x16x32_bf16 v[120:123], v[72:75], a[148:151], v[120:123]
    v_mfma_f32_16x16x32_bf16 v[116:119], v[76:79], a[56:59], v[116:119]
    v_mfma_f32_16x16x32_bf16 v[120:123], v[76:79], a[152:155], v[120:123]
    v_mfma_f32_16x16x32_bf16 v[116:119], v[80:83], a[60:63], v[116:119]
    v_mfma_f32_16x16x32_bf16 v[120:123], v[80:83], a[156:159], v[120:123]
    v_mfma_f32_16x16x32_bf16 v[116:119], v[84:87], a[64:67], v[116:119]
    v_mfma_f32_16x16x32_bf16 v[120:123], v[84:87], a[160:163], v[120:123]
    v_mfma_f32_16x16x32_bf16 v[116:119], v[88:91], a[68:71], v[116:119]
    v_mfma_f32_16x16x32_bf16 v[120:123], v[88:91], a[164:167], v[120:123]
    v_mfma_f32_16x16x32_bf16 v[116:119], v[92:95], a[72:75], v[116:119]
    v_mfma_f32_16x16x32_bf16 v[120:123], v[92:95], a[168:171], v[120:123]
    v_mfma_f32_16x16x32_bf16 v[116:119], v[96:99], a[76:79], v[116:119]
    v_mfma_f32_16x16x32_bf16 v[120:123], v[96:99], a[172:175], v[120:123]
    v_mfma_f32_16x16x32_bf16 v[116:119], v[100:103], a[80:83], v[116:119]
    v_mfma_f32_16x16x32_bf16 v[120:123], v[100:103], a[176:179], v[120:123]
    v_mfma_f32_16x16x32_bf16 v[116:119], v[104:107], a[84:87], v[116:119]
    v_mfma_f32_16x16x32_bf16 v[120:123], v[104:107], a[180:183], v[120:123]
    v_mfma_f32_16x16x32_bf16 v[116:119], v[108:111], a[88:91], v[116:119]
    v_mfma_f32_16x16x32_bf16 v[120:123], v[108:111], a[184:187], v[120:123]
    v_mfma_f32_16x16x32_bf16 v[116:119], v[112:115], a[92:95], v[116:119]
    v_mfma_f32_16x16x32_bf16 v[120:123], v[112:115], a[188:191], v[120:123]
    s_nop 7
    s_nop 1
    s_mul_i32 s28, s24, 57344
    s_lshl_b32 s29, s27, 6
    s_add_u32 s28, s28, s29
    v_cvt_pk_bf16_f32 v10, v116, v117
    v_and_b32 v11, 0xffff0000, v10
    v_lshlrev_b32 v10, 16, v10
    v_mul_f32 v10, v140, v10
    v_mul_f32 v11, v140, v11
    v_cvt_pk_bf16_f32 v10, v10, v11
    v_and_b32 v11, 0xffff0000, v10
    v_lshlrev_b32 v10, 16, v10
    v_add_f32 v116, v124, v132
    v_add_f32 v117, v125, v133
    v_add_f32 v116, v116, v10
    v_add_f32 v117, v117, v11
    v_cvt_pk_bf16_f32 v10, v118, v119
    v_and_b32 v11, 0xffff0000, v10
    v_lshlrev_b32 v10, 16, v10
    v_mul_f32 v10, v140, v10
    v_mul_f32 v11, v140, v11
    v_cvt_pk_bf16_f32 v10, v10, v11
    v_and_b32 v11, 0xffff0000, v10
    v_lshlrev_b32 v10, 16, v10
    v_add_f32 v118, v126, v134
    v_add_f32 v119, v127, v135
    v_add_f32 v118, v118, v10
    v_add_f32 v119, v119, v11
    buffer_store_dwordx4 v[116:119], v17, s[40:43], s28 offen
    s_add_u32 s28, s28, 28672
    v_cvt_pk_bf16_f32 v10, v120, v121
    v_and_b32 v11, 0xffff0000, v10
    v_lshlrev_b32 v10, 16, v10
    v_mul_f32 v10, v141, v10
    v_mul_f32 v11, v141, v11
    v_cvt_pk_bf16_f32 v10, v10, v11
    v_and_b32 v11, 0xffff0000, v10
    v_lshlrev_b32 v10, 16, v10
    v_add_f32 v120, v128, v136
    v_add_f32 v121, v129, v137
    v_add_f32 v120, v120, v10
    v_add_f32 v121, v121, v11
    v_cvt_pk_bf16_f32 v10, v122, v123
    v_and_b32 v11, 0xffff0000, v10
    v_lshlrev_b32 v10, 16, v10
    v_mul_f32 v10, v141, v10
    v_mul_f32 v11, v141, v11
    v_cvt_pk_bf16_f32 v10, v10, v11
    v_and_b32 v11, 0xffff0000, v10
    v_lshlrev_b32 v10, 16, v10
    v_add_f32 v122, v130, v138
    v_add_f32 v123, v131, v139
    v_add_f32 v122, v122, v10
    v_add_f32 v123, v123, v11
    buffer_store_dwordx4 v[120:123], v17, s[40:43], s28 offen
    s_add_u32 s24, s24, 20
    s_cmp_lt_u32 s24, 64
    s_cbranch_scc1 F2_LOOP
    s_waitcnt vmcnt(0)
    s_branch K2_END
    s_branch K2_END
K2_AROLE:
    v_lshlrev_b32 v5, 4, v1
    v_lshlrev_b32 v9, 4, v0
    v_mov_b32 v6, v9
    v_add_u32 v7, 4096, v9
    v_cmp_gt_u32 vcc, 192, v0
    v_mov_b32 v10, 536870912
    s_nop 1
    v_cndmask_b32 v7, v10, v7, vcc
    v_cmp_gt_u32 vcc, 8, v3
    v_mov_b32 v10, 0xeeeeeeee
    v_mov_b32 v11, 0x44444444
    s_nop 1
    v_cndmask_b32 v8, v10, v11, vcc
    s_mov_b32 s24, s21
    s_mul_i32 s25, s24, 401408
    s_add_u32 s25, s25, 0
    s_mul_i32 s26, s20, 86016
    s_add_u32 s26, s26, s25
    s_add_u32 s27, s20, 24
    s_mul_i32 s27, s27, 14336
    s_add_u32 s27, s27, s25
    s_mul_i32 s28, s20, 28672
    s_add_u32 s28, s28, 49152
    v_add_u32 v12, s28, v5
    s_cmp_lt_u32 s20, 3
    s_cselect_b32 s56, s20, 0
    s_lshl_b32 s56, s56, 11
    s_add_u32 s56, s56, 8192
    s_mov_b32 s57, 10240
    s_mov_b32 s58, 12288
    s_cmp_eq_u32 s20, 1
    s_cselect_b32 s57, 0x2000, s57
    s_cmp_eq_u32 s20, 2
    s_cselect_b32 s57, 0x2000, s57
    s_cselect_b32 s58, 0x2800, s58
    s_add_u32 s29, s26, 0
    s_add_u32 s30, s29, 0
    buffer_load_dwordx4 a[0:3], v5, s[4:7], s30 offen
    buffer_load_dwordx4 a[4:7], v5, s[4:7], s30 offen offset:1024
    s_add_u32 s30, s29, 2048
    buffer_load_dwordx4 a[8:11], v5, s[4:7], s30 offen
    buffer_load_dwordx4 a[12:15], v5, s[4:7], s30 offen offset:1024
    s_add_u32 s30, s29, 4096
    buffer_load_dwordx4 a[16:19], v5, s[4:7], s30 offen
    buffer_load_dwordx4 a[20:23], v5, s[4:7], s30 offen offset:1024
    s_add_u32 s30, s29, 6144
    buffer_load_dwordx4 a[24:27], v5, s[4:7], s30 offen
    buffer_load_dwordx4 a[28:31], v5, s[4:7], s30 offen offset:1024
    s_add_u32 s30, s29, s56
    buffer_load_dwordx4 a[32:35], v5, s[4:7], s30 offen
    buffer_load_dwordx4 a[36:39], v5, s[4:7], s30 offen offset:1024
    s_add_u32 s30, s29, s57
    buffer_load_dwordx4 v[32:35], v5, s[4:7], s30 offen
    buffer_load_dwordx4 v[36:39], v5, s[4:7], s30 offen offset:1024
    s_add_u32 s30, s29, s58
    buffer_load_dwordx4 v[40:43], v5, s[4:7], s30 offen
    buffer_load_dwordx4 v[44:47], v5, s[4:7], s30 offen offset:1024
    s_add_u32 s29, s26, 14336
    s_add_u32 s30, s29, 0
    buffer_load_dwordx4 a[40:43], v5, s[4:7], s30 offen
    buffer_load_dwordx4 a[44:47], v5, s[4:7], s30 offen offset:1024
    s_add_u32 s30, s29, 2048
    buffer_load_dwordx4 a[48:51], v5, s[4:7], s30 offen
    buffer_load_dwordx4 a[52:55], v5, s[4:7], s30 offen offset:1024
    s_add_u32 s30, s29, 4096
    buffer_load_dwordx4 a[56:59], v5, s[4:7], s30 offen
    buffer_load_dwordx4 a[60:63], v5, s[4:7], s30 offen offset:1024
    s_add_u32 s30, s29, 6144
    buffer_load_dwordx4 a[64:67], v5, s[4:7], s30 offen
    buffer_load_dwordx4 a[68:71], v5, s[4:7], s30 offen offset:1024
    s_add_u32 s30, s29, s56
    buffer_load_dwordx4 a[72:75], v5, s[4:7], s30 offen
    buffer_load_dwordx4 a[76:79], v5, s[4:7], s30 offen offset:1024
    s_add_u32 s30, s29, s57
    buffer_load_dwordx4 v[48:51], v5, s[4:7], s30 offen
    buffer_load_dwordx4 v[52:55], v5, s[4:7], s30 offen offset:1024
    s_add_u32 s30, s29, s58
    buffer_load_dwordx4 v[56:59], v5, s[4:7], s30 offen
    buffer_load_dwordx4 v[60:63], v5, s[4:7], s30 offen offset:1024
    s_add_u32 s29, s26, 28672
    s_add_u32 s30, s29, 0
    buffer_load_dwordx4 a[80:83], v5, s[4:7], s30 offen
    buffer_load_dwordx4 a[84:87], v5, s[4:7], s30 offen offset:1024
    s_add_u32 s30, s29, 2048
    buffer_load_dwordx4 a[88:91], v5, s[4:7], s30 offen
    buffer_load_dwordx4 a[92:95], v5, s[4:7], s30 offen offset:1024
    s_add_u32 s30, s29, 4096
    buffer_load_dwordx4 a[96:99], v5, s[4:7], s30 offen
    buffer_load_dwordx4 a[100:103], v5, s[4:7], s30 offen offset:1024
    s_add_u32 s30, s29, 6144
    buffer_load_dwordx4 a[104:107], v5, s[4:7], s30 offen
    buffer_load_dwordx4 a[108:111], v5, s[4:7], s30 offen offset:1024
    s_add_u32 s30, s29, s56
    buffer_load_dwordx4 a[112:115], v5, s[4:7], s30 offen
    buffer_load_dwordx4 a[116:119], v5, s[4:7], s30 offen offset:1024
    s_add_u32 s30, s29, s57
    buffer_load_dwordx4 v[64:67], v5, s[4:7], s30 offen
    buffer_load_dwordx4 v[68:71], v5, s[4:7], s30 offen offset:1024
    s_add_u32 s30, s29, s58
    buffer_load_dwordx4 v[72:75], v5, s[4:7], s30 offen
    buffer_load_dwordx4 v[76:79], v5, s[4:7], s30 offen offset:1024
    s_add_u32 s29, s26, 43008
    s_add_u32 s30, s29, 0
    buffer_load_dwordx4 a[120:123], v5, s[4:7], s30 offen
    buffer_load_dwordx4 a[124:127], v5, s[4:7], s30 offen offset:1024
    s_add_u32 s30, s29, 2048
    buffer_load_dwordx4 a[128:131], v5, s[4:7], s30 offen
    buffer_load_dwordx4 a[132:135], v5, s[4:7], s30 offen offset:1024
    s_add_u32 s30, s29, 4096
    buffer_load_dwordx4 a[136:139], v5, s[4:7], s30 offen
    buffer_load_dwordx4 a[140:143], v5, s[4:7], s30 offen offset:1024
    s_add_u32 s30, s29, 6144
    buffer_load_dwordx4 a[144:147], v5, s[4:7], s30 offen
    buffer_load_dwordx4 a[148:151], v5, s[4:7], s30 offen offset:1024
    s_add_u32 s30, s29, s56
    buffer_load_dwordx4 a[152:155], v5, s[4:7], s30 offen
    buffer_load_dwordx4 a[156:159], v5, s[4:7], s30 offen offset:1024
    s_add_u32 s30, s29, s57
    buffer_load_dwordx4 v[80:83], v5, s[4:7], s30 offen
    buffer_load_dwordx4 v[84:87], v5, s[4:7], s30 offen offset:1024
    s_add_u32 s30, s29, s58
    buffer_load_dwordx4 v[88:91], v5, s[4:7], s30 offen
    buffer_load_dwordx4 v[92:95], v5, s[4:7], s30 offen offset:1024
    s_add_u32 s29, s26, 57344
    s_add_u32 s30, s29, 0
    buffer_load_dwordx4 a[160:163], v5, s[4:7], s30 offen
    buffer_load_dwordx4 a[164:167], v5, s[4:7], s30 offen offset:1024
    s_add_u32 s30, s29, 2048
    buffer_load_dwordx4 a[168:171], v5, s[4:7], s30 offen
    buffer_load_dwordx4 a[172:175], v5, s[4:7], s30 offen offset:1024
    s_add_u32 s30, s29, 4096
    buffer_load_dwordx4 a[176:179], v5, s[4:7], s30 offen
    buffer_load_dwordx4 a[180:183], v5, s[4:7], s30 offen offset:1024
    s_add_u32 s30, s29, 6144
    buffer_load_dwordx4 a[184:187], v5, s[4:7], s30 offen
    buffer_load_dwordx4 a[188:191], v5, s[4:7], s30 offen offset:1024
    s_add_u32 s30, s29, s56
    buffer_load_dwordx4 a[192:195], v5, s[4:7], s30 offen
    buffer_load_dwordx4 a[196:199], v5, s[4:7], s30 offen offset:1024
    s_add_u32 s30, s29, s57
    buffer_load_dwordx4 v[96:99], v5, s[4:7], s30 offen
    buffer_load_dwordx4 v[100:103], v5, s[4:7], s30 offen offset:1024
    s_add_u32 s30, s29, s58
    buffer_load_dwordx4 v[104:107], v5, s[4:7], s30 offen
    buffer_load_dwordx4 v[108:111], v5, s[4:7], s30 offen offset:1024
    s_add_u32 s29, s26, 71680
    s_add_u32 s30, s29, 0
    buffer_load_dwordx4 a[200:203], v5, s[4:7], s30 offen
    buffer_load_dwordx4 a[204:207], v5, s[4:7], s30 offen offset:1024
    s_add_u32 s30, s29, 2048
    buffer_load_dwordx4 a[208:211], v5, s[4:7], s30 offen
    buffer_load_dwordx4 a[212:215], v5, s[4:7], s30 offen offset:1024
    s_add_u32 s30, s29, 4096
    buffer_load_dwordx4 a[216:219], v5, s[4:7], s30 offen
    buffer_load_dwordx4 a[220:223], v5, s[4:7], s30 offen offset:1024
    s_add_u32 s30, s29, 6144
    buffer_load_dwordx4 a[224:227], v5, s[4:7], s30 offen
    buffer_load_dwordx4 a[228:231], v5, s[4:7], s30 offen offset:1024
    s_add_u32 s30, s29, s56
    buffer_load_dwordx4 a[232:235], v5, s[4:7], s30 offen
    buffer_load_dwordx4 a[236:239], v5, s[4:7], s30 offen offset:1024
    s_add_u32 s30, s29, s57
    buffer_load_dwordx4 v[112:115], v5, s[4:7], s30 offen
    buffer_load_dwordx4 v[116:119], v5, s[4:7], s30 offen offset:1024
    s_add_u32 s30, s29, s58
    buffer_load_dwordx4 v[120:123], v5, s[4:7], s30 offen
    buffer_load_dwordx4 v[124:127], v5, s[4:7], s30 offen offset:1024
    s_mov_b32 s29, s27
    s_add_u32 s30, s29, 0
    buffer_load_dwordx4 a[240:243], v5, s[4:7], s30 offen
    buffer_load_dwordx4 a[244:247], v5, s[4:7], s30 offen offset:1024
    s_add_u32 s30, s29, 2048
    buffer_load_dwordx4 a[248:251], v5, s[4:7], s30 offen
    buffer_load_dwordx4 a[252:255], v5, s[4:7], s30 offen offset:1024
    s_add_u32 s30, s29, 4096
    buffer_load_dwordx4 v[232:235], v5, s[4:7], s30 offen
    buffer_load_dwordx4 v[236:239], v5, s[4:7], s30 offen offset:1024
    s_add_u32 s30, s29, 6144
    buffer_load_dwordx4 v[240:243], v5, s[4:7], s30 offen
    buffer_load_dwordx4 v[244:247], v5, s[4:7], s30 offen offset:1024
    s_add_u32 s30, s29, s56
    buffer_load_dwordx4 v[248:251], v5, s[4:7], s30 offen
    buffer_load_dwordx4 v[252:255], v5, s[4:7], s30 offen offset:1024
    s_add_u32 s30, s29, s57
    buffer_load_dwordx4 v[128:131], v5, s[4:7], s30 offen
    buffer_load_dwordx4 v[132:135], v5, s[4:7], s30 offen offset:1024
    s_add_u32 s30, s29, s58
    buffer_load_dwordx4 v[136:139], v5, s[4:7], s30 offen
    buffer_load_dwordx4 v[140:143], v5, s[4:7], s30 offen offset:1024
    s_waitcnt vmcnt(0)
    ds_write_b128 v12, v[32:35] offset:0
    ds_write_b128 v12, v[36:39] offset:1024
    ds_write_b128 v12, v[40:43] offset:2048
    ds_write_b128 v12, v[44:47] offset:3072
    ds_write_b128 v12, v[48:51] offset:4096
    ds_write_b128 v12, v[52:55] offset:5120
    ds_write_b128 v12, v[56:59] offset:6144
    ds_write_b128 v12, v[60:63] offset:7168
    ds_write_b128 v12, v[64:67] offset:8192
    ds_write_b128 v12, v[68:71] offset:9216
    ds_write_b128 v12, v[72:75] offset:10240
    ds_write_b128 v12, v[76:79] offset:11264
    ds_write_b128 v12, v[80:83] offset:12288
    ds_write_b128 v12, v[84:87] offset:13312
    ds_write_b128 v12, v[88:91] offset:14336
    ds_write_b128 v12, v[92:95] offset:15360
    ds_write_b128 v12, v[96:99] offset:16384
    ds_write_b128 v12, v[100:103] offset:17408
    ds_write_b128 v12, v[104:107] offset:18432
    ds_write_b128 v12, v[108:111] offset:19456
    ds_write_b128 v12, v[112:115] offset:20480
    ds_write_b128 v12, v[116:119] offset:21504
    ds_write_b128 v12, v[120:123] offset:22528
    ds_write_b128 v12, v[124:127] offset:23552
    ds_write_b128 v12, v[128:131] offset:24576
    ds_write_b128 v12, v[132:135] offset:25600
    ds_write_b128 v12, v[136:139] offset:26624
    ds_write_b128 v12, v[140:143] offset:27648
    s_waitcnt lgkmcnt(0)
    s_mul_i32 s28, s20, 6272
    s_add_u32 s28, s28, 8192
    v_lshrrev_b32 v10, 2, v3
    v_mul_u32_u24 v10, 392, v10
    v_and_b32 v11, 3, v3
    v_lshl_add_u32 v10, v11, 5, v10
    v_lshl_add_u32 v10, v4, 3, v10
    v_add_u32 v13, s28, v10
    s_and_b32 s29, s20, 1
    s_lshl_b32 s29, s29, 7
    s_add_u32 s29, s29, 4704
    v_add_u32 v14, s29, v13
    v_mul_u32_u24 v10, 392, v4
    v_lshrrev_b32 v11, 2, v3
    v_lshl_add_u32 v10, v11, 5, v10
    v_and_b32 v11, 3, v3
    v_lshl_add_u32 v10, v11, 3, v10
    v_add_u32 v15, s28, v10
    v_lshrrev_b32 v10, 1, v4
    v_lshlrev_b32 v10, 8, v10
    v_and_b32 v11, 7, v3
    v_lshl_add_u32 v10, v11, 4, v10
    v_and_b32 v11, 1, v4
    v_lshl_add_u32 v10, v11, 3, v10
    s_mul_i32 s29, s20, 1536
    v_add_u32 v16, s29, v10
    s_lshr_b32 s29, s20, 1
    s_add_u32 s29, s29, 12
    s_lshl_b32 s29, s29, 9
    v_add_u32 v17, s29, v10
    s_mul_i32 s29, s20, 3456
    s_add_u32 s29, s29, 33792
    v_mul_u32_u24 v10, 288, v4
    v_lshl_add_u32 v10, v3, 4, v10
    v_add_u32 v18, s29, v10
    v_lshrrev_b32 v22, 5, v1
    v_bfe_u32 v23, v1, 1, 4
    v_and_b32 v24, 1, v1
    v_min_u32 v25, 11, v23
    v_lshrrev_b32 v26, 2, v25
    v_and_b32 v27, 3, v25
    s_lshl_b32 s29, s20, 1
    v_add_u32 v28, s29, v22
    v_lshl_add_u32 v28, v24, 3, v28
    v_mul_u32_u24 v29, 288, v27
    v_lshl_add_u32 v29, v28, 4, v29
    v_mul_u32_u24 v30, 1152, v26
    v_add_u32 v29, v29, v30
    v_add_u32 v19, 33792, v29
    s_and_b32 s29, s24, 1
    s_lshr_b32 s30, s24, 1
    s_lshl_b32 s30, s30, 10
    s_lshl_b32 s31, s29, 9
    s_add_u32 s30, s30, s31
    v_lshrrev_b32 v30, 1, v27
    v_lshl_add_u32 v30, v30, 4, v28
    v_lshlrev_b32 v30, 4, v30
    v_and_b32 v31, 1, v27
    v_lshl_add_u32 v30, v31, 3, v30
    v_lshl_add_u32 v31, v26, 2, v30
    v_add_u32 v31, s30, v31
    s_lshr_b32 s30, s24, 2
    s_lshl_b32 s30, s30, 10
    s_bfe_u32 s31, s24, 0x10001
    s_lshl_b32 s31, s31, 9
    s_add_u32 s30, s30, s31
    s_lshl_b32 s31, s29, 2
    s_add_u32 s30, s30, s31
    s_add_u32 s30, s30, 8192
    v_add_u32 v30, s30, v30
    v_cmp_eq_u32 vcc, 2, v26
    s_nop 1
    v_cndmask_b32 v20, v31, v30, vcc
    v_cmp_gt_u32 s[40:41], 12, v23
    v_mov_b32 v30, 536870912
    s_nop 1
    v_cndmask_b32 v20, v30, v20, s[40:41]
    v_cmp_eq_u32 s[42:43], 1, v24
    v_cmp_gt_u32 vcc, 10, v23
    v_mov_b32 v30, 0
    v_mov_b32 v31, 1.0
    s_nop 0
    v_cndmask_b32 v21, v30, v31, vcc
    s_cmp_eq_u32 s20, 0
    s_cselect_b32 s29, 4, 6
    s_mov_b32 s44, 74317824
    s_mov_b32 s45, 12288
    s_cselect_b32 s44, 73400320, s44
    s_cselect_b32 s45, 7168, s45
    s_mul_i32 s30, s29, s24
    v_add_u32 v22, s30, v1
    v_lshlrev_b32 v22, 7, v22
    v_cmp_gt_u32 vcc, s29, v1
    v_mov_b32 v30, 536870912
    s_nop 1
    v_cndmask_b32 v22, v30, v22, vcc
    s_cmp_lt_u32 s20, 2
    s_cbranch_scc1 A_WOK2
    v_mov_b32 v22, 536870912
    s_cmp_eq_u32 s20, 2
    s_cbranch_scc0 A_WOK
    s_mov_b32 s44, 100556800
    s_mov_b32 s45, 128
    v_cmp_eq_u32 vcc, 0, v1
    v_mov_b32 v30, 0
    s_nop 1
    v_cndmask_b32 v22, v22, v30, vcc
    s_branch A_WOK2
A_WOK:
    s_cmp_eq_u32 s20, 3
    s_cbranch_scc0 A_WOK2
    s_mov_b32 s44, 12845056
    s_mov_b32 s45, 28672
    s_mul_i32 s30, s24, 14
    v_add_u32 v22, s30, v1
    v_lshlrev_b32 v22, 7, v22
    v_cmp_gt_u32 vcc, 14, v1
    v_mov_b32 v30, 536870912
    s_nop 1
    v_cndmask_b32 v22, v30, v22, vcc
A_WOK2:
    v_mov_b32 v32, 0
    v_mov_b32 v33, 0
    v_mov_b32 v34, 0
    v_mov_b32 v35, 0
    ds_write_b128 v9, v[32:35] offset:8192
    ds_write_b128 v9, v[32:35] offset:12288
    ds_write_b128 v9, v[32:35] offset:16384
    ds_write_b128 v9, v[32:35] offset:20480
    ds_write_b128 v9, v[32:35] offset:24576
    ds_write_b128 v9, v[32:35] offset:28672
    ds_write_b128 v9, v[32:35] offset:32768
    s_mul_i32 s46, s20, 3072
    s_add_u32 s46, s46, 12845056
    s_lshr_b32 s47, s20, 1
    s_lshl_b32 s47, s47, 10
    s_add_u32 s47, s47, 12857344
    s_add_u32 s29, s46, 0
    s_add_u32 s30, s47, 0
    buffer_load_dwordx4 v[112:115], v5, s[4:7], s29 offen offset:0
    buffer_load_dwordx4 v[116:119], v5, s[4:7], s29 offen offset:1024
    buffer_load_dwordx4 v[120:123], v5, s[4:7], s29 offen offset:2048
    buffer_load_dwordx4 v[124:127], v5, s[4:7], s30 offen
    s_add_u32 s29, s46, 14336
    s_add_u32 s30, s47, 14336
    buffer_load_dwordx4 v[128:131], v5, s[4:7], s29 offen offset:0
    buffer_load_dwordx4 v[132:135], v5, s[4:7], s29 offen offset:1024
    buffer_load_dwordx4 v[136:139], v5, s[4:7], s29 offen offset:2048
    buffer_load_dwordx4 v[140:143], v5, s[4:7], s30 offen
    s_add_u32 s46, s46, 28672
    s_add_u32 s47, s47, 28672
    s_mov_b32 s48, 73400320
    s_mov_b32 s49, 74317824
    s_mov_b32 s50, 0
    s_mul_i32 s51, s45, 2
    s_add_u32 s44, s44, s51
    s_mov_b32 s52, 100556800
    s_mov_b32 s53, 0x3fb8aa3b
    s_cmp_eq_u32 s20, 3
    s_cbranch_scc0 A_V7
    v_add_u32 v7, 4096, v5
A_V7:
    s_waitcnt lgkmcnt(0)
    s_barrier
    s_cmp_eq_u32 s20, 1
    s_cbranch_scc1 A_LOOP1
    s_cmp_eq_u32 s20, 2
    s_cbranch_scc1 A_LOOP2
    s_cmp_eq_u32 s20, 3
    s_cbranch_scc1 A_LOOP3
A_LOOP0:
    v_mov_b32 v172, 0
    v_mov_b32 v173, 0
    v_mov_b32 v174, 0
    v_mov_b32 v175, 0
    v_mov_b32 v176, 0
    v_mov_b32 v177, 0
    v_mov_b32 v178, 0
    v_mov_b32 v179, 0
    v_mov_b32 v180, 0
    v_mov_b32 v181, 0
    v_mov_b32 v182, 0
    v_mov_b32 v183, 0
    v_mov_b32 v184, 0
    v_mov_b32 v185, 0
    v_mov_b32 v186, 0
    v_mov_b32 v187, 0
    v_mov_b32 v188, 0
    v_mov_b32 v189, 0
    v_mov_b32 v190, 0
    v_mov_b32 v191, 0
    v_mov_b32 v192, 0
    v_mov_b32 v193, 0
    v_mov_b32 v194, 0
    v_mov_b32 v195, 0
    v_mov_b32 v196, 0
    v_mov_b32 v197, 0
    v_mov_b32 v198, 0
    v_mov_b32 v199, 0
    v_mov_b32 v68, 0
    v_mov_b32 v69, 0
    v_mov_b32 v70, 0
    v_mov_b32 v71, 0
    v_mov_b32 v72, 0
    v_mov_b32 v73, 0
    v_mov_b32 v74, 0
    v_mov_b32 v75, 0
    v_mov_b32 v76, 0
    v_mov_b32 v77, 0
    v_mov_b32 v78, 0
    v_mov_b32 v79, 0
    ds_read_b128 v[200:203], v12 offset:0
    ds_read_b128 v[204:207], v12 offset:1024
    ds_read_b128 v[208:211], v12 offset:2048
    ds_read_b128 v[212:215], v12 offset:3072
A_POLL0:
    buffer_load_dwordx4 v[52:55], v6, s[4:7], s48 offen sc1
    buffer_load_dwordx4 v[56:59], v7, s[4:7], s48 offen sc1
    s_waitcnt vmcnt(0)
    v_max3_u32 v10, v52, v53, v54
    v_max3_u32 v11, v55, v56, v57
    v_max3_u32 v10, v10, v58, v59
    v_max_u32 v10, v10, v11
    v_cmp_eq_u32 vcc, -1, v10
    s_cbranch_vccz A_POLL0_ok
    s_sub_u32 s23, s23, 1
    s_cmp_gt_i32 s23, 0
    s_cbranch_scc1 A_POLL0
A_POLL0_ok:
    ds_write_b128 v9, v[52:55]
    ds_write_b128 v9, v[56:59] offset:4096
    v_smfmac_f32_16x16x64_bf16 v[172:175], v[52:55], a[0:7], v8
    v_smfmac_f32_16x16x64_bf16 v[176:179], v[52:55], a[40:47], v8
    v_smfmac_f32_16x16x64_bf16 v[180:183], v[52:55], a[80:87], v8
    v_smfmac_f32_16x16x64_bf16 v[184:187], v[52:55], a[120:127], v8
    v_smfmac_f32_16x16x64_bf16 v[188:191], v[52:55], a[160:167], v8
    s_waitcnt lgkmcnt(0)
    s_barrier
    ds_read_b128 v[148:151], v5 offset:1024
    ds_read_b128 v[152:155], v5 offset:2048
    ds_read_b128 v[156:159], v5 offset:3072
    ds_read_b128 v[164:167], v5 offset:5120
    ds_read_b128 v[168:171], v5 offset:6144
    buffer_load_dword v23, v22, s[4:7], s44 offen sc1
    s_add_u32 s44, s44, s45
    v_smfmac_f32_16x16x64_bf16 v[192:195], v[52:55], a[200:207], v8
    v_smfmac_f32_16x16x64_bf16 v[196:199], v[52:55], a[240:247], v8
    v_smfmac_f32_16x16x64_bf16 v[172:175], v[56:59], a[32:39], v8
    v_smfmac_f32_16x16x64_bf16 v[176:179], v[56:59], a[72:79], v8
    v_smfmac_f32_16x16x64_bf16 v[180:183], v[56:59], a[112:119], v8
    v_smfmac_f32_16x16x64_bf16 v[184:187], v[56:59], a[152:159], v8
    v_smfmac_f32_16x16x64_bf16 v[188:191], v[56:59], a[192:199], v8
    v_smfmac_f32_16x16x64_bf16 v[192:195], v[56:59], a[232:239], v8
    v_smfmac_f32_16x16x64_bf16 v[196:199], v[56:59], v[248:255], v8
    s_waitcnt lgkmcnt(4)
    v_smfmac_f32_16x16x64_bf16 v[172:175], v[148:151], a[8:15], v8
    s_waitcnt lgkmcnt(3)
    v_smfmac_f32_16x16x64_bf16 v[172:175], v[152:155], a[16:23], v8
    s_waitcnt lgkmcnt(2)
    v_smfmac_f32_16x16x64_bf16 v[172:175], v[156:159], a[24:31], v8
    ds_read_b128 v[216:219], v12 offset:4096
    ds_read_b128 v[220:223], v12 offset:5120
    ds_read_b128 v[224:227], v12 offset:6144
    ds_read_b128 v[228:231], v12 offset:7168
    ds_read_b32 v96, v16 offset:0
    ds_read_b32 v97, v16 offset:128
    ds_read_b32 v98, v16 offset:4
    ds_read_b32 v99, v16 offset:132
    s_waitcnt lgkmcnt(9)
    s_waitcnt lgkmcnt(8)
    v_smfmac_f32_16x16x64_bf16 v[172:175], v[164:167], v[200:207], v8
    v_smfmac_f32_16x16x64_bf16 v[172:175], v[168:171], v[208:215], v8
    v_smfmac_f32_16x16x64_bf16 v[176:179], v[148:151], a[48:55], v8
    ds_read_b128 v[200:203], v12 offset:8192
    ds_read_b128 v[204:207], v12 offset:9216
    ds_read_b128 v[208:211], v12 offset:10240
    ds_read_b128 v[212:215], v12 offset:11264
    ds_read_b32 v100, v16 offset:512
    ds_read_b32 v101, v16 offset:640
    ds_read_b32 v102, v16 offset:516
    ds_read_b32 v103, v16 offset:644
    v_smfmac_f32_16x16x64_bf16 v[176:179], v[152:155], a[56:63], v8
    v_smfmac_f32_16x16x64_bf16 v[176:179], v[156:159], a[64:71], v8
    s_nop 1
    v_cvt_pk_bf16_f32 v60, v172, v173
    v_cvt_pk_bf16_f32 v61, v174, v175
    ds_write_b64 v13, v[60:61] offset:0
    s_waitcnt lgkmcnt(13)
    v_smfmac_f32_16x16x64_bf16 v[176:179], v[164:167], v[216:223], v8
    v_smfmac_f32_16x16x64_bf16 v[176:179], v[168:171], v[224:231], v8
    v_smfmac_f32_16x16x64_bf16 v[180:183], v[148:151], a[88:95], v8
    ds_read_b128 v[216:219], v12 offset:12288
    ds_read_b128 v[220:223], v12 offset:13312
    ds_read_b128 v[224:227], v12 offset:14336
    ds_read_b128 v[228:231], v12 offset:15360
    ds_read_b32 v104, v16 offset:1024
    ds_read_b32 v105, v16 offset:1152
    ds_read_b32 v106, v16 offset:1028
    ds_read_b32 v107, v16 offset:1156
    v_smfmac_f32_16x16x64_bf16 v[180:183], v[152:155], a[96:103], v8
    v_smfmac_f32_16x16x64_bf16 v[180:183], v[156:159], a[104:111], v8
    s_nop 1
    v_cvt_pk_bf16_f32 v62, v176, v177
    v_cvt_pk_bf16_f32 v63, v178, v179
    ds_write_b64 v13, v[62:63] offset:128
    ds_read_b64_tr_b16 v[80:81], v15 offset:0
    ds_read_b64_tr_b16 v[82:83], v15 offset:128
    s_waitcnt lgkmcnt(15)
    v_smfmac_f32_16x16x64_bf16 v[180:183], v[164:167], v[200:207], v8
    v_smfmac_f32_16x16x64_bf16 v[180:183], v[168:171], v[208:215], v8
    v_smfmac_f32_16x16x64_bf16 v[184:187], v[148:151], a[128:135], v8
    ds_read_b128 v[200:203], v12 offset:16384
    ds_read_b128 v[204:207], v12 offset:17408
    ds_read_b128 v[208:211], v12 offset:18432
    ds_read_b128 v[212:215], v12 offset:19456
    ds_read_b32 v108, v17 offset:0
    ds_read_b32 v109, v17 offset:128
    ds_read_b32 v110, v17 offset:4
    ds_read_b32 v111, v17 offset:132
    v_smfmac_f32_16x16x64_bf16 v[184:187], v[152:155], a[136:143], v8
    v_smfmac_f32_16x16x64_bf16 v[184:187], v[156:159], a[144:151], v8
    s_nop 1
    v_cvt_pk_bf16_f32 v60, v180, v181
    v_cvt_pk_bf16_f32 v61, v182, v183
    ds_write_b64 v13, v[60:61] offset:1568
    s_waitcnt lgkmcnt(15)
    v_smfmac_f32_16x16x64_bf16 v[184:187], v[164:167], v[216:223], v8
    v_smfmac_f32_16x16x64_bf16 v[184:187], v[168:171], v[224:231], v8
    s_waitcnt lgkmcnt(9)
    v_mfma_f32_16x16x32_bf16 v[68:71], v[112:115], v[80:83], v[68:71]
    v_mfma_f32_16x16x32_bf16 v[72:75], v[128:131], v[80:83], v[72:75]
    v_mfma_f32_16x16x32_bf16 v[76:79], v[96:99], v[80:83], v[76:79]
    s_add_u32 s29, s46, 0
    buffer_load_dwordx4 v[112:115], v5, s[4:7], s29 offen offset:0
    s_add_u32 s29, s46, 14336
    buffer_load_dwordx4 v[128:131], v5, s[4:7], s29 offen offset:0
    v_smfmac_f32_16x16x64_bf16 v[188:191], v[148:151], a[168:175], v8
    ds_read_b128 v[216:219], v12 offset:20480
    ds_read_b128 v[220:223], v12 offset:21504
    ds_read_b128 v[224:227], v12 offset:22528
    ds_read_b128 v[228:231], v12 offset:23552
    v_smfmac_f32_16x16x64_bf16 v[188:191], v[152:155], a[176:183], v8
    v_smfmac_f32_16x16x64_bf16 v[188:191], v[156:159], a[184:191], v8
    s_nop 1
    v_cvt_pk_bf16_f32 v62, v184, v185
    v_cvt_pk_bf16_f32 v63, v186, v187
    ds_write_b64 v13, v[62:63] offset:1696
    ds_read_b64_tr_b16 v[84:85], v15 offset:1568
    ds_read_b64_tr_b16 v[86:87], v15 offset:1696
    s_waitcnt lgkmcnt(12)
    v_smfmac_f32_16x16x64_bf16 v[188:191], v[164:167], v[200:207], v8
    v_smfmac_f32_16x16x64_bf16 v[188:191], v[168:171], v[208:215], v8
    v_smfmac_f32_16x16x64_bf16 v[192:195], v[148:151], a[208:215], v8
    ds_read_b128 v[200:203], v12 offset:24576
    ds_read_b128 v[204:207], v12 offset:25600
    ds_read_b128 v[208:211], v12 offset:26624
    ds_read_b128 v[212:215], v12 offset:27648
    v_smfmac_f32_16x16x64_bf16 v[192:195], v[152:155], a[216:223], v8
    v_smfmac_f32_16x16x64_bf16 v[192:195], v[156:159], a[224:231], v8
    s_nop 1
    v_cvt_pk_bf16_f32 v60, v188, v189
    v_cvt_pk_bf16_f32 v61, v190, v191
    ds_write_b64 v13, v[60:61] offset:3136
    s_waitcnt lgkmcnt(8)
    v_smfmac_f32_16x16x64_bf16 v[192:195], v[164:167], v[216:223], v8
    v_smfmac_f32_16x16x64_bf16 v[192:195], v[168:171], v[224:231], v8
    s_waitcnt lgkmcnt(5)
    v_mfma_f32_16x16x32_bf16 v[68:71], v[116:119], v[84:87], v[68:71]
    v_mfma_f32_16x16x32_bf16 v[72:75], v[132:135], v[84:87], v[72:75]
    v_mfma_f32_16x16x32_bf16 v[76:79], v[100:103], v[84:87], v[76:79]
    s_add_u32 s29, s46, 0
    buffer_load_dwordx4 v[116:119], v5, s[4:7], s29 offen offset:1024
    s_add_u32 s29, s46, 14336
    buffer_load_dwordx4 v[132:135], v5, s[4:7], s29 offen offset:1024
    v_smfmac_f32_16x16x64_bf16 v[196:199], v[148:151], a[248:255], v8
    v_smfmac_f32_16x16x64_bf16 v[196:199], v[152:155], v[232:239], v8
    v_smfmac_f32_16x16x64_bf16 v[196:199], v[156:159], v[240:247], v8
    s_nop 1
    v_cvt_pk_bf16_f32 v62, v192, v193
    v_cvt_pk_bf16_f32 v63, v194, v195
    ds_write_b64 v13, v[62:63] offset:3264
    ds_read_b64_tr_b16 v[88:89], v15 offset:3136
    ds_read_b64_tr_b16 v[90:91], v15 offset:3264
    s_waitcnt lgkmcnt(4)
    v_smfmac_f32_16x16x64_bf16 v[196:199], v[164:167], v[200:207], v8
    v_smfmac_f32_16x16x64_bf16 v[196:199], v[168:171], v[208:215], v8
    s_waitcnt lgkmcnt(0)
    v_mfma_f32_16x16x32_bf16 v[68:71], v[120:123], v[88:91], v[68:71]
    v_mfma_f32_16x16x32_bf16 v[72:75], v[136:139], v[88:91], v[72:75]
    v_mfma_f32_16x16x32_bf16 v[76:79], v[104:107], v[88:91], v[76:79]
    s_add_u32 s29, s46, 0
    buffer_load_dwordx4 v[120:123], v5, s[4:7], s29 offen offset:2048
    s_add_u32 s29, s46, 14336
    buffer_load_dwordx4 v[136:139], v5, s[4:7], s29 offen offset:2048
    s_nop 3
    v_cvt_pk_bf16_f32 v60, v196, v197
    v_cvt_pk_bf16_f32 v61, v198, v199
    ds_write_b64 v14, v[60:61]
    ds_read_b64_tr_b16 v[92:93], v15 offset:4704
    ds_read_b64_tr_b16 v[94:95], v15 offset:4832
    s_waitcnt lgkmcnt(0)
    v_mfma_f32_16x16x32_bf16 v[68:71], v[124:127], v[92:95], v[68:71]
    v_mfma_f32_16x16x32_bf16 v[72:75], v[140:143], v[92:95], v[72:75]
    v_mfma_f32_16x16x32_bf16 v[76:79], v[108:111], v[92:95], v[76:79]
    s_nop 7
    ds_write_b128 v18, v[68:71] offset:0
    ds_write_b128 v18, v[72:75] offset:1152
    ds_write_b128 v18, v[76:79] offset:2304
    s_add_u32 s30, s47, 0
    buffer_load_dwordx4 v[124:127], v5, s[4:7], s30 offen
    s_add_u32 s30, s47, 14336
    buffer_load_dwordx4 v[140:143], v5, s[4:7], s30 offen
    s_add_u32 s46, s46, 28672
    s_add_u32 s47, s47, 28672
    s_waitcnt lgkmcnt(0)
    s_barrier
    ds_read_b128 v[32:35], v19 offset:0
    ds_read_b128 v[36:39], v19 offset:3456
    ds_read_b128 v[40:43], v19 offset:6912
    ds_read_b128 v[44:47], v19 offset:10368
    s_waitcnt lgkmcnt(2)
    v_pk_add_f32 v[32:33], v[32:33], v[36:37]
    v_pk_add_f32 v[34:35], v[34:35], v[38:39]
    s_waitcnt lgkmcnt(0)
    v_pk_add_f32 v[40:41], v[40:41], v[44:45]
    v_pk_add_f32 v[42:43], v[42:43], v[46:47]
    v_pk_add_f32 v[32:33], v[32:33], v[40:41]
    v_pk_add_f32 v[34:35], v[34:35], v[42:43]
    s_nop 1
    v_add_f32_dpp v36, v32, v32 quad_perm:[1,0,3,2] row_mask:0xf bank_mask:0xf
    v_add_f32_dpp v37, v33, v33 quad_perm:[1,0,3,2] row_mask:0xf bank_mask:0xf
    v_add_f32_dpp v38, v34, v34 quad_perm:[1,0,3,2] row_mask:0xf bank_mask:0xf
    v_add_f32_dpp v39, v35, v35 quad_perm:[1,0,3,2] row_mask:0xf bank_mask:0xf
    v_max3_f32 v40, v36, v37, v38
    v_max_f32 v40, v40, v39
    s_nop 1
    v_max_f32_dpp v40, v40, v40 row_ror:8 row_mask:0xf bank_mask:0xf
    s_nop 1
    v_max_f32_dpp v40, v40, v40 row_ror:4 row_mask:0xf bank_mask:0xf
    s_nop 1
    v_max_f32_dpp v40, v40, v40 row_ror:2 row_mask:0xf bank_mask:0xf
    v_mov_b32 v41, v40
    s_nop 1
    v_permlane16_swap_b32 v41, v40
    s_nop 1
    v_max_f32 v40, v41, v40
    v_mul_f32 v40, 0xbfb8aa3b, v40
    v_fma_f32 v36, v36, s53, v40
    v_fma_f32 v37, v37, s53, v40
    v_fma_f32 v38, v38, s53, v40
    v_fma_f32 v39, v39, s53, v40
    v_exp_f32 v36, v36
    v_exp_f32 v37, v37
    v_exp_f32 v38, v38
    v_exp_f32 v39, v39
    s_nop 0
    v_add_f32 v40, v36, v37
    v_add_f32 v42, v38, v39
    v_add_f32 v40, v40, v42
    v_mul_f32 v40, v40, v21
    s_nop 1
    v_add_f32_dpp v40, v40, v40 row_ror:8 row_mask:0xf bank_mask:0xf
    s_nop 1
    v_add_f32_dpp v40, v40, v40 row_ror:4 row_mask:0xf bank_mask:0xf
    s_nop 1
    v_add_f32_dpp v40, v40, v40 row_ror:2 row_mask:0xf bank_mask:0xf
    v_mov_b32 v41, v40
    s_nop 1
    v_permlane16_swap_b32 v41, v40
    s_nop 1
    v_add_f32 v40, v41, v40
    v_rcp_f32 v40, v40
    s_nop 0
    v_mul_f32 v36, v36, v40
    v_mul_f32 v37, v37, v40
    v_mul_f32 v38, v38, v40
    v_mul_f32 v39, v39, v40
    v_cvt_pk_bf16_f32 v36, v36, v37
    v_cvt_pk_bf16_f32 v37, v38, v39
    v_cndmask_b32 v36, v36, v37, s[42:43]
    v_min_u32 v36, -2, v36
    s_cmp_eq_u32 s22, 0
    s_cbranch_scc0 SF_3
    buffer_store_dword v36, v20, s[4:7], s49 offen
    s_branch SF_3_e
SF_3:
    buffer_store_dword v36, v20, s[4:7], s49 offen sc1
SF_3_e:
    s_add_u32 s48, s48, 7168
    s_add_u32 s49, s49, 12288
    s_add_u32 s50, s50, 1
    s_cmp_lt_u32 s50, 63
    s_cbranch_scc1 A_LOOP0
    s_branch A_END
A_LOOP1:
    v_mov_b32 v172, 0
    v_mov_b32 v173, 0
    v_mov_b32 v174, 0
    v_mov_b32 v175, 0
    v_mov_b32 v176, 0
    v_mov_b32 v177, 0
    v_mov_b32 v178, 0
    v_mov_b32 v179, 0
    v_mov_b32 v180, 0
    v_mov_b32 v181, 0
    v_mov_b32 v182, 0
    v_mov_b32 v183, 0
    v_mov_b32 v184, 0
    v_mov_b32 v185, 0
    v_mov_b32 v186, 0
    v_mov_b32 v187, 0
    v_mov_b32 v188, 0
    v_mov_b32 v189, 0
    v_mov_b32 v190, 0
    v_mov_b32 v191, 0
    v_mov_b32 v192, 0
    v_mov_b32 v193, 0
    v_mov_b32 v194, 0
    v_mov_b32 v195, 0
    v_mov_b32 v196, 0
    v_mov_b32 v197, 0
    v_mov_b32 v198, 0
    v_mov_b32 v199, 0
    v_mov_b32 v68, 0
    v_mov_b32 v69, 0
    v_mov_b32 v70, 0
    v_mov_b32 v71, 0
    v_mov_b32 v72, 0
    v_mov_b32 v73, 0
    v_mov_b32 v74, 0
    v_mov_b32 v75, 0
    v_mov_b32 v76, 0
    v_mov_b32 v77, 0
    v_mov_b32 v78, 0
    v_mov_b32 v79, 0
    ds_read_b128 v[200:203], v12 offset:0
    ds_read_b128 v[204:207], v12 offset:1024
    ds_read_b128 v[208:211], v12 offset:2048
    ds_read_b128 v[212:215], v12 offset:3072
A_POLL1:
    buffer_load_dwordx4 v[52:55], v6, s[4:7], s48 offen sc1
    buffer_load_dwordx4 v[56:59], v7, s[4:7], s48 offen sc1
    s_waitcnt vmcnt(0)
    v_max3_u32 v10, v52, v53, v54
    v_max3_u32 v11, v55, v56, v57
    v_max3_u32 v10, v10, v58, v59
    v_max_u32 v10, v10, v11
    v_cmp_eq_u32 vcc, -1, v10
    s_cbranch_vccz A_POLL1_ok
    s_sub_u32 s23, s23, 1
    s_cmp_gt_i32 s23, 0
    s_cbranch_scc1 A_POLL1
A_POLL1_ok:
    ds_write_b128 v9, v[52:55]
    ds_write_b128 v9, v[56:59] offset:4096
    v_smfmac_f32_16x16x64_bf16 v[172:175], v[52:55], a[8:15], v8
    v_smfmac_f32_16x16x64_bf16 v[176:179], v[52:55], a[48:55], v8
    v_smfmac_f32_16x16x64_bf16 v[180:183], v[52:55], a[88:95], v8
    v_smfmac_f32_16x16x64_bf16 v[184:187], v[52:55], a[128:135], v8
    v_smfmac_f32_16x16x64_bf16 v[188:191], v[52:55], a[168:175], v8
    s_waitcnt lgkmcnt(0)
    s_barrier
    ds_read_b128 v[144:147], v5 offset:0
    ds_read_b128 v[152:155], v5 offset:2048
    ds_read_b128 v[156:159], v5 offset:3072
    ds_read_b128 v[160:163], v5 offset:4096
    ds_read_b128 v[168:171], v5 offset:6144
    buffer_load_dword v23, v22, s[4:7], s44 offen sc1
    s_add_u32 s44, s44, s45
    v_smfmac_f32_16x16x64_bf16 v[192:195], v[52:55], a[208:215], v8
    v_smfmac_f32_16x16x64_bf16 v[196:199], v[52:55], a[248:255], v8
    v_smfmac_f32_16x16x64_bf16 v[172:175], v[56:59], a[32:39], v8
    v_smfmac_f32_16x16x64_bf16 v[176:179], v[56:59], a[72:79], v8
    v_smfmac_f32_16x16x64_bf16 v[180:183], v[56:59], a[112:119], v8
    v_smfmac_f32_16x16x64_bf16 v[184:187], v[56:59], a[152:159], v8
    v_smfmac_f32_16x16x64_bf16 v[188:191], v[56:59], a[192:199], v8
    v_smfmac_f32_16x16x64_bf16 v[192:195], v[56:59], a[232:239], v8
    v_smfmac_f32_16x16x64_bf16 v[196:199], v[56:59], v[248:255], v8
    s_waitcnt lgkmcnt(4)
    v_smfmac_f32_16x16x64_bf16 v[172:175], v[144:147], a[0:7], v8
    s_waitcnt lgkmcnt(3)
    v_smfmac_f32_16x16x64_bf16 v[172:175], v[152:155], a[16:23], v8
    s_waitcnt lgkmcnt(2)
    v_smfmac_f32_16x16x64_bf16 v[172:175], v[156:159], a[24:31], v8
    ds_read_b128 v[216:219], v12 offset:4096
    ds_read_b128 v[220:223], v12 offset:5120
    ds_read_b128 v[224:227], v12 offset:6144
    ds_read_b128 v[228:231], v12 offset:7168
    ds_read_b32 v96, v16 offset:0
    ds_read_b32 v97, v16 offset:128
    ds_read_b32 v98, v16 offset:4
    ds_read_b32 v99, v16 offset:132
    s_waitcnt lgkmcnt(9)
    s_waitcnt lgkmcnt(8)
    v_smfmac_f32_16x16x64_bf16 v[172:175], v[160:163], v[200:207], v8
    v_smfmac_f32_16x16x64_bf16 v[172:175], v[168:171], v[208:215], v8
    v_smfmac_f32_16x16x64_bf16 v[176:179], v[144:147], a[40:47], v8
    ds_read_b128 v[200:203], v12 offset:8192
    ds_read_b128 v[204:207], v12 offset:9216
    ds_read_b128 v[208:211], v12 offset:10240
    ds_read_b128 v[212:215], v12 offset:11264
    ds_read_b32 v100, v16 offset:512
    ds_read_b32 v101, v16 offset:640
    ds_read_b32 v102, v16 offset:516
    ds_read_b32 v103, v16 offset:644
    v_smfmac_f32_16x16x64_bf16 v[176:179], v[152:155], a[56:63], v8
    v_smfmac_f32_16x16x64_bf16 v[176:179], v[156:159], a[64:71], v8
    s_nop 1
    v_cvt_pk_bf16_f32 v60, v172, v173
    v_cvt_pk_bf16_f32 v61, v174, v175
    ds_write_b64 v13, v[60:61] offset:0
    s_waitcnt lgkmcnt(13)
    v_smfmac_f32_16x16x64_bf16 v[176:179], v[160:163], v[216:223], v8
    v_smfmac_f32_16x16x64_bf16 v[176:179], v[168:171], v[224:231], v8
    v_smfmac_f32_16x16x64_bf16 v[180:183], v[144:147], a[80:87], v8
    ds_read_b128 v[216:219], v12 offset:12288
    ds_read_b128 v[220:223], v12 offset:13312
    ds_read_b128 v[224:227], v12 offset:14336
    ds_read_b128 v[228:231], v12 offset:15360
    ds_read_b32 v104, v16 offset:1024
    ds_read_b32 v105, v16 offset:1152
    ds_read_b32 v106, v16 offset:1028
    ds_read_b32 v107, v16 offset:1156
    v_smfmac_f32_16x16x64_bf16 v[180:183], v[152:155], a[96:103], v8
    v_smfmac_f32_16x16x64_bf16 v[180:183], v[156:159], a[104:111], v8
    s_nop 1
    v_cvt_pk_bf16_f32 v62, v176, v177
    v_cvt_pk_bf16_f32 v63, v178, v179
    ds_write_b64 v13, v[62:63] offset:128
    ds_read_b64_tr_b16 v[80:81], v15 offset:0
    ds_read_b64_tr_b16 v[82:83], v15 offset:128
    s_waitcnt lgkmcnt(15)
    v_smfmac_f32_16x16x64_bf16 v[180:183], v[160:163], v[200:207], v8
    v_smfmac_f32_16x16x64_bf16 v[180:183], v[168:171], v[208:215], v8
    v_smfmac_f32_16x16x64_bf16 v[184:187], v[144:147], a[120:127], v8
    ds_read_b128 v[200:203], v12 offset:16384
    ds_read_b128 v[204:207], v12 offset:17408
    ds_read_b128 v[208:211], v12 offset:18432
    ds_read_b128 v[212:215], v12 offset:19456
    ds_read_b32 v108, v17 offset:0
    ds_read_b32 v109, v17 offset:128
    ds_read_b32 v110, v17 offset:4
    ds_read_b32 v111, v17 offset:132
    v_smfmac_f32_16x16x64_bf16 v[184:187], v[152:155], a[136:143], v8
    v_smfmac_f32_16x16x64_bf16 v[184:187], v[156:159], a[144:151], v8
    s_nop 1
    v_cvt_pk_bf16_f32 v60, v180, v181
    v_cvt_pk_bf16_f32 v61, v182, v183
    ds_write_b64 v13, v[60:61] offset:1568
    s_waitcnt lgkmcnt(15)
    v_smfmac_f32_16x16x64_bf16 v[184:187], v[160:163], v[216:223], v8
    v_smfmac_f32_16x16x64_bf16 v[184:187], v[168:171], v[224:231], v8
    s_waitcnt lgkmcnt(9)
    v_mfma_f32_16x16x32_bf16 v[68:71], v[112:115], v[80:83], v[68:71]
    v_mfma_f32_16x16x32_bf16 v[72:75], v[128:131], v[80:83], v[72:75]
    v_mfma_f32_16x16x32_bf16 v[76:79], v[96:99], v[80:83], v[76:79]
    s_add_u32 s29, s46, 0
    buffer_load_dwordx4 v[112:115], v5, s[4:7], s29 offen offset:0
    s_add_u32 s29, s46, 14336
    buffer_load_dwordx4 v[128:131], v5, s[4:7], s29 offen offset:0
    v_smfmac_f32_16x16x64_bf16 v[188:191], v[144:147], a[160:167], v8
    ds_read_b128 v[216:219], v12 offset:20480
    ds_read_b128 v[220:223], v12 offset:21504
    ds_read_b128 v[224:227], v12 offset:22528
    ds_read_b128 v[228:231], v12 offset:23552
    v_smfmac_f32_16x16x64_bf16 v[188:191], v[152:155], a[176:183], v8
    v_smfmac_f32_16x16x64_bf16 v[188:191], v[156:159], a[184:191], v8
    s_nop 1
    v_cvt_pk_bf16_f32 v62, v184, v185
    v_cvt_pk_bf16_f32 v63, v186, v187
    ds_write_b64 v13, v[62:63] offset:1696
    ds_read_b64_tr_b16 v[84:85], v15 offset:1568
    ds_read_b64_tr_b16 v[86:87], v15 offset:1696
    s_waitcnt lgkmcnt(12)
    v_smfmac_f32_16x16x64_bf16 v[188:191], v[160:163], v[200:207], v8
    v_smfmac_f32_16x16x64_bf16 v[188:191], v[168:171], v[208:215], v8
    v_smfmac_f32_16x16x64_bf16 v[192:195], v[144:147], a[200:207], v8
    ds_read_b128 v[200:203], v12 offset:24576
    ds_read_b128 v[204:207], v12 offset:25600
    ds_read_b128 v[208:211], v12 offset:26624
    ds_read_b128 v[212:215], v12 offset:27648
    v_smfmac_f32_16x16x64_bf16 v[192:195], v[152:155], a[216:223], v8
    v_smfmac_f32_16x16x64_bf16 v[192:195], v[156:159], a[224:231], v8
    s_nop 1
    v_cvt_pk_bf16_f32 v60, v188, v189
    v_cvt_pk_bf16_f32 v61, v190, v191
    ds_write_b64 v13, v[60:61] offset:3136
    s_waitcnt lgkmcnt(8)
    v_smfmac_f32_16x16x64_bf16 v[192:195], v[160:163], v[216:223], v8
    v_smfmac_f32_16x16x64_bf16 v[192:195], v[168:171], v[224:231], v8
    s_waitcnt lgkmcnt(5)
    v_mfma_f32_16x16x32_bf16 v[68:71], v[116:119], v[84:87], v[68:71]
    v_mfma_f32_16x16x32_bf16 v[72:75], v[132:135], v[84:87], v[72:75]
    v_mfma_f32_16x16x32_bf16 v[76:79], v[100:103], v[84:87], v[76:79]
    s_add_u32 s29, s46, 0
    buffer_load_dwordx4 v[116:119], v5, s[4:7], s29 offen offset:1024
    s_add_u32 s29, s46, 14336
    buffer_load_dwordx4 v[132:135], v5, s[4:7], s29 offen offset:1024
    v_smfmac_f32_16x16x64_bf16 v[196:199], v[144:147], a[240:247], v8
    v_smfmac_f32_16x16x64_bf16 v[196:199], v[152:155], v[232:239], v8
    v_smfmac_f32_16x16x64_bf16 v[196:199], v[156:159], v[240:247], v8
    s_nop 1
    v_cvt_pk_bf16_f32 v62, v192, v193
    v_cvt_pk_bf16_f32 v63, v194, v195
    ds_write_b64 v13, v[62:63] offset:3264
    ds_read_b64_tr_b16 v[88:89], v15 offset:3136
    ds_read_b64_tr_b16 v[90:91], v15 offset:3264
    s_waitcnt lgkmcnt(4)
    v_smfmac_f32_16x16x64_bf16 v[196:199], v[160:163], v[200:207], v8
    v_smfmac_f32_16x16x64_bf16 v[196:199], v[168:171], v[208:215], v8
    s_waitcnt lgkmcnt(0)
    v_mfma_f32_16x16x32_bf16 v[68:71], v[120:123], v[88:91], v[68:71]
    v_mfma_f32_16x16x32_bf16 v[72:75], v[136:139], v[88:91], v[72:75]
    v_mfma_f32_16x16x32_bf16 v[76:79], v[104:107], v[88:91], v[76:79]
    s_add_u32 s29, s46, 0
    buffer_load_dwordx4 v[120:123], v5, s[4:7], s29 offen offset:2048
    s_add_u32 s29, s46, 14336
    buffer_load_dwordx4 v[136:139], v5, s[4:7], s29 offen offset:2048
    s_nop 3
    v_cvt_pk_bf16_f32 v60, v196, v197
    v_cvt_pk_bf16_f32 v61, v198, v199
    ds_write_b64 v14, v[60:61]
    ds_read_b64_tr_b16 v[92:93], v15 offset:4704
    ds_read_b64_tr_b16 v[94:95], v15 offset:4832
    s_waitcnt lgkmcnt(0)
    v_mfma_f32_16x16x32_bf16 v[68:71], v[124:127], v[92:95], v[68:71]
    v_mfma_f32_16x16x32_bf16 v[72:75], v[140:143], v[92:95], v[72:75]
    v_mfma_f32_16x16x32_bf16 v[76:79], v[108:111], v[92:95], v[76:79]
    s_nop 7
    ds_write_b128 v18, v[68:71] offset:0
    ds_write_b128 v18, v[72:75] offset:1152
    ds_write_b128 v18, v[76:79] offset:2304
    s_add_u32 s30, s47, 0
    buffer_load_dwordx4 v[124:127], v5, s[4:7], s30 offen
    s_add_u32 s30, s47, 14336
    buffer_load_dwordx4 v[140:143], v5, s[4:7], s30 offen
    s_add_u32 s46, s46, 28672
    s_add_u32 s47, s47, 28672
    s_waitcnt lgkmcnt(0)
    s_barrier
    ds_read_b128 v[32:35], v19 offset:0
    ds_read_b128 v[36:39], v19 offset:3456
    ds_read_b128 v[40:43], v19 offset:6912
    ds_read_b128 v[44:47], v19 offset:10368
    s_waitcnt lgkmcnt(2)
    v_pk_add_f32 v[32:33], v[32:33], v[36:37]
    v_pk_add_f32 v[34:35], v[34:35], v[38:39]
    s_waitcnt lgkmcnt(0)
    v_pk_add_f32 v[40:41], v[40:41], v[44:45]
    v_pk_add_f32 v[42:43], v[42:43], v[46:47]
    v_pk_add_f32 v[32:33], v[32:33], v[40:41]
    v_pk_add_f32 v[34:35], v[34:35], v[42:43]
    s_nop 1
    v_add_f32_dpp v36, v32, v32 quad_perm:[1,0,3,2] row_mask:0xf bank_mask:0xf
    v_add_f32_dpp v37, v33, v33 quad_perm:[1,0,3,2] row_mask:0xf bank_mask:0xf
    v_add_f32_dpp v38, v34, v34 quad_perm:[1,0,3,2] row_mask:0xf bank_mask:0xf
    v_add_f32_dpp v39, v35, v35 quad_perm:[1,0,3,2] row_mask:0xf bank_mask:0xf
    v_max3_f32 v40, v36, v37, v38
    v_max_f32 v40, v40, v39
    s_nop 1
    v_max_f32_dpp v40, v40, v40 row_ror:8 row_mask:0xf bank_mask:0xf
    s_nop 1
    v_max_f32_dpp v40, v40, v40 row_ror:4 row_mask:0xf bank_mask:0xf
    s_nop 1
    v_max_f32_dpp v40, v40, v40 row_ror:2 row_mask:0xf bank_mask:0xf
    v_mov_b32 v41, v40
    s_nop 1
    v_permlane16_swap_b32 v41, v40
    s_nop 1
    v_max_f32 v40, v41, v40
    v_mul_f32 v40, 0xbfb8aa3b, v40
    v_fma_f32 v36, v36, s53, v40
    v_fma_f32 v37, v37, s53, v40
    v_fma_f32 v38, v38, s53, v40
    v_fma_f32 v39, v39, s53, v40
    v_exp_f32 v36, v36
    v_exp_f32 v37, v37
    v_exp_f32 v38, v38
    v_exp_f32 v39, v39
    s_nop 0
    v_add_f32 v40, v36, v37
    v_add_f32 v42, v38, v39
    v_add_f32 v40, v40, v42
    v_mul_f32 v40, v40, v21
    s_nop 1
    v_add_f32_dpp v40, v40, v40 row_ror:8 row_mask:0xf bank_mask:0xf
    s_nop 1
    v_add_f32_dpp v40, v40, v40 row_ror:4 row_mask:0xf bank_mask:0xf
    s_nop 1
    v_add_f32_dpp v40, v40, v40 row_ror:2 row_mask:0xf bank_mask:0xf
    v_mov_b32 v41, v40
    s_nop 1
    v_permlane16_swap_b32 v41, v40
    s_nop 1
    v_add_f32 v40, v41, v40
    v_rcp_f32 v40, v40
    s_nop 0
    v_mul_f32 v36, v36, v40
    v_mul_f32 v37, v37, v40
    v_mul_f32 v38, v38, v40
    v_mul_f32 v39, v39, v40
    v_cvt_pk_bf16_f32 v36, v36, v37
    v_cvt_pk_bf16_f32 v37, v38, v39
    v_cndmask_b32 v36, v36, v37, s[42:43]
    v_min_u32 v36, -2, v36
    s_cmp_eq_u32 s22, 0
    s_cbranch_scc0 SF_4
    buffer_store_dword v36, v20, s[4:7], s49 offen
    s_branch SF_4_e
SF_4:
    buffer_store_dword v36, v20, s[4:7], s49 offen sc1
SF_4_e:
    s_add_u32 s48, s48, 7168
    s_add_u32 s49, s49, 12288
    s_add_u32 s50, s50, 1
    s_cmp_lt_u32 s50, 63
    s_cbranch_scc1 A_LOOP1
    s_branch A_END
A_LOOP2:
    v_mov_b32 v172, 0
    v_mov_b32 v173, 0
    v_mov_b32 v174, 0
    v_mov_b32 v175, 0
    v_mov_b32 v176, 0
    v_mov_b32 v177, 0
    v_mov_b32 v178, 0
    v_mov_b32 v179, 0
    v_mov_b32 v180, 0
    v_mov_b32 v181, 0
    v_mov_b32 v182, 0
    v_mov_b32 v183, 0
    v_mov_b32 v184, 0
    v_mov_b32 v185, 0
    v_mov_b32 v186, 0
    v_mov_b32 v187, 0
    v_mov_b32 v188, 0
    v_mov_b32 v189, 0
    v_mov_b32 v190, 0
    v_mov_b32 v191, 0
    v_mov_b32 v192, 0
    v_mov_b32 v193, 0
    v_mov_b32 v194, 0
    v_mov_b32 v195, 0
    v_mov_b32 v196, 0
    v_mov_b32 v197, 0
    v_mov_b32 v198, 0
    v_mov_b32 v199, 0
    v_mov_b32 v68, 0
    v_mov_b32 v69, 0
    v_mov_b32 v70, 0
    v_mov_b32 v71, 0
    v_mov_b32 v72, 0
    v_mov_b32 v73, 0
    v_mov_b32 v74, 0
    v_mov_b32 v75, 0
    v_mov_b32 v76, 0
    v_mov_b32 v77, 0
    v_mov_b32 v78, 0
    v_mov_b32 v79, 0
    ds_read_b128 v[200:203], v12 offset:0
    ds_read_b128 v[204:207], v12 offset:1024
    ds_read_b128 v[208:211], v12 offset:2048
    ds_read_b128 v[212:215], v12 offset:3072
A_POLL2:
    buffer_load_dwordx4 v[52:55], v6, s[4:7], s48 offen sc1
    buffer_load_dwordx4 v[56:59], v7, s[4:7], s48 offen sc1
    s_waitcnt vmcnt(0)
    v_max3_u32 v10, v52, v53, v54
    v_max3_u32 v11, v55, v56, v57
    v_max3_u32 v10, v10, v58, v59
    v_max_u32 v10, v10, v11
    v_cmp_eq_u32 vcc, -1, v10
    s_cbranch_vccz A_POLL2_ok
    s_sub_u32 s23, s23, 1
    s_cmp_gt_i32 s23, 0
    s_cbranch_scc1 A_POLL2
A_POLL2_ok:
    ds_write_b128 v9, v[52:55]
    ds_write_b128 v9, v[56:59] offset:4096
    v_smfmac_f32_16x16x64_bf16 v[172:175], v[52:55], a[16:23], v8
    v_smfmac_f32_16x16x64_bf16 v[176:179], v[52:55], a[56:63], v8
    v_smfmac_f32_16x16x64_bf16 v[180:183], v[52:55], a[96:103], v8
    v_smfmac_f32_16x16x64_bf16 v[184:187], v[52:55], a[136:143], v8
    v_smfmac_f32_16x16x64_bf16 v[188:191], v[52:55], a[176:183], v8
    s_waitcnt lgkmcnt(0)
    s_barrier
    ds_read_b128 v[144:147], v5 offset:0
    ds_read_b128 v[148:151], v5 offset:1024
    ds_read_b128 v[156:159], v5 offset:3072
    ds_read_b128 v[160:163], v5 offset:4096
    ds_read_b128 v[164:167], v5 offset:5120
    buffer_load_dword v23, v22, s[4:7], s44 offen sc1
    s_add_u32 s44, s44, s45
    v_smfmac_f32_16x16x64_bf16 v[192:195], v[52:55], a[216:223], v8
    v_smfmac_f32_16x16x64_bf16 v[196:199], v[52:55], v[232:239], v8
    v_smfmac_f32_16x16x64_bf16 v[172:175], v[56:59], a[32:39], v8
    v_smfmac_f32_16x16x64_bf16 v[176:179], v[56:59], a[72:79], v8
    v_smfmac_f32_16x16x64_bf16 v[180:183], v[56:59], a[112:119], v8
    v_smfmac_f32_16x16x64_bf16 v[184:187], v[56:59], a[152:159], v8
    v_smfmac_f32_16x16x64_bf16 v[188:191], v[56:59], a[192:199], v8
    v_smfmac_f32_16x16x64_bf16 v[192:195], v[56:59], a[232:239], v8
    v_smfmac_f32_16x16x64_bf16 v[196:199], v[56:59], v[248:255], v8
    s_waitcnt lgkmcnt(4)
    v_smfmac_f32_16x16x64_bf16 v[172:175], v[144:147], a[0:7], v8
    s_waitcnt lgkmcnt(3)
    v_smfmac_f32_16x16x64_bf16 v[172:175], v[148:151], a[8:15], v8
    s_waitcnt lgkmcnt(2)
    v_smfmac_f32_16x16x64_bf16 v[172:175], v[156:159], a[24:31], v8
    ds_read_b128 v[216:219], v12 offset:4096
    ds_read_b128 v[220:223], v12 offset:5120
    ds_read_b128 v[224:227], v12 offset:6144
    ds_read_b128 v[228:231], v12 offset:7168
    ds_read_b32 v96, v16 offset:0
    ds_read_b32 v97, v16 offset:128
    ds_read_b32 v98, v16 offset:4
    ds_read_b32 v99, v16 offset:132
    s_waitcnt lgkmcnt(9)
    s_waitcnt lgkmcnt(8)
    v_smfmac_f32_16x16x64_bf16 v[172:175], v[160:163], v[200:207], v8
    v_smfmac_f32_16x16x64_bf16 v[172:175], v[164:167], v[208:215], v8
    v_smfmac_f32_16x16x64_bf16 v[176:179], v[144:147], a[40:47], v8
    v_smfmac_f32_16x16x64_bf16 v[176:179], v[148:151], a[48:55], v8
    ds_read_b128 v[200:203], v12 offset:8192
    ds_read_b128 v[204:207], v12 offset:9216
    ds_read_b128 v[208:211], v12 offset:10240
    ds_read_b128 v[212:215], v12 offset:11264
    ds_read_b32 v100, v16 offset:512
    ds_read_b32 v101, v16 offset:640
    ds_read_b32 v102, v16 offset:516
    ds_read_b32 v103, v16 offset:644
    v_smfmac_f32_16x16x64_bf16 v[176:179], v[156:159], a[64:71], v8
    s_nop 1
    v_cvt_pk_bf16_f32 v60, v172, v173
    v_cvt_pk_bf16_f32 v61, v174, v175
    ds_write_b64 v13, v[60:61] offset:0
    s_waitcnt lgkmcnt(13)
    v_smfmac_f32_16x16x64_bf16 v[176:179], v[160:163], v[216:223], v8
    v_smfmac_f32_16x16x64_bf16 v[176:179], v[164:167], v[224:231], v8
    v_smfmac_f32_16x16x64_bf16 v[180:183], v[144:147], a[80:87], v8
    v_smfmac_f32_16x16x64_bf16 v[180:183], v[148:151], a[88:95], v8
    ds_read_b128 v[216:219], v12 offset:12288
    ds_read_b128 v[220:223], v12 offset:13312
    ds_read_b128 v[224:227], v12 offset:14336
    ds_read_b128 v[228:231], v12 offset:15360
    ds_read_b32 v104, v16 offset:1024
    ds_read_b32 v105, v16 offset:1152
    ds_read_b32 v106, v16 offset:1028
    ds_read_b32 v107, v16 offset:1156
    v_smfmac_f32_16x16x64_bf16 v[180:183], v[156:159], a[104:111], v8
    s_nop 1
    v_cvt_pk_bf16_f32 v62, v176, v177
    v_cvt_pk_bf16_f32 v63, v178, v179
    ds_write_b64 v13, v[62:63] offset:128
    ds_read_b64_tr_b16 v[80:81], v15 offset:0
    ds_read_b64_tr_b16 v[82:83], v15 offset:128
    s_waitcnt lgkmcnt(15)
    v_smfmac_f32_16x16x64_bf16 v[180:183], v[160:163], v[200:207], v8
    v_smfmac_f32_16x16x64_bf16 v[180:183], v[164:167], v[208:215], v8
    v_smfmac_f32_16x16x64_bf16 v[184:187], v[144:147], a[120:127], v8
    v_smfmac_f32_16x16x64_bf16 v[184:187], v[148:151], a[128:135], v8
    ds_read_b128 v[200:203], v12 offset:16384
    ds_read_b128 v[204:207], v12 offset:17408
    ds_read_b128 v[208:211], v12 offset:18432
    ds_read_b128 v[212:215], v12 offset:19456
    ds_read_b32 v108, v17 offset:0
    ds_read_b32 v109, v17 offset:128
    ds_read_b32 v110, v17 offset:4
    ds_read_b32 v111, v17 offset:132
    v_smfmac_f32_16x16x64_bf16 v[184:187], v[156:159], a[144:151], v8
    s_nop 1
    v_cvt_pk_bf16_f32 v60, v180, v181
    v_cvt_pk_bf16_f32 v61, v182, v183
    ds_write_b64 v13, v[60:61] offset:1568
    s_waitcnt lgkmcnt(15)
    v_smfmac_f32_16x16x64_bf16 v[184:187], v[160:163], v[216:223], v8
    v_smfmac_f32_16x16x64_bf16 v[184:187], v[164:167], v[224:231], v8
    s_waitcnt lgkmcnt(9)
    v_mfma_f32_16x16x32_bf16 v[68:71], v[112:115], v[80:83], v[68:71]
    v_mfma_f32_16x16x32_bf16 v[72:75], v[128:131], v[80:83], v[72:75]
    v_mfma_f32_16x16x32_bf16 v[76:79], v[96:99], v[80:83], v[76:79]
    s_add_u32 s29, s46, 0
    buffer_load_dwordx4 v[112:115], v5, s[4:7], s29 offen offset:0
    s_add_u32 s29, s46, 14336
    buffer_load_dwordx4 v[128:131], v5, s[4:7], s29 offen offset:0
    v_smfmac_f32_16x16x64_bf16 v[188:191], v[144:147], a[160:167], v8
    v_smfmac_f32_16x16x64_bf16 v[188:191], v[148:151], a[168:175], v8
    ds_read_b128 v[216:219], v12 offset:20480
    ds_read_b128 v[220:223], v12 offset:21504
    ds_read_b128 v[224:227], v12 offset:22528
    ds_read_b128 v[228:231], v12 offset:23552
    v_smfmac_f32_16x16x64_bf16 v[188:191], v[156:159], a[184:191], v8
    s_nop 1
    v_cvt_pk_bf16_f32 v62, v184, v185
    v_cvt_pk_bf16_f32 v63, v186, v187
    ds_write_b64 v13, v[62:63] offset:1696
    ds_read_b64_tr_b16 v[84:85], v15 offset:1568
    ds_read_b64_tr_b16 v[86:87], v15 offset:1696
    s_waitcnt lgkmcnt(12)
    v_smfmac_f32_16x16x64_bf16 v[188:191], v[160:163], v[200:207], v8
    v_smfmac_f32_16x16x64_bf16 v[188:191], v[164:167], v[208:215], v8
    v_smfmac_f32_16x16x64_bf16 v[192:195], v[144:147], a[200:207], v8
    v_smfmac_f32_16x16x64_bf16 v[192:195], v[148:151], a[208:215], v8
    ds_read_b128 v[200:203], v12 offset:24576
    ds_read_b128 v[204:207], v12 offset:25600
    ds_read_b128 v[208:211], v12 offset:26624
    ds_read_b128 v[212:215], v12 offset:27648
    v_smfmac_f32_16x16x64_bf16 v[192:195], v[156:159], a[224:231], v8
    s_nop 1
    v_cvt_pk_bf16_f32 v60, v188, v189
    v_cvt_pk_bf16_f32 v61, v190, v191
    ds_write_b64 v13, v[60:61] offset:3136
    s_waitcnt lgkmcnt(8)
    v_smfmac_f32_16x16x64_bf16 v[192:195], v[160:163], v[216:223], v8
    v_smfmac_f32_16x16x64_bf16 v[192:195], v[164:167], v[224:231], v8
    s_waitcnt lgkmcnt(5)
    v_mfma_f32_16x16x32_bf16 v[68:71], v[116:119], v[84:87], v[68:71]
    v_mfma_f32_16x16x32_bf16 v[72:75], v[132:135], v[84:87], v[72:75]
    v_mfma_f32_16x16x32_bf16 v[76:79], v[100:103], v[84:87], v[76:79]
    s_add_u32 s29, s46, 0
    buffer_load_dwordx4 v[116:119], v5, s[4:7], s29 offen offset:1024
    s_add_u32 s29, s46, 14336
    buffer_load_dwordx4 v[132:135], v5, s[4:7], s29 offen offset:1024
    v_smfmac_f32_16x16x64_bf16 v[196:199], v[144:147], a[240:247], v8
    v_smfmac_f32_16x16x64_bf16 v[196:199], v[148:151], a[248:255], v8
    v_smfmac_f32_16x16x64_bf16 v[196:199], v[156:159], v[240:247], v8
    s_nop 1
    v_cvt_pk_bf16_f32 v62, v192, v193
    v_cvt_pk_bf16_f32 v63, v194, v195
    ds_write_b64 v13, v[62:63] offset:3264
    ds_read_b64_tr_b16 v[88:89], v15 offset:3136
    ds_read_b64_tr_b16 v[90:91], v15 offset:3264
    s_waitcnt lgkmcnt(4)
    v_smfmac_f32_16x16x64_bf16 v[196:199], v[160:163], v[200:207], v8
    v_smfmac_f32_16x16x64_bf16 v[196:199], v[164:167], v[208:215], v8
    s_waitcnt lgkmcnt(0)
    v_mfma_f32_16x16x32_bf16 v[68:71], v[120:123], v[88:91], v[68:71]
    v_mfma_f32_16x16x32_bf16 v[72:75], v[136:139], v[88:91], v[72:75]
    v_mfma_f32_16x16x32_bf16 v[76:79], v[104:107], v[88:91], v[76:79]
    s_add_u32 s29, s46, 0
    buffer_load_dwordx4 v[120:123], v5, s[4:7], s29 offen offset:2048
    s_add_u32 s29, s46, 14336
    buffer_load_dwordx4 v[136:139], v5, s[4:7], s29 offen offset:2048
    s_nop 3
    v_cvt_pk_bf16_f32 v60, v196, v197
    v_cvt_pk_bf16_f32 v61, v198, v199
    ds_write_b64 v14, v[60:61]
    ds_read_b64_tr_b16 v[92:93], v15 offset:4704
    ds_read_b64_tr_b16 v[94:95], v15 offset:4832
    s_waitcnt lgkmcnt(0)
    v_mfma_f32_16x16x32_bf16 v[68:71], v[124:127], v[92:95], v[68:71]
    v_mfma_f32_16x16x32_bf16 v[72:75], v[140:143], v[92:95], v[72:75]
    v_mfma_f32_16x16x32_bf16 v[76:79], v[108:111], v[92:95], v[76:79]
    s_nop 7
    ds_write_b128 v18, v[68:71] offset:0
    ds_write_b128 v18, v[72:75] offset:1152
    ds_write_b128 v18, v[76:79] offset:2304
    s_add_u32 s30, s47, 0
    buffer_load_dwordx4 v[124:127], v5, s[4:7], s30 offen
    s_add_u32 s30, s47, 14336
    buffer_load_dwordx4 v[140:143], v5, s[4:7], s30 offen
    s_add_u32 s46, s46, 28672
    s_add_u32 s47, s47, 28672
    s_waitcnt lgkmcnt(0)
    s_barrier
    ds_read_b128 v[32:35], v19 offset:0
    ds_read_b128 v[36:39], v19 offset:3456
    ds_read_b128 v[40:43], v19 offset:6912
    ds_read_b128 v[44:47], v19 offset:10368
    s_waitcnt lgkmcnt(2)
    v_pk_add_f32 v[32:33], v[32:33], v[36:37]
    v_pk_add_f32 v[34:35], v[34:35], v[38:39]
    s_waitcnt lgkmcnt(0)
    v_pk_add_f32 v[40:41], v[40:41], v[44:45]
    v_pk_add_f32 v[42:43], v[42:43], v[46:47]
    v_pk_add_f32 v[32:33], v[32:33], v[40:41]
    v_pk_add_f32 v[34:35], v[34:35], v[42:43]
    s_nop 1
    v_add_f32_dpp v36, v32, v32 quad_perm:[1,0,3,2] row_mask:0xf bank_mask:0xf
    v_add_f32_dpp v37, v33, v33 quad_perm:[1,0,3,2] row_mask:0xf bank_mask:0xf
    v_add_f32_dpp v38, v34, v34 quad_perm:[1,0,3,2] row_mask:0xf bank_mask:0xf
    v_add_f32_dpp v39, v35, v35 quad_perm:[1,0,3,2] row_mask:0xf bank_mask:0xf
    v_max3_f32 v40, v36, v37, v38
    v_max_f32 v40, v40, v39
    s_nop 1
    v_max_f32_dpp v40, v40, v40 row_ror:8 row_mask:0xf bank_mask:0xf
    s_nop 1
    v_max_f32_dpp v40, v40, v40 row_ror:4 row_mask:0xf bank_mask:0xf
    s_nop 1
    v_max_f32_dpp v40, v40, v40 row_ror:2 row_mask:0xf bank_mask:0xf
    v_mov_b32 v41, v40
    s_nop 1
    v_permlane16_swap_b32 v41, v40
    s_nop 1
    v_max_f32 v40, v41, v40
    v_mul_f32 v40, 0xbfb8aa3b, v40
    v_fma_f32 v36, v36, s53, v40
    v_fma_f32 v37, v37, s53, v40
    v_fma_f32 v38, v38, s53, v40
    v_fma_f32 v39, v39, s53, v40
    v_exp_f32 v36, v36
    v_exp_f32 v37, v37
    v_exp_f32 v38, v38
    v_exp_f32 v39, v39
    s_nop 0
    v_add_f32 v40, v36, v37
    v_add_f32 v42, v38, v39
    v_add_f32 v40, v40, v42
    v_mul_f32 v40, v40, v21
    s_nop 1
    v_add_f32_dpp v40, v40, v40 row_ror:8 row_mask:0xf bank_mask:0xf
    s_nop 1
    v_add_f32_dpp v40, v40, v40 row_ror:4 row_mask:0xf bank_mask:0xf
    s_nop 1
    v_add_f32_dpp v40, v40, v40 row_ror:2 row_mask:0xf bank_mask:0xf
    v_mov_b32 v41, v40
    s_nop 1
    v_permlane16_swap_b32 v41, v40
    s_nop 1
    v_add_f32 v40, v41, v40
    v_rcp_f32 v40, v40
    s_nop 0
    v_mul_f32 v36, v36, v40
    v_mul_f32 v37, v37, v40
    v_mul_f32 v38, v38, v40
    v_mul_f32 v39, v39, v40
    v_cvt_pk_bf16_f32 v36, v36, v37
    v_cvt_pk_bf16_f32 v37, v38, v39
    v_cndmask_b32 v36, v36, v37, s[42:43]
    v_min_u32 v36, -2, v36
    s_cmp_eq_u32 s22, 0
    s_cbranch_scc0 SF_5
    buffer_store_dword v36, v20, s[4:7], s49 offen
    s_branch SF_5_e
SF_5:
    buffer_store_dword v36, v20, s[4:7], s49 offen sc1
SF_5_e:
    s_add_u32 s48, s48, 7168
    s_add_u32 s49, s49, 12288
    s_add_u32 s50, s50, 1
    s_cmp_lt_u32 s50, 63
    s_cbranch_scc1 A_LOOP2
    s_branch A_END
A_LOOP3:
    v_mov_b32 v172, 0
    v_mov_b32 v173, 0
    v_mov_b32 v174, 0
    v_mov_b32 v175, 0
    v_mov_b32 v176, 0
    v_mov_b32 v177, 0
    v_mov_b32 v178, 0
    v_mov_b32 v179, 0
    v_mov_b32 v180, 0
    v_mov_b32 v181, 0
    v_mov_b32 v182, 0
    v_mov_b32 v183, 0
    v_mov_b32 v184, 0
    v_mov_b32 v185, 0
    v_mov_b32 v186, 0
    v_mov_b32 v187, 0
    v_mov_b32 v188, 0
    v_mov_b32 v189, 0
    v_mov_b32 v190, 0
    v_mov_b32 v191, 0
    v_mov_b32 v192, 0
    v_mov_b32 v193, 0
    v_mov_b32 v194, 0
    v_mov_b32 v195, 0
    v_mov_b32 v196, 0
    v_mov_b32 v197, 0
    v_mov_b32 v198, 0
    v_mov_b32 v199, 0
    v_mov_b32 v68, 0
    v_mov_b32 v69, 0
    v_mov_b32 v70, 0
    v_mov_b32 v71, 0
    v_mov_b32 v72, 0
    v_mov_b32 v73, 0
    v_mov_b32 v74, 0
    v_mov_b32 v75, 0
    v_mov_b32 v76, 0
    v_mov_b32 v77, 0
    v_mov_b32 v78, 0
    v_mov_b32 v79, 0
    ds_read_b128 v[200:203], v12 offset:0
    ds_read_b128 v[204:207], v12 offset:1024
    ds_read_b128 v[208:211], v12 offset:2048
    ds_read_b128 v[212:215], v12 offset:3072
A_POLL3:
    buffer_load_dwordx4 v[52:55], v6, s[4:7], s48 offen sc1
    buffer_load_dwordx4 v[56:59], v7, s[4:7], s48 offen sc1
    s_waitcnt vmcnt(0)
    v_max3_u32 v10, v52, v53, v54
    v_max3_u32 v11, v55, v56, v57
    v_max3_u32 v10, v10, v58, v59
    v_max_u32 v10, v10, v11
    v_cmp_eq_u32 vcc, -1, v10
    s_cbranch_vccz A_POLL3_ok
    s_sub_u32 s23, s23, 1
    s_cmp_gt_i32 s23, 0
    s_cbranch_scc1 A_POLL3
A_POLL3_ok:
    ds_write_b128 v9, v[52:55]
    ds_write_b128 v9, v[56:59] offset:4096
    v_smfmac_f32_16x16x64_bf16 v[172:175], v[52:55], a[24:31], v8
    v_smfmac_f32_16x16x64_bf16 v[176:179], v[52:55], a[64:71], v8
    v_smfmac_f32_16x16x64_bf16 v[180:183], v[52:55], a[104:111], v8
    v_smfmac_f32_16x16x64_bf16 v[184:187], v[52:55], a[144:151], v8
    v_smfmac_f32_16x16x64_bf16 v[188:191], v[52:55], a[184:191], v8
    s_waitcnt lgkmcnt(0)
    s_barrier
    ds_read_b128 v[144:147], v5 offset:0
    ds_read_b128 v[148:151], v5 offset:1024
    ds_read_b128 v[152:155], v5 offset:2048
    ds_read_b128 v[164:167], v5 offset:5120
    ds_read_b128 v[168:171], v5 offset:6144
    buffer_load_dword v23, v22, s[4:7], s44 offen sc1
    s_add_u32 s44, s44, s45
    v_smfmac_f32_16x16x64_bf16 v[192:195], v[52:55], a[224:231], v8
    v_smfmac_f32_16x16x64_bf16 v[196:199], v[52:55], v[240:247], v8
    v_smfmac_f32_16x16x64_bf16 v[172:175], v[56:59], a[32:39], v8
    v_smfmac_f32_16x16x64_bf16 v[176:179], v[56:59], a[72:79], v8
    v_smfmac_f32_16x16x64_bf16 v[180:183], v[56:59], a[112:119], v8
    v_smfmac_f32_16x16x64_bf16 v[184:187], v[56:59], a[152:159], v8
    v_smfmac_f32_16x16x64_bf16 v[188:191], v[56:59], a[192:199], v8
    v_smfmac_f32_16x16x64_bf16 v[192:195], v[56:59], a[232:239], v8
    v_smfmac_f32_16x16x64_bf16 v[196:199], v[56:59], v[248:255], v8
    s_waitcnt lgkmcnt(4)
    v_smfmac_f32_16x16x64_bf16 v[172:175], v[144:147], a[0:7], v8
    s_waitcnt lgkmcnt(3)
    v_smfmac_f32_16x16x64_bf16 v[172:175], v[148:151], a[8:15], v8
    s_waitcnt lgkmcnt(2)
    v_smfmac_f32_16x16x64_bf16 v[172:175], v[152:155], a[16:23], v8
    ds_read_b128 v[216:219], v12 offset:4096
    ds_read_b128 v[220:223], v12 offset:5120
    ds_read_b128 v[224:227], v12 offset:6144
    ds_read_b128 v[228:231], v12 offset:7168
    ds_read_b32 v96, v16 offset:0
    ds_read_b32 v97, v16 offset:128
    ds_read_b32 v98, v16 offset:4
    ds_read_b32 v99, v16 offset:132
    s_waitcnt lgkmcnt(9)
    s_waitcnt lgkmcnt(8)
    v_smfmac_f32_16x16x64_bf16 v[172:175], v[164:167], v[200:207], v8
    v_smfmac_f32_16x16x64_bf16 v[172:175], v[168:171], v[208:215], v8
    v_smfmac_f32_16x16x64_bf16 v[176:179], v[144:147], a[40:47], v8
    v_smfmac_f32_16x16x64_bf16 v[176:179], v[148:151], a[48:55], v8
    ds_read_b128 v[200:203], v12 offset:8192
    ds_read_b128 v[204:207], v12 offset:9216
    ds_read_b128 v[208:211], v12 offset:10240
    ds_read_b128 v[212:215], v12 offset:11264
    ds_read_b32 v100, v16 offset:512
    ds_read_b32 v101, v16 offset:640
    ds_read_b32 v102, v16 offset:516
    ds_read_b32 v103, v16 offset:644
    v_smfmac_f32_16x16x64_bf16 v[176:179], v[152:155], a[56:63], v8
    s_nop 1
    v_cvt_pk_bf16_f32 v60, v172, v173
    v_cvt_pk_bf16_f32 v61, v174, v175
    ds_write_b64 v13, v[60:61] offset:0
    s_waitcnt lgkmcnt(13)
    v_smfmac_f32_16x16x64_bf16 v[176:179], v[164:167], v[216:223], v8
    v_smfmac_f32_16x16x64_bf16 v[176:179], v[168:171], v[224:231], v8
    v_smfmac_f32_16x16x64_bf16 v[180:183], v[144:147], a[80:87], v8
    v_smfmac_f32_16x16x64_bf16 v[180:183], v[148:151], a[88:95], v8
    ds_read_b128 v[216:219], v12 offset:12288
    ds_read_b128 v[220:223], v12 offset:13312
    ds_read_b128 v[224:227], v12 offset:14336
    ds_read_b128 v[228:231], v12 offset:15360
    ds_read_b32 v104, v16 offset:1024
    ds_read_b32 v105, v16 offset:1152
    ds_read_b32 v106, v16 offset:1028
    ds_read_b32 v107, v16 offset:1156
    v_smfmac_f32_16x16x64_bf16 v[180:183], v[152:155], a[96:103], v8
    s_nop 1
    v_cvt_pk_bf16_f32 v62, v176, v177
    v_cvt_pk_bf16_f32 v63, v178, v179
    ds_write_b64 v13, v[62:63] offset:128
    ds_read_b64_tr_b16 v[80:81], v15 offset:0
    ds_read_b64_tr_b16 v[82:83], v15 offset:128
    s_waitcnt lgkmcnt(15)
    v_smfmac_f32_16x16x64_bf16 v[180:183], v[164:167], v[200:207], v8
    v_smfmac_f32_16x16x64_bf16 v[180:183], v[168:171], v[208:215], v8
    v_smfmac_f32_16x16x64_bf16 v[184:187], v[144:147], a[120:127], v8
    v_smfmac_f32_16x16x64_bf16 v[184:187], v[148:151], a[128:135], v8
    ds_read_b128 v[200:203], v12 offset:16384
    ds_read_b128 v[204:207], v12 offset:17408
    ds_read_b128 v[208:211], v12 offset:18432
    ds_read_b128 v[212:215], v12 offset:19456
    ds_read_b32 v108, v17 offset:0
    ds_read_b32 v109, v17 offset:128
    ds_read_b32 v110, v17 offset:4
    ds_read_b32 v111, v17 offset:132
    v_smfmac_f32_16x16x64_bf16 v[184:187], v[152:155], a[136:143], v8
    s_nop 1
    v_cvt_pk_bf16_f32 v60, v180, v181
    v_cvt_pk_bf16_f32 v61, v182, v183
    ds_write_b64 v13, v[60:61] offset:1568
    s_waitcnt lgkmcnt(15)
    v_smfmac_f32_16x16x64_bf16 v[184:187], v[164:167], v[216:223], v8
    v_smfmac_f32_16x16x64_bf16 v[184:187], v[168:171], v[224:231], v8
    s_waitcnt lgkmcnt(9)
    v_mfma_f32_16x16x32_bf16 v[68:71], v[112:115], v[80:83], v[68:71]
    v_mfma_f32_16x16x32_bf16 v[72:75], v[128:131], v[80:83], v[72:75]
    v_mfma_f32_16x16x32_bf16 v[76:79], v[96:99], v[80:83], v[76:79]
    s_add_u32 s29, s46, 0
    buffer_load_dwordx4 v[112:115], v5, s[4:7], s29 offen offset:0
    s_add_u32 s29, s46, 14336
    buffer_load_dwordx4 v[128:131], v5, s[4:7], s29 offen offset:0
    v_smfmac_f32_16x16x64_bf16 v[188:191], v[144:147], a[160:167], v8
    v_smfmac_f32_16x16x64_bf16 v[188:191], v[148:151], a[168:175], v8
    ds_read_b128 v[216:219], v12 offset:20480
    ds_read_b128 v[220:223], v12 offset:21504
    ds_read_b128 v[224:227], v12 offset:22528
    ds_read_b128 v[228:231], v12 offset:23552
    v_smfmac_f32_16x16x64_bf16 v[188:191], v[152:155], a[176:183], v8
    s_nop 1
    v_cvt_pk_bf16_f32 v62, v184, v185
    v_cvt_pk_bf16_f32 v63, v186, v187
    ds_write_b64 v13, v[62:63] offset:1696
    ds_read_b64_tr_b16 v[84:85], v15 offset:1568
    ds_read_b64_tr_b16 v[86:87], v15 offset:1696
    s_waitcnt lgkmcnt(12)
    v_smfmac_f32_16x16x64_bf16 v[188:191], v[164:167], v[200:207], v8
    v_smfmac_f32_16x16x64_bf16 v[188:191], v[168:171], v[208:215], v8
    v_smfmac_f32_16x16x64_bf16 v[192:195], v[144:147], a[200:207], v8
    v_smfmac_f32_16x16x64_bf16 v[192:195], v[148:151], a[208:215], v8
    ds_read_b128 v[200:203], v12 offset:24576
    ds_read_b128 v[204:207], v12 offset:25600
    ds_read_b128 v[208:211], v12 offset:26624
    ds_read_b128 v[212:215], v12 offset:27648
    v_smfmac_f32_16x16x64_bf16 v[192:195], v[152:155], a[216:223], v8
    s_nop 1
    v_cvt_pk_bf16_f32 v60, v188, v189
    v_cvt_pk_bf16_f32 v61, v190, v191
    ds_write_b64 v13, v[60:61] offset:3136
    s_waitcnt lgkmcnt(8)
    v_smfmac_f32_16x16x64_bf16 v[192:195], v[164:167], v[216:223], v8
    v_smfmac_f32_16x16x64_bf16 v[192:195], v[168:171], v[224:231], v8
    s_waitcnt lgkmcnt(5)
    v_mfma_f32_16x16x32_bf16 v[68:71], v[116:119], v[84:87], v[68:71]
    v_mfma_f32_16x16x32_bf16 v[72:75], v[132:135], v[84:87], v[72:75]
    v_mfma_f32_16x16x32_bf16 v[76:79], v[100:103], v[84:87], v[76:79]
    s_add_u32 s29, s46, 0
    buffer_load_dwordx4 v[116:119], v5, s[4:7], s29 offen offset:1024
    s_add_u32 s29, s46, 14336
    buffer_load_dwordx4 v[132:135], v5, s[4:7], s29 offen offset:1024
    v_smfmac_f32_16x16x64_bf16 v[196:199], v[144:147], a[240:247], v8
    v_smfmac_f32_16x16x64_bf16 v[196:199], v[148:151], a[248:255], v8
    v_smfmac_f32_16x16x64_bf16 v[196:199], v[152:155], v[232:239], v8
    s_nop 1
    v_cvt_pk_bf16_f32 v62, v192, v193
    v_cvt_pk_bf16_f32 v63, v194, v195
    ds_write_b64 v13, v[62:63] offset:3264
    ds_read_b64_tr_b16 v[88:89], v15 offset:3136
    ds_read_b64_tr_b16 v[90:91], v15 offset:3264
    s_waitcnt lgkmcnt(4)
    v_smfmac_f32_16x16x64_bf16 v[196:199], v[164:167], v[200:207], v8
    v_smfmac_f32_16x16x64_bf16 v[196:199], v[168:171], v[208:215], v8
    s_waitcnt lgkmcnt(0)
    v_mfma_f32_16x16x32_bf16 v[68:71], v[120:123], v[88:91], v[68:71]
    v_mfma_f32_16x16x32_bf16 v[72:75], v[136:139], v[88:91], v[72:75]
    v_mfma_f32_16x16x32_bf16 v[76:79], v[104:107], v[88:91], v[76:79]
    s_add_u32 s29, s46, 0
    buffer_load_dwordx4 v[120:123], v5, s[4:7], s29 offen offset:2048
    s_add_u32 s29, s46, 14336
    buffer_load_dwordx4 v[136:139], v5, s[4:7], s29 offen offset:2048
    s_nop 3
    v_cvt_pk_bf16_f32 v60, v196, v197
    v_cvt_pk_bf16_f32 v61, v198, v199
    ds_write_b64 v14, v[60:61]
    ds_read_b64_tr_b16 v[92:93], v15 offset:4704
    ds_read_b64_tr_b16 v[94:95], v15 offset:4832
    s_waitcnt lgkmcnt(0)
    v_mfma_f32_16x16x32_bf16 v[68:71], v[124:127], v[92:95], v[68:71]
    v_mfma_f32_16x16x32_bf16 v[72:75], v[140:143], v[92:95], v[72:75]
    v_mfma_f32_16x16x32_bf16 v[76:79], v[108:111], v[92:95], v[76:79]
    s_nop 7
    ds_write_b128 v18, v[68:71] offset:0
    ds_write_b128 v18, v[72:75] offset:1152
    ds_write_b128 v18, v[76:79] offset:2304
    s_add_u32 s30, s47, 0
    buffer_load_dwordx4 v[124:127], v5, s[4:7], s30 offen
    s_add_u32 s30, s47, 14336
    buffer_load_dwordx4 v[140:143], v5, s[4:7], s30 offen
    s_add_u32 s46, s46, 28672
    s_add_u32 s47, s47, 28672
    s_waitcnt lgkmcnt(0)
    s_barrier
    ds_read_b128 v[32:35], v19 offset:0
    ds_read_b128 v[36:39], v19 offset:3456
    ds_read_b128 v[40:43], v19 offset:6912
    ds_read_b128 v[44:47], v19 offset:10368
    s_waitcnt lgkmcnt(2)
    v_pk_add_f32 v[32:33], v[32:33], v[36:37]
    v_pk_add_f32 v[34:35], v[34:35], v[38:39]
    s_waitcnt lgkmcnt(0)
    v_pk_add_f32 v[40:41], v[40:41], v[44:45]
    v_pk_add_f32 v[42:43], v[42:43], v[46:47]
    v_pk_add_f32 v[32:33], v[32:33], v[40:41]
    v_pk_add_f32 v[34:35], v[34:35], v[42:43]
    s_nop 1
    v_add_f32_dpp v36, v32, v32 quad_perm:[1,0,3,2] row_mask:0xf bank_mask:0xf
    v_add_f32_dpp v37, v33, v33 quad_perm:[1,0,3,2] row_mask:0xf bank_mask:0xf
    v_add_f32_dpp v38, v34, v34 quad_perm:[1,0,3,2] row_mask:0xf bank_mask:0xf
    v_add_f32_dpp v39, v35, v35 quad_perm:[1,0,3,2] row_mask:0xf bank_mask:0xf
    v_max3_f32 v40, v36, v37, v38
    v_max_f32 v40, v40, v39
    s_nop 1
    v_max_f32_dpp v40, v40, v40 row_ror:8 row_mask:0xf bank_mask:0xf
    s_nop 1
    v_max_f32_dpp v40, v40, v40 row_ror:4 row_mask:0xf bank_mask:0xf
    s_nop 1
    v_max_f32_dpp v40, v40, v40 row_ror:2 row_mask:0xf bank_mask:0xf
    v_mov_b32 v41, v40
    s_nop 1
    v_permlane16_swap_b32 v41, v40
    s_nop 1
    v_max_f32 v40, v41, v40
    v_mul_f32 v40, 0xbfb8aa3b, v40
    v_fma_f32 v36, v36, s53, v40
    v_fma_f32 v37, v37, s53, v40
    v_fma_f32 v38, v38, s53, v40
    v_fma_f32 v39, v39, s53, v40
    v_exp_f32 v36, v36
    v_exp_f32 v37, v37
    v_exp_f32 v38, v38
    v_exp_f32 v39, v39
    s_nop 0
    v_add_f32 v40, v36, v37
    v_add_f32 v42, v38, v39
    v_add_f32 v40, v40, v42
    v_mul_f32 v40, v40, v21
    s_nop 1
    v_add_f32_dpp v40, v40, v40 row_ror:8 row_mask:0xf bank_mask:0xf
    s_nop 1
    v_add_f32_dpp v40, v40, v40 row_ror:4 row_mask:0xf bank_mask:0xf
    s_nop 1
    v_add_f32_dpp v40, v40, v40 row_ror:2 row_mask:0xf bank_mask:0xf
    v_mov_b32 v41, v40
    s_nop 1
    v_permlane16_swap_b32 v41, v40
    s_nop 1
    v_add_f32 v40, v41, v40
    v_rcp_f32 v40, v40
    s_nop 0
    v_mul_f32 v36, v36, v40
    v_mul_f32 v37, v37, v40
    v_mul_f32 v38, v38, v40
    v_mul_f32 v39, v39, v40
    v_cvt_pk_bf16_f32 v36, v36, v37
    v_cvt_pk_bf16_f32 v37, v38, v39
    v_cndmask_b32 v36, v36, v37, s[42:43]
    v_min_u32 v36, -2, v36
    s_cmp_eq_u32 s22, 0
    s_cbranch_scc0 SF_6
    buffer_store_dword v36, v20, s[4:7], s49 offen
    s_branch SF_6_e
SF_6:
    buffer_store_dword v36, v20, s[4:7], s49 offen sc1
SF_6_e:
    s_add_u32 s48, s48, 7168
    s_add_u32 s49, s49, 12288
    s_add_u32 s50, s50, 1
    s_cmp_lt_u32 s50, 63
    s_cbranch_scc1 A_LOOP3
    s_branch A_END
A_END:
    s_cmp_eq_u32 s21, 3
    s_cbranch_scc0 A_ND
    s_cmp_eq_u32 s20, 0
    s_cbranch_scc0 A_ND
A_ND:
    s_branch K2_END
K2_VROLE:
    v_lshlrev_b32 v5, 4, v1
    v_lshlrev_b32 v9, 4, v0
    v_mov_b32 v6, v9
    v_add_u32 v7, 4096, v9
    v_cmp_gt_u32 vcc, 192, v0
    v_mov_b32 v10, 536870912
    s_nop 1
    v_cndmask_b32 v7, v10, v7, vcc
    v_cmp_gt_u32 vcc, 8, v3
    v_mov_b32 v10, 0xeeeeeeee
    v_mov_b32 v11, 0x44444444
    s_nop 1
    v_cndmask_b32 v8, v10, v11, vcc
    s_sub_u32 s24, s21, 16
    s_and_b32 s25, s20, 1
    s_lshr_b32 s26, s20, 1
    s_lshl_b32 s27, s24, 1
    s_mul_i32 s28, s20, 112
    s_add_u32 s28, s28, s27
    s_mul_i32 s28, s28, 14336
    s_add_u32 s28, s28, 6422528
    s_lshl_b32 s29, s20, 15
    s_add_u32 s29, s29, 16384
    v_add_u32 v12, s29, v5
    s_add_u32 s29, s28, 0
    buffer_load_dwordx4 a[0:3], v5, s[4:7], s29 offen
    buffer_load_dwordx4 a[4:7], v5, s[4:7], s29 offen offset:1024
    buffer_load_dwordx4 a[8:11], v5, s[4:7], s29 offen offset:2048
    buffer_load_dwordx4 a[12:15], v5, s[4:7], s29 offen offset:3072
    s_add_u32 s29, s29, 4096
    buffer_load_dwordx4 a[16:19], v5, s[4:7], s29 offen
    buffer_load_dwordx4 a[20:23], v5, s[4:7], s29 offen offset:1024
    buffer_load_dwordx4 a[24:27], v5, s[4:7], s29 offen offset:2048
    buffer_load_dwordx4 a[28:31], v5, s[4:7], s29 offen offset:3072
    s_add_u32 s29, s29, 4096
    buffer_load_dwordx4 a[32:35], v5, s[4:7], s29 offen
    buffer_load_dwordx4 a[36:39], v5, s[4:7], s29 offen offset:1024
    buffer_load_dwordx4 v[32:35], v5, s[4:7], s29 offen offset:2048
    buffer_load_dwordx4 v[36:39], v5, s[4:7], s29 offen offset:3072
    s_add_u32 s29, s29, 4096
    buffer_load_dwordx4 v[40:43], v5, s[4:7], s29 offen
    buffer_load_dwordx4 v[44:47], v5, s[4:7], s29 offen offset:1024
    s_add_u32 s29, s28, 401408
    buffer_load_dwordx4 a[40:43], v5, s[4:7], s29 offen
    buffer_load_dwordx4 a[44:47], v5, s[4:7], s29 offen offset:1024
    buffer_load_dwordx4 a[48:51], v5, s[4:7], s29 offen offset:2048
    buffer_load_dwordx4 a[52:55], v5, s[4:7], s29 offen offset:3072
    s_add_u32 s29, s29, 4096
    buffer_load_dwordx4 a[56:59], v5, s[4:7], s29 offen
    buffer_load_dwordx4 a[60:63], v5, s[4:7], s29 offen offset:1024
    buffer_load_dwordx4 a[64:67], v5, s[4:7], s29 offen offset:2048
    buffer_load_dwordx4 a[68:71], v5, s[4:7], s29 offen offset:3072
    s_add_u32 s29, s29, 4096
    buffer_load_dwordx4 a[72:75], v5, s[4:7], s29 offen
    buffer_load_dwordx4 a[76:79], v5, s[4:7], s29 offen offset:1024
    buffer_load_dwordx4 v[48:51], v5, s[4:7], s29 offen offset:2048
    buffer_load_dwordx4 v[52:55], v5, s[4:7], s29 offen offset:3072
    s_add_u32 s29, s29, 4096
    buffer_load_dwordx4 v[56:59], v5, s[4:7], s29 offen
    buffer_load_dwordx4 v[60:63], v5, s[4:7], s29 offen offset:1024
    s_add_u32 s29, s28, 802816
    buffer_load_dwordx4 a[80:83], v5, s[4:7], s29 offen
    buffer_load_dwordx4 a[84:87], v5, s[4:7], s29 offen offset:1024
    buffer_load_dwordx4 a[88:91], v5, s[4:7], s29 offen offset:2048
    buffer_load_dwordx4 a[92:95], v5, s[4:7], s29 offen offset:3072
    s_add_u32 s29, s29, 4096
    buffer_load_dwordx4 a[96:99], v5, s[4:7], s29 offen
    buffer_load_dwordx4 a[100:103], v5, s[4:7], s29 offen offset:1024
    buffer_load_dwordx4 a[104:107], v5, s[4:7], s29 offen offset:2048
    buffer_load_dwordx4 a[108:111], v5, s[4:7], s29 offen offset:3072
    s_add_u32 s29, s29, 4096
    buffer_load_dwordx4 a[112:115], v5, s[4:7], s29 offen
    buffer_load_dwordx4 a[116:119], v5, s[4:7], s29 offen offset:1024
    buffer_load_dwordx4 v[64:67], v5, s[4:7], s29 offen offset:2048
    buffer_load_dwordx4 v[68:71], v5, s[4:7], s29 offen offset:3072
    s_add_u32 s29, s29, 4096
    buffer_load_dwordx4 v[72:75], v5, s[4:7], s29 offen
    buffer_load_dwordx4 v[76:79], v5, s[4:7], s29 offen offset:1024
    s_add_u32 s29, s28, 1204224
    buffer_load_dwordx4 a[120:123], v5, s[4:7], s29 offen
    buffer_load_dwordx4 a[124:127], v5, s[4:7], s29 offen offset:1024
    buffer_load_dwordx4 a[128:131], v5, s[4:7], s29 offen offset:2048
    buffer_load_dwordx4 a[132:135], v5, s[4:7], s29 offen offset:3072
    s_add_u32 s29, s29, 4096
    buffer_load_dwordx4 a[136:139], v5, s[4:7], s29 offen
    buffer_load_dwordx4 a[140:143], v5, s[4:7], s29 offen offset:1024
    buffer_load_dwordx4 a[144:147], v5, s[4:7], s29 offen offset:2048
    buffer_load_dwordx4 a[148:151], v5, s[4:7], s29 offen offset:3072
    s_add_u32 s29, s29, 4096
    buffer_load_dwordx4 a[152:155], v5, s[4:7], s29 offen
    buffer_load_dwordx4 a[156:159], v5, s[4:7], s29 offen offset:1024
    buffer_load_dwordx4 v[80:83], v5, s[4:7], s29 offen offset:2048
    buffer_load_dwordx4 v[84:87], v5, s[4:7], s29 offen offset:3072
    s_add_u32 s29, s29, 4096
    buffer_load_dwordx4 v[88:91], v5, s[4:7], s29 offen
    buffer_load_dwordx4 v[92:95], v5, s[4:7], s29 offen offset:1024
    s_add_u32 s29, s28, 14336
    buffer_load_dwordx4 a[160:163], v5, s[4:7], s29 offen
    buffer_load_dwordx4 a[164:167], v5, s[4:7], s29 offen offset:1024
    buffer_load_dwordx4 a[168:171], v5, s[4:7], s29 offen offset:2048
    buffer_load_dwordx4 a[172:175], v5, s[4:7], s29 offen offset:3072
    s_add_u32 s29, s29, 4096
    buffer_load_dwordx4 a[176:179], v5, s[4:7], s29 offen
    buffer_load_dwordx4 a[180:183], v5, s[4:7], s29 offen offset:1024
    buffer_load_dwordx4 a[184:187], v5, s[4:7], s29 offen offset:2048
    buffer_load_dwordx4 a[188:191], v5, s[4:7], s29 offen offset:3072
    s_add_u32 s29, s29, 4096
    buffer_load_dwordx4 a[192:195], v5, s[4:7], s29 offen
    buffer_load_dwordx4 a[196:199], v5, s[4:7], s29 offen offset:1024
    buffer_load_dwordx4 v[96:99], v5, s[4:7], s29 offen offset:2048
    buffer_load_dwordx4 v[100:103], v5, s[4:7], s29 offen offset:3072
    s_add_u32 s29, s29, 4096
    buffer_load_dwordx4 v[104:107], v5, s[4:7], s29 offen
    buffer_load_dwordx4 v[108:111], v5, s[4:7], s29 offen offset:1024
    s_add_u32 s29, s28, 415744
    buffer_load_dwordx4 a[200:203], v5, s[4:7], s29 offen
    buffer_load_dwordx4 a[204:207], v5, s[4:7], s29 offen offset:1024
    buffer_load_dwordx4 a[208:211], v5, s[4:7], s29 offen offset:2048
    buffer_load_dwordx4 a[212:215], v5, s[4:7], s29 offen offset:3072
    s_add_u32 s29, s29, 4096
    buffer_load_dwordx4 a[216:219], v5, s[4:7], s29 offen
    buffer_load_dwordx4 a[220:223], v5, s[4:7], s29 offen offset:1024
    buffer_load_dwordx4 a[224:227], v5, s[4:7], s29 offen offset:2048
    buffer_load_dwordx4 a[228:231], v5, s[4:7], s29 offen offset:3072
    s_add_u32 s29, s29, 4096
    buffer_load_dwordx4 a[232:235], v5, s[4:7], s29 offen
    buffer_load_dwordx4 a[236:239], v5, s[4:7], s29 offen offset:1024
    buffer_load_dwordx4 v[112:115], v5, s[4:7], s29 offen offset:2048
    buffer_load_dwordx4 v[116:119], v5, s[4:7], s29 offen offset:3072
    s_add_u32 s29, s29, 4096
    buffer_load_dwordx4 v[120:123], v5, s[4:7], s29 offen
    buffer_load_dwordx4 v[124:127], v5, s[4:7], s29 offen offset:1024
    s_add_u32 s29, s28, 817152
    buffer_load_dwordx4 a[240:243], v5, s[4:7], s29 offen
    buffer_load_dwordx4 a[244:247], v5, s[4:7], s29 offen offset:1024
    buffer_load_dwordx4 a[248:251], v5, s[4:7], s29 offen offset:2048
    buffer_load_dwordx4 a[252:255], v5, s[4:7], s29 offen offset:3072
    s_add_u32 s29, s29, 4096
    buffer_load_dwordx4 v[168:171], v5, s[4:7], s29 offen
    buffer_load_dwordx4 v[172:175], v5, s[4:7], s29 offen offset:1024
    buffer_load_dwordx4 v[176:179], v5, s[4:7], s29 offen offset:2048
    buffer_load_dwordx4 v[180:183], v5, s[4:7], s29 offen offset:3072
    s_add_u32 s29, s29, 4096
    buffer_load_dwordx4 v[184:187], v5, s[4:7], s29 offen
    buffer_load_dwordx4 v[188:191], v5, s[4:7], s29 offen offset:1024
    buffer_load_dwordx4 v[128:131], v5, s[4:7], s29 offen offset:2048
    buffer_load_dwordx4 v[132:135], v5, s[4:7], s29 offen offset:3072
    s_add_u32 s29, s29, 4096
    buffer_load_dwordx4 v[136:139], v5, s[4:7], s29 offen
    buffer_load_dwordx4 v[140:143], v5, s[4:7], s29 offen offset:1024
    s_add_u32 s29, s28, 1218560
    buffer_load_dwordx4 v[192:195], v5, s[4:7], s29 offen
    buffer_load_dwordx4 v[196:199], v5, s[4:7], s29 offen offset:1024
    buffer_load_dwordx4 v[200:203], v5, s[4:7], s29 offen offset:2048
    buffer_load_dwordx4 v[204:207], v5, s[4:7], s29 offen offset:3072
    s_add_u32 s29, s29, 4096
    buffer_load_dwordx4 v[208:211], v5, s[4:7], s29 offen
    buffer_load_dwordx4 v[212:215], v5, s[4:7], s29 offen offset:1024
    buffer_load_dwordx4 v[216:219], v5, s[4:7], s29 offen offset:2048
    buffer_load_dwordx4 v[220:223], v5, s[4:7], s29 offen offset:3072
    s_add_u32 s29, s29, 4096
    buffer_load_dwordx4 v[224:227], v5, s[4:7], s29 offen
    buffer_load_dwordx4 v[228:231], v5, s[4:7], s29 offen offset:1024
    buffer_load_dwordx4 v[144:147], v5, s[4:7], s29 offen offset:2048
    buffer_load_dwordx4 v[148:151], v5, s[4:7], s29 offen offset:3072
    s_add_u32 s29, s29, 4096
    buffer_load_dwordx4 v[152:155], v5, s[4:7], s29 offen
    buffer_load_dwordx4 v[156:159], v5, s[4:7], s29 offen offset:1024
    s_waitcnt vmcnt(0)
    ds_write_b128 v12, v[32:35] offset:0
    ds_write_b128 v12, v[36:39] offset:1024
    ds_write_b128 v12, v[40:43] offset:2048
    ds_write_b128 v12, v[44:47] offset:3072
    ds_write_b128 v12, v[48:51] offset:4096
    ds_write_b128 v12, v[52:55] offset:5120
    ds_write_b128 v12, v[56:59] offset:6144
    ds_write_b128 v12, v[60:63] offset:7168
    ds_write_b128 v12, v[64:67] offset:8192
    ds_write_b128 v12, v[68:71] offset:9216
    ds_write_b128 v12, v[72:75] offset:10240
    ds_write_b128 v12, v[76:79] offset:11264
    ds_write_b128 v12, v[80:83] offset:12288
    ds_write_b128 v12, v[84:87] offset:13312
    ds_write_b128 v12, v[88:91] offset:14336
    ds_write_b128 v12, v[92:95] offset:15360
    ds_write_b128 v12, v[96:99] offset:16384
    ds_write_b128 v12, v[100:103] offset:17408
    ds_write_b128 v12, v[104:107] offset:18432
    ds_write_b128 v12, v[108:111] offset:19456
    ds_write_b128 v12, v[112:115] offset:20480
    ds_write_b128 v12, v[116:119] offset:21504
    ds_write_b128 v12, v[120:123] offset:22528
    ds_write_b128 v12, v[124:127] offset:23552
    ds_write_b128 v12, v[128:131] offset:24576
    ds_write_b128 v12, v[132:135] offset:25600
    ds_write_b128 v12, v[136:139] offset:26624
    ds_write_b128 v12, v[140:143] offset:27648
    ds_write_b128 v12, v[144:147] offset:28672
    ds_write_b128 v12, v[148:151] offset:29696
    ds_write_b128 v12, v[152:155] offset:30720
    ds_write_b128 v12, v[156:159] offset:31744
    s_waitcnt lgkmcnt(0)
    s_lshl_b32 s29, s20, 11
    s_add_u32 s29, s29, 8192
    v_lshlrev_b32 v10, 8, v4
    v_lshl_add_u32 v10, v3, 2, v10
    v_add_u32 v13, s29, v10
    v_lshrrev_b32 v10, 2, v1
    v_and_b32 v11, 7, v10
    v_lshlrev_b32 v11, 6, v11
    v_and_b32 v14, 3, v1
    v_lshl_add_u32 v11, v14, 4, v11
    v_lshrrev_b32 v10, 3, v10
    v_lshl_add_u32 v11, v10, 3, v11
    s_lshl_b32 s29, s25, 10
    s_add_u32 s29, s29, 8192
    v_add_u32 v14, s29, v11
    v_add_u32 v10, 0, v4
    v_and_b32 v10, 3, v10
    v_mov_b32 v10, v10
    v_lshlrev_b32 v10, 6, v10
    v_add_u32 v248, v13, v10
    v_add_u32 v248, 0, v248
    v_add_u32 v10, 1, v4
    v_and_b32 v10, 3, v10
    v_subrev_u32 v10, 1, v10
    v_lshlrev_b32 v10, 6, v10
    v_add_u32 v249, v13, v10
    v_add_u32 v249, 64, v249
    v_add_u32 v10, 2, v4
    v_and_b32 v10, 3, v10
    v_subrev_u32 v10, 2, v10
    v_lshlrev_b32 v10, 6, v10
    v_add_u32 v250, v13, v10
    v_add_u32 v250, 128, v250
    v_add_u32 v10, 3, v4
    v_and_b32 v10, 3, v10
    v_subrev_u32 v10, 3, v10
    v_lshlrev_b32 v10, 6, v10
    v_add_u32 v251, v13, v10
    v_add_u32 v251, 192, v251
    v_lshrrev_b32 v10, 2, v1
    v_and_b32 v10, 7, v10
    v_lshrrev_b32 v11, 2, v10
    v_and_b32 v252, 3, v10
    v_add_u32 v253, v252, v11
    v_and_b32 v253, 3, v253
    v_sub_u32 v253, v253, v252
    v_lshlrev_b32 v253, 6, v253
    v_add_u32 v254, v252, v11
    v_add_u32 v254, 2, v254
    v_and_b32 v254, 3, v254
    v_sub_u32 v254, v254, v252
    v_lshlrev_b32 v254, 6, v254
    v_add_u32 v252, v14, v254
    v_add_u32 v252, 512, v252
    v_add_u32 v14, v14, v253
    s_lshl_b32 s29, s24, 9
    s_lshl_b32 s30, s25, 8
    s_add_u32 s29, s29, s30
    v_lshlrev_b32 v15, 2, v1
    v_add_u32 v15, s29, v15
    v_lshlrev_b32 v16, 4, v1
    v_mov_b32 v17, 0
    v_mov_b32 v18, 1
    s_mul_i32 s46, s20, 1792
    s_lshl_b32 s29, s27, 4
    s_add_u32 s46, s46, s29
    s_lshl_b32 s46, s46, 6
    s_add_u32 s46, s46, 14680064
    s_lshl_b32 s47, s27, 3
    s_lshl_b32 s29, s20, 1
    s_add_u32 s47, s47, s29
    s_lshl_b32 s47, s47, 10
    s_add_u32 s47, s47, 75104256
    s_lshl_b32 s49, s20, 11
    s_add_u32 s49, s49, 74317824
    s_lshl_b32 s51, s20, 10
    s_add_u32 s51, s51, 74326016
    s_mov_b32 s55, 100556800
    s_mov_b32 s48, 73400320
    s_mov_b32 s50, 0
    s_mov_b32 s52, 0
    s_cmp_lt_u32 s50, s52
    s_cbranch_scc1 V_X0_ok
V_X0:
    s_lshl_b32 s29, s50, 7
    s_add_u32 s29, s29, 100507648
    s_mov_b32 s30, 100515712
    buffer_load_dword v10, v17, s[4:7], s29 offen sc1
    buffer_load_dword v11, v17, s[4:7], s30 offen sc1
    s_waitcnt vmcnt(0)
    v_readfirstlane_b32 s29, v10
    v_readfirstlane_b32 s30, v11
    s_cmp_ge_u32 s30, 112
    s_cselect_b32 s52, 64, s52
    s_cmp_ge_u32 s29, 112
    s_cbranch_scc1 V_X0_ok
    s_sub_u32 s23, s23, 1
    s_cmp_gt_i32 s23, 0
    s_cbranch_scc1 V_X0
V_X0_ok:
    s_add_u32 s29, s46, 0
    buffer_load_dwordx4 v[60:63], v16, s[4:7], s29 offen sc1
    s_add_u32 s29, s46, 28672
    buffer_load_dwordx4 v[64:67], v16, s[4:7], s29 offen sc1
    s_add_u32 s29, s46, 57344
    buffer_load_dwordx4 v[68:71], v16, s[4:7], s29 offen sc1
    s_add_u32 s29, s46, 86016
    buffer_load_dwordx4 v[72:75], v16, s[4:7], s29 offen sc1
    s_add_u32 s29, s46, 1024
    buffer_load_dwordx4 v[76:79], v16, s[4:7], s29 offen sc1
    s_add_u32 s29, s46, 29696
    buffer_load_dwordx4 v[80:83], v16, s[4:7], s29 offen sc1
    s_add_u32 s29, s46, 58368
    buffer_load_dwordx4 v[84:87], v16, s[4:7], s29 offen sc1
    s_add_u32 s29, s46, 87040
    buffer_load_dwordx4 v[88:91], v16, s[4:7], s29 offen sc1
    s_add_u32 s46, s46, 458752
V_LOOP:
V_POLL:
    buffer_load_dwordx4 v[20:23], v6, s[4:7], s48 offen sc1
    buffer_load_dwordx4 v[24:27], v7, s[4:7], s48 offen sc1
    s_waitcnt vmcnt(0)
    v_max3_u32 v10, v20, v21, v22
    v_max3_u32 v11, v23, v24, v25
    v_max3_u32 v10, v10, v26, v27
    v_max_u32 v10, v10, v11
    v_cmp_eq_u32 vcc, -1, v10
    s_cbranch_vccz V_POLL_ok
    s_sub_u32 s23, s23, 1
    s_cmp_gt_i32 s23, 0
    s_cbranch_scc1 V_POLL
V_POLL_ok:
    ds_write_b128 v9, v[20:23]
    ds_write_b128 v9, v[24:27] offset:4096
    s_waitcnt lgkmcnt(0)
    s_barrier
    s_cmp_eq_u32 s21, 16
    s_cbranch_scc0 V_NOM2
    s_add_u32 s29, s48, 458752
    buffer_store_dwordx4 v[20:23], v6, s[4:7], s29 offen sc1
    buffer_store_dwordx4 v[24:27], v7, s[4:7], s29 offen sc1
V_NOM2:
    ds_read_b128 v[32:35], v5 offset:0
    ds_read_b128 v[36:39], v5 offset:1024
    ds_read_b128 v[40:43], v5 offset:2048
    ds_read_b128 v[44:47], v5 offset:3072
    ds_read_b128 v[48:51], v5 offset:4096
    ds_read_b128 v[52:55], v5 offset:5120
    ds_read_b128 v[56:59], v5 offset:6144
    ds_read_b128 v[152:155], v12 offset:0
    ds_read_b128 v[156:159], v12 offset:1024
    ds_read_b128 v[160:163], v12 offset:2048
    ds_read_b128 v[164:167], v12 offset:3072
    v_mov_b32 v140, 0
    v_mov_b32 v141, 0
    v_mov_b32 v142, 0
    v_mov_b32 v143, 0
    ds_read_b128 v[232:235], v12 offset:4096
    ds_read_b128 v[236:239], v12 offset:5120
    ds_read_b128 v[240:243], v12 offset:6144
    ds_read_b128 v[244:247], v12 offset:7168
    s_waitcnt lgkmcnt(14)
    v_smfmac_f32_16x16x64_bf16 v[140:143], v[32:35], a[0:7], v8
    v_mov_b32 v144, 0
    v_mov_b32 v145, 0
    v_mov_b32 v146, 0
    v_mov_b32 v147, 0
    s_waitcnt lgkmcnt(13)
    v_smfmac_f32_16x16x64_bf16 v[140:143], v[36:39], a[8:15], v8
    s_waitcnt lgkmcnt(12)
    v_smfmac_f32_16x16x64_bf16 v[140:143], v[40:43], a[16:23], v8
    s_waitcnt lgkmcnt(11)
    v_smfmac_f32_16x16x64_bf16 v[140:143], v[44:47], a[24:31], v8
    s_waitcnt lgkmcnt(10)
    v_smfmac_f32_16x16x64_bf16 v[140:143], v[48:51], a[32:39], v8
    s_waitcnt lgkmcnt(8)
    s_waitcnt lgkmcnt(4)
    v_smfmac_f32_16x16x64_bf16 v[140:143], v[52:55], v[152:159], v8
    v_smfmac_f32_16x16x64_bf16 v[140:143], v[56:59], v[160:167], v8
    s_cmp_eq_u32 s50, 0
    s_cbranch_scc1 VG_7
    s_cmp_eq_u32 s20, 0
    s_cbranch_scc0 VG_7
    s_sub_u32 s29, s50, 1
    s_lshl_b32 s29, s29, 7
    s_add_u32 s29, s29, 100524032
    s_mov_b64 exec, 1
    buffer_atomic_add v18, v17, s[4:7], s29 offen
    s_mov_b64 exec, -1
VG_7:
    s_add_u32 s53, s50, 1
    s_cmp_lt_u32 s53, 63
    s_cbranch_scc0 V_NOX
    s_cmp_lt_u32 s53, s52
    s_cbranch_scc1 V_X1_ok
V_X1:
    s_lshl_b32 s29, s53, 7
    s_add_u32 s29, s29, 100507648
    s_mov_b32 s30, 100515712
    buffer_load_dword v10, v17, s[4:7], s29 offen sc1
    buffer_load_dword v11, v17, s[4:7], s30 offen sc1
    s_waitcnt vmcnt(0)
    v_readfirstlane_b32 s29, v10
    v_readfirstlane_b32 s30, v11
    s_cmp_ge_u32 s30, 112
    s_cselect_b32 s52, 64, s52
    s_cmp_ge_u32 s29, 112
    s_cbranch_scc1 V_X1_ok
    s_sub_u32 s23, s23, 1
    s_cmp_gt_i32 s23, 0
    s_cbranch_scc1 V_X1
V_X1_ok:
V_NOX:
    s_cmp_lt_u32 s53, 63
    s_cselect_b32 s56, s46, 12845056
    s_add_u32 s29, s56, 0
    buffer_load_dwordx4 v[92:95], v16, s[4:7], s29 offen sc1
    ds_read_b128 v[152:155], v12 offset:8192
    ds_read_b128 v[156:159], v12 offset:9216
    ds_read_b128 v[160:163], v12 offset:10240
    ds_read_b128 v[164:167], v12 offset:11264
    v_smfmac_f32_16x16x64_bf16 v[144:147], v[32:35], a[40:47], v8
    v_mov_b32 v148, 0
    v_mov_b32 v149, 0
    v_mov_b32 v150, 0
    v_mov_b32 v151, 0
    v_smfmac_f32_16x16x64_bf16 v[144:147], v[36:39], a[48:55], v8
    v_smfmac_f32_16x16x64_bf16 v[144:147], v[40:43], a[56:63], v8
    v_smfmac_f32_16x16x64_bf16 v[144:147], v[44:47], a[64:71], v8
    v_cvt_pk_bf16_f32 v124, v140, v141
    v_cvt_pk_bf16_f32 v125, v142, v143
    v_smfmac_f32_16x16x64_bf16 v[144:147], v[48:51], a[72:79], v8
    s_waitcnt lgkmcnt(4)
    v_smfmac_f32_16x16x64_bf16 v[144:147], v[52:55], v[232:239], v8
    v_smfmac_f32_16x16x64_bf16 v[144:147], v[56:59], v[240:247], v8
    s_add_u32 s29, s56, 28672
    buffer_load_dwordx4 v[96:99], v16, s[4:7], s29 offen sc1
    ds_read_b128 v[232:235], v12 offset:12288
    ds_read_b128 v[236:239], v12 offset:13312
    ds_read_b128 v[240:243], v12 offset:14336
    ds_read_b128 v[244:247], v12 offset:15360
    v_smfmac_f32_16x16x64_bf16 v[148:151], v[32:35], a[80:87], v8
    v_mov_b32 v140, 0
    v_mov_b32 v141, 0
    v_mov_b32 v142, 0
    v_mov_b32 v143, 0
    v_smfmac_f32_16x16x64_bf16 v[148:151], v[36:39], a[88:95], v8
    v_smfmac_f32_16x16x64_bf16 v[148:151], v[40:43], a[96:103], v8
    v_smfmac_f32_16x16x64_bf16 v[148:151], v[44:47], a[104:111], v8
    v_cvt_pk_bf16_f32 v126, v144, v145
    v_cvt_pk_bf16_f32 v127, v146, v147
    buffer_store_dwordx4 v[124:127], v5, s[4:7], s47 offen offset:0 sc1
    v_smfmac_f32_16x16x64_bf16 v[148:151], v[48:51], a[112:119], v8
    s_waitcnt lgkmcnt(4)
    v_smfmac_f32_16x16x64_bf16 v[148:151], v[52:55], v[152:159], v8
    v_smfmac_f32_16x16x64_bf16 v[148:151], v[56:59], v[160:167], v8
    s_add_u32 s29, s56, 57344
    buffer_load_dwordx4 v[100:103], v16, s[4:7], s29 offen sc1
    ds_read_b128 v[152:155], v12 offset:16384
    ds_read_b128 v[156:159], v12 offset:17408
    ds_read_b128 v[160:163], v12 offset:18432
    ds_read_b128 v[164:167], v12 offset:19456
    v_smfmac_f32_16x16x64_bf16 v[140:143], v[32:35], a[120:127], v8
    v_mov_b32 v144, 0
    v_mov_b32 v145, 0
    v_mov_b32 v146, 0
    v_mov_b32 v147, 0
    v_smfmac_f32_16x16x64_bf16 v[140:143], v[36:39], a[128:135], v8
    v_smfmac_f32_16x16x64_bf16 v[140:143], v[40:43], a[136:143], v8
    v_smfmac_f32_16x16x64_bf16 v[140:143], v[44:47], a[144:151], v8
    v_cvt_pk_bf16_f32 v128, v148, v149
    v_cvt_pk_bf16_f32 v129, v150, v151
    v_smfmac_f32_16x16x64_bf16 v[140:143], v[48:51], a[152:159], v8
    s_waitcnt lgkmcnt(4)
    v_smfmac_f32_16x16x64_bf16 v[140:143], v[52:55], v[232:239], v8
    v_smfmac_f32_16x16x64_bf16 v[140:143], v[56:59], v[240:247], v8
    s_add_u32 s29, s56, 86016
    buffer_load_dwordx4 v[104:107], v16, s[4:7], s29 offen sc1
    ds_read_b128 v[232:235], v12 offset:20480
    ds_read_b128 v[236:239], v12 offset:21504
    ds_read_b128 v[240:243], v12 offset:22528
    ds_read_b128 v[244:247], v12 offset:23552
    v_smfmac_f32_16x16x64_bf16 v[144:147], v[32:35], a[160:167], v8
    v_mov_b32 v148, 0
    v_mov_b32 v149, 0
    v_mov_b32 v150, 0
    v_mov_b32 v151, 0
    v_smfmac_f32_16x16x64_bf16 v[144:147], v[36:39], a[168:175], v8
    v_smfmac_f32_16x16x64_bf16 v[144:147], v[40:43], a[176:183], v8
    v_smfmac_f32_16x16x64_bf16 v[144:147], v[44:47], a[184:191], v8
    v_cvt_pk_bf16_f32 v130, v140, v141
    v_cvt_pk_bf16_f32 v131, v142, v143
    buffer_store_dwordx4 v[128:131], v5, s[4:7], s47 offen offset:1024 sc1
    v_smfmac_f32_16x16x64_bf16 v[144:147], v[48:51], a[192:199], v8
    s_waitcnt lgkmcnt(4)
    v_smfmac_f32_16x16x64_bf16 v[144:147], v[52:55], v[152:159], v8
    v_smfmac_f32_16x16x64_bf16 v[144:147], v[56:59], v[160:167], v8
    s_add_u32 s29, s56, 1024
    buffer_load_dwordx4 v[108:111], v16, s[4:7], s29 offen sc1
    ds_read_b128 v[152:155], v12 offset:24576
    ds_read_b128 v[156:159], v12 offset:25600
    ds_read_b128 v[160:163], v12 offset:26624
    ds_read_b128 v[164:167], v12 offset:27648
    v_smfmac_f32_16x16x64_bf16 v[148:151], v[32:35], a[200:207], v8
    v_mov_b32 v140, 0
    v_mov_b32 v141, 0
    v_mov_b32 v142, 0
    v_mov_b32 v143, 0
    v_smfmac_f32_16x16x64_bf16 v[148:151], v[36:39], a[208:215], v8
    v_smfmac_f32_16x16x64_bf16 v[148:151], v[40:43], a[216:223], v8
    v_smfmac_f32_16x16x64_bf16 v[148:151], v[44:47], a[224:231], v8
    v_cvt_pk_bf16_f32 v132, v144, v145
    v_cvt_pk_bf16_f32 v133, v146, v147
    v_smfmac_f32_16x16x64_bf16 v[148:151], v[48:51], a[232:239], v8
    s_waitcnt lgkmcnt(4)
    v_smfmac_f32_16x16x64_bf16 v[148:151], v[52:55], v[232:239], v8
    v_smfmac_f32_16x16x64_bf16 v[148:151], v[56:59], v[240:247], v8
    s_add_u32 s29, s56, 29696
    buffer_load_dwordx4 v[112:115], v16, s[4:7], s29 offen sc1
    ds_read_b128 v[232:235], v12 offset:28672
    ds_read_b128 v[236:239], v12 offset:29696
    ds_read_b128 v[240:243], v12 offset:30720
    ds_read_b128 v[244:247], v12 offset:31744
    v_smfmac_f32_16x16x64_bf16 v[140:143], v[32:35], a[240:247], v8
    v_mov_b32 v144, 0
    v_mov_b32 v145, 0
    v_mov_b32 v146, 0
    v_mov_b32 v147, 0
    v_smfmac_f32_16x16x64_bf16 v[140:143], v[36:39], a[248:255], v8
    v_smfmac_f32_16x16x64_bf16 v[140:143], v[40:43], v[168:175], v8
    v_smfmac_f32_16x16x64_bf16 v[140:143], v[44:47], v[176:183], v8
    v_cvt_pk_bf16_f32 v134, v148, v149
    v_cvt_pk_bf16_f32 v135, v150, v151
    s_add_u32 s54, s47, 8192
    buffer_store_dwordx4 v[132:135], v5, s[4:7], s54 offen offset:0 sc1
    v_smfmac_f32_16x16x64_bf16 v[140:143], v[48:51], v[184:191], v8
    s_waitcnt lgkmcnt(4)
    v_smfmac_f32_16x16x64_bf16 v[140:143], v[52:55], v[152:159], v8
    v_smfmac_f32_16x16x64_bf16 v[140:143], v[56:59], v[160:167], v8
    s_add_u32 s29, s56, 58368
    buffer_load_dwordx4 v[116:119], v16, s[4:7], s29 offen sc1
    v_smfmac_f32_16x16x64_bf16 v[144:147], v[32:35], v[192:199], v8
    v_smfmac_f32_16x16x64_bf16 v[144:147], v[36:39], v[200:207], v8
    v_smfmac_f32_16x16x64_bf16 v[144:147], v[40:43], v[208:215], v8
    v_smfmac_f32_16x16x64_bf16 v[144:147], v[44:47], v[216:223], v8
    v_cvt_pk_bf16_f32 v136, v140, v141
    v_cvt_pk_bf16_f32 v137, v142, v143
    v_smfmac_f32_16x16x64_bf16 v[144:147], v[48:51], v[224:231], v8
    s_waitcnt lgkmcnt(0)
    v_smfmac_f32_16x16x64_bf16 v[144:147], v[52:55], v[232:239], v8
    v_smfmac_f32_16x16x64_bf16 v[144:147], v[56:59], v[240:247], v8
    s_add_u32 s29, s56, 87040
    buffer_load_dwordx4 v[120:123], v16, s[4:7], s29 offen sc1
    s_add_u32 s46, s46, 458752
    s_nop 7
    s_nop 1
    v_cvt_pk_bf16_f32 v138, v144, v145
    v_cvt_pk_bf16_f32 v139, v146, v147
    s_cmp_eq_u32 s50, 63
    s_cbranch_scc1 V_FIN
    v_mov_b32 v140, 0
    v_mov_b32 v141, 0
    v_mov_b32 v142, 0
    v_mov_b32 v143, 0
    v_mov_b32 v144, 0
    v_mov_b32 v145, 0
    v_mov_b32 v146, 0
    v_mov_b32 v147, 0
V_PP:
    buffer_load_dwordx4 v[32:35], v5, s[4:7], s49 offen offset:0 sc1
    buffer_load_dwordx4 v[36:39], v5, s[4:7], s49 offen offset:1024 sc1
    buffer_load_dwordx4 v[40:43], v5, s[4:7], s51 offen sc1
    s_waitcnt vmcnt(0)
    v_max3_u32 v10, v32, v33, v34
    v_max3_u32 v11, v35, v36, v37
    v_max3_u32 v10, v10, v38, v39
    v_max3_u32 v11, v11, v40, v41
    v_max3_u32 v10, v10, v42, v43
    v_max_u32 v10, v10, v11
    v_cmp_eq_u32 vcc, -1, v10
    s_cbranch_vccz V_PP0
    s_sub_u32 s23, s23, 1
    s_cmp_gt_i32 s23, 0
    s_cbranch_scc1 V_PP
V_PP0:
    v_smfmac_f32_16x16x64_bf16 v[140:143], v[32:35], v[60:67], v8
    v_smfmac_f32_16x16x64_bf16 v[144:147], v[32:35], v[76:83], v8
    v_smfmac_f32_16x16x64_bf16 v[140:143], v[36:39], v[68:75], v8
    v_smfmac_f32_16x16x64_bf16 v[144:147], v[36:39], v[84:91], v8
    v_smfmac_f32_16x16x64_bf16 v[140:143], v[40:43], v[124:131], v8
    v_smfmac_f32_16x16x64_bf16 v[144:147], v[40:43], v[132:139], v8
V_PPE:
    s_cmp_eq_u32 s21, 16
    s_cbranch_scc0 V_NOF
    s_cmp_eq_u32 s20, 2
    s_cbranch_scc0 V_NOF
    s_cmp_eq_u32 s22, 0
    s_cbranch_scc0 SF_8
    buffer_store_dword v18, v17, s[4:7], s55 offen
    s_branch SF_8_e
SF_8:
    buffer_store_dword v18, v17, s[4:7], s55 offen sc1
SF_8_e:
V_NOF:
    s_add_u32 s55, s55, 128
    s_nop 5
    ds_write_b32 v248, v140 offset:0
    ds_write_b32 v249, v141 offset:0
    ds_write_b32 v250, v142 offset:0
    ds_write_b32 v251, v143 offset:0
    ds_write_b32 v248, v144 offset:1024
    ds_write_b32 v249, v145 offset:1024
    ds_write_b32 v250, v146 offset:1024
    ds_write_b32 v251, v147 offset:1024
    s_waitcnt lgkmcnt(0)
    s_barrier
    s_add_u32 s48, s48, 7168
    s_cmp_lt_u32 s20, 2
    s_cbranch_scc0 V_NOPUB
    ds_read_b64 v[152:153], v14 offset:0
    ds_read_b64 v[154:155], v252 offset:0
    ds_read_b64 v[156:157], v14 offset:2048
    ds_read_b64 v[158:159], v252 offset:2048
    ds_read_b64 v[160:161], v14 offset:4096
    ds_read_b64 v[162:163], v252 offset:4096
    ds_read_b64 v[164:165], v14 offset:6144
    ds_read_b64 v[166:167], v252 offset:6144
    s_waitcnt lgkmcnt(6)
    v_pk_add_f32 v[152:153], v[152:153], v[154:155]
    s_waitcnt lgkmcnt(4)
    v_pk_add_f32 v[156:157], v[156:157], v[158:159]
    s_waitcnt lgkmcnt(2)
    v_pk_add_f32 v[160:161], v[160:161], v[162:163]
    s_waitcnt lgkmcnt(0)
    v_pk_add_f32 v[164:165], v[164:165], v[166:167]
    v_pk_add_f32 v[152:153], v[152:153], v[156:157]
    v_pk_add_f32 v[160:161], v[160:161], v[164:165]
    v_pk_add_f32 v[152:153], v[152:153], v[160:161]
    v_cvt_pk_bf16_f32 v20, v152, v153
    v_min_u32 v20, -2, v20
    s_cmp_eq_u32 s22, 0
    s_cbranch_scc0 SF_9
    buffer_store_dword v20, v15, s[4:7], s48 offen
    s_branch SF_9_e
SF_9:
    buffer_store_dword v20, v15, s[4:7], s48 offen sc1
SF_9_e:
V_NOPUB:
    s_add_u32 s54, s47, 8192
    buffer_store_dwordx4 v[136:139], v5, s[4:7], s54 offen offset:1024 sc1
    s_add_u32 s47, s47, 229376
    v_mov_b32 v60, v92
    v_mov_b32 v61, v93
    v_mov_b32 v62, v94
    v_mov_b32 v63, v95
    v_mov_b32 v64, v96
    v_mov_b32 v65, v97
    v_mov_b32 v66, v98
    v_mov_b32 v67, v99
    v_mov_b32 v68, v100
    v_mov_b32 v69, v101
    v_mov_b32 v70, v102
    v_mov_b32 v71, v103
    v_mov_b32 v72, v104
    v_mov_b32 v73, v105
    v_mov_b32 v74, v106
    v_mov_b32 v75, v107
    v_mov_b32 v76, v108
    v_mov_b32 v77, v109
    v_mov_b32 v78, v110
    v_mov_b32 v79, v111
    v_mov_b32 v80, v112
    v_mov_b32 v81, v113
    v_mov_b32 v82, v114
    v_mov_b32 v83, v115
    v_mov_b32 v84, v116
    v_mov_b32 v85, v117
    v_mov_b32 v86, v118
    v_mov_b32 v87, v119
    v_mov_b32 v88, v120
    v_mov_b32 v89, v121
    v_mov_b32 v90, v122
    v_mov_b32 v91, v123
    s_add_u32 s49, s49, 12288
    s_add_u32 s51, s51, 12288
    s_add_u32 s50, s50, 1
    s_branch V_LOOP
V_FIN:
    s_nop 1
    s_add_u32 s54, s47, 8192
    buffer_store_dwordx4 v[136:139], v5, s[4:7], s54 offen offset:1024 sc1
    s_cmp_eq_u32 s21, 19
    s_cbranch_scc0 V_ND
    s_cmp_eq_u32 s20, 0
    s_cbranch_scc0 V_ND
V_ND:
    s_waitcnt vmcnt(0)
    s_barrier
    s_cmp_eq_u32 s20, 0
    s_cbranch_scc0 K2_END
    s_mov_b32 s29, 100532096
    s_mov_b64 exec, 1
    buffer_atomic_add v18, v17, s[4:7], s29 offen
    s_mov_b64 exec, -1
K2_END:
    s_endpgm
.section .rodata,"a"

.p2align 6
.amdhsa_kernel prep_kernel
  .amdhsa_next_free_vgpr 256
  .amdhsa_next_free_sgpr 102
  .amdhsa_accum_offset 256
  .amdhsa_group_segment_fixed_size 0
  .amdhsa_kernarg_size 160
  .amdhsa_user_sgpr_count 2
  .amdhsa_user_sgpr_kernarg_segment_ptr 1
  .amdhsa_system_sgpr_workgroup_id_x 1
.end_amdhsa_kernel

.p2align 6
.amdhsa_kernel main_kernel
  .amdhsa_next_free_vgpr 512
  .amdhsa_next_free_sgpr 102
  .amdhsa_accum_offset 256
  .amdhsa_group_segment_fixed_size 0
  .amdhsa_kernarg_size 160
  .amdhsa_user_sgpr_count 2
  .amdhsa_user_sgpr_kernarg_segment_ptr 1
  .amdhsa_system_sgpr_workgroup_id_x 1
.end_amdhsa_kernel
```
